```python
import torch

def _softmax(x, axis=-1):
    return torch.softmax(x, dim=axis)
def _gelu(x):
    return torch.nn.functional.gelu(x, approximate="tanh")
def _silu(x):
    return torch.nn.functional.silu(x)
def _sigmoid(x):
    return torch.sigmoid(x)
def _layernorm(x, axis=-1, eps=1e-5):
    m = x.mean(dim=axis, keepdim=True)
    v = x.var(dim=axis, keepdim=True, unbiased=False)
    return (x - m) / torch.sqrt(v + eps)
def _scatter_add(tgt, idx, src, axis=0):
    return tgt.clone().index_add_(axis, idx, src)
def _segment_sum(src, seg, n):
    out = torch.zeros((n,) + src.shape[1:], dtype=src.dtype)
    return out.index_add_(0, seg, src)
def _pad(x, pw):
    flat = tuple(v for pair in reversed(pw) for v in pair)
    return torch.nn.functional.pad(x, flat)

kernel_name = 'parallel_sum__ssm_conv_s5__mixer_token_mlp__prompt'

def setup_inputs():

    _w = (lambda a: (lambda t: t.to(torch.bfloat16) if t.is_floating_point() else t)(torch.as_tensor(a)))
    def _A_setup():
        B, S, D = 1, 2048, 1024
        P = D
        Lambda_re = -0.5 * (lambda _x: torch.exp(torch.as_tensor(_x)))((lambda *s: torch.randn(*s, dtype=torch.bfloat16) * 0.1)(P))
        Lambda_im = (lambda *s: torch.randn(*s, dtype=torch.bfloat16) * 0.4)(P) * 1.0
        B_re = (lambda *s: torch.randn(*s, dtype=torch.bfloat16) * 0.2)(P, D) * (D ** -0.5)
        B_im = (lambda *s: torch.randn(*s, dtype=torch.bfloat16) * 0.2)(P, D) * (D ** -0.5)
        C_re = (lambda *s: torch.randn(*s, dtype=torch.bfloat16) * 0.2)(D, P) * (P ** -0.5)
        C_im = (lambda *s: torch.randn(*s, dtype=torch.bfloat16) * 0.2)(D, P) * (P ** -0.5)
        log_dt = (lambda *s: torch.randn(*s, dtype=torch.bfloat16) * 0.1)(P) * 0.3 - 2.0
        Dskip = (lambda *s: torch.randn(*s, dtype=torch.bfloat16) * 0.05)(D)
        return {
            "x": _w((lambda *s: torch.randn(*s, dtype=torch.bfloat16) * 0.05)(B, S, D)),
            "Lambda_re": _w(Lambda_re),
            "Lambda_im": _w(Lambda_im),
            "B_re": _w(B_re),
            "B_im": _w(B_im),
            "C_re": _w(C_re),
            "C_im": _w(C_im),
            "log_dt": _w(log_dt),
            "Dskip": _w(Dskip),
        }
    _A_in = _A_setup()

    def _B_setup():
        B, S, D, F = 1, 2048, 1024, 3584
        return {
            "x": _w((lambda *s: torch.randn(*s, dtype=torch.bfloat16) * 0.05)(B, S, D)),
            "w1": _w((lambda *s: torch.randn(*s, dtype=torch.bfloat16) * 0.8)(S, F) * (S ** -0.5)),
            "b1": _w((lambda *s: torch.randn(*s, dtype=torch.bfloat16) * 3.2)(F) * 0.02),
            "w2": _w((lambda *s: torch.randn(*s, dtype=torch.bfloat16) * 0.4)(F, S) * (F ** -0.5)),
            "b2": _w((lambda *s: torch.randn(*s, dtype=torch.bfloat16) * 1.6)(S) * 0.02),
        }
    _B_in = _B_setup()

    return {
        "A_x": _A_in["x"],
        "A_Lambda_re": _A_in["Lambda_re"],
        "A_Lambda_im": _A_in["Lambda_im"],
        "A_B_re": _A_in["B_re"],
        "A_B_im": _A_in["B_im"],
        "A_C_re": _A_in["C_re"],
        "A_C_im": _A_in["C_im"],
        "A_log_dt": _A_in["log_dt"],
        "A_Dskip": _A_in["Dskip"],
        "B_x": _B_in["x"],
        "B_w1": _B_in["w1"],
        "B_b1": _B_in["b1"],
        "B_w2": _B_in["w2"],
        "B_b2": _B_in["b2"],
    }

def reference(A_x, A_Lambda_re, A_Lambda_im, A_B_re, A_B_im, A_C_re, A_C_im, A_log_dt, A_Dskip, B_x, B_w1, B_b1, B_w2, B_b2):
    def _A_ref(x, Lambda_re, Lambda_im, B_re, B_im, C_re, C_im, log_dt, Dskip):
        Bsz, L, H = x.shape
        Lam = Lambda_re + 1j * Lambda_im
        Bmat = B_re + 1j * B_im
        Cmat = C_re + 1j * C_im
        dt = torch.exp(log_dt)
        Lam_bar = torch.exp(dt * Lam)
        B_bar = ((Lam_bar - 1.0) / Lam)[:, None] * Bmat
        Bu = torch.einsum("bld,pd->blp", x + 0j, B_bar)
        h = torch.zeros_like(Bu[:, 0, :])
        hs = []
        for t in range(L):
            h = Lam_bar[None, :] * h + Bu[:, t, :]
            hs.append(h)
        hseq = torch.stack(hs, 1)
        y = 2.0 * torch.einsum("blp,dp->bld", hseq, Cmat).real + x * Dskip[None, None, :]
        return y

    def _B_ref(x, w1, b1, w2, b2):
        B, S, D = x.shape
        h = _layernorm(x, axis=-1)
        u = torch.einsum("bsd,sf->bdf", h, w1) + b1
        u = _gelu(u)
        y = torch.einsum("bdf,fs->bds", u, w2) + b2
        return (lambda x, *d: x.permute(*d))(y, 0, 2, 1)

    x = A_x
    xn = _layernorm(x, axis=-1)
    return x + _A_ref(xn, A_Lambda_re, A_Lambda_im, A_B_re, A_B_im, A_C_re, A_C_im, A_log_dt, A_Dskip) + _B_ref(xn, B_w1, B_b1, B_w2, B_b2)
```

```asm
; @launch kernel=k1_kernel grid=(256,1,1) block=(384,1,1) lds=163840
.amdgcn_target "amdgcn-amd-amdhsa--gfx950"
.text
.globl k1_kernel
.p2align 8
.type k1_kernel,@function
k1_kernel:
s_cmp_ge_u32 s2, 256
s_cbranch_scc1 K1_end
s_load_dwordx2 s[56:57], s[0:1], 0
s_load_dwordx2 s[52:53], s[0:1], 128
s_load_dwordx4 s[44:47], s[0:1], 24
s_load_dwordx4 s[48:51], s[0:1], 80
s_load_dwordx2 s[54:55], s[0:1], 112
s_load_dwordx2 s[58:59], s[0:1], 64
s_load_dwordx4 s[4:7], s[0:1], 40
s_load_dwordx4 s[20:23], s[0:1], 96
s_load_dwordx4 s[76:79], s[0:1], 8
s_load_dwordx2 s[80:81], s[0:1], 56
v_lshrrev_b32 v2, 6, v0
v_and_b32 v1, 63, v0
v_readfirstlane_b32 s32, v2
s_getpc_b64 s[82:83]
K1_pc:
s_cmp_lt_u32 s32, 4
s_cbranch_scc1 K1_nopf
s_lshr_b32 s62, s2, 2
s_andn2_b32 s62, s62, 1
s_add_u32 s62, s62, s32
s_and_b32 s62, s62, 7
s_lshl_b32 s62, s62, 13
v_lshlrev_b32 v3, 7, v1
v_add_u32 v3, s62, v3
v_min_u32 v3, K1_code_end-K1_pc-4, v3
global_load_dword v60, v3, s[82:83]
K1_nopf:
s_and_b32 s33, s2, 7
s_lshr_b32 s34, s2, 3
s_and_b32 s35, s34, 3
s_bfe_u32 s36, s34, 0x20002
s_add_u32 s88, s35, s36
s_and_b32 s62, s33, 1
s_lshl_b32 s62, s62, 2
s_add_u32 s39, s62, s35
s_lshr_b32 s62, s33, 1
s_lshl_b32 s62, s62, 2
s_add_u32 s40, s62, s36
s_add_u32 s43, s62, s35
s_and_b32 s62, s33, 3
s_lshl_b32 s62, s62, 2
s_add_u32 s41, s62, s35
s_lshr_b32 s62, s33, 2
s_lshl_b32 s62, s62, 2
s_add_u32 s42, s62, s36
s_lshr_b32 s62, s34, 4
s_xor_b32 s62, s62, s33
s_and_b32 s62, s62, 1
s_xor_b32 s62, s62, 1
s_lshl_b32 s62, s62, 2
s_add_u32 s37, s62, s36
s_lshr_b32 s34, s34, 4
s_and_b32 s3, s2, 127
s_lshr_b32 s62, s33, 1
s_lshr_b32 s63, s33, 2
s_xor_b32 s43, s62, s63
s_and_b32 s43, s43, 1
s_lshl_b32 s43, s43, 2
s_add_u32 s43, s43, s35
s_andn2_b32 s64, 1, s33
s_lshl_b32 s64, s64, 3
s_add_u32 s43, s43, s64
s_xor_b32 s37, s63, s34
s_lshl_b32 s37, s37, 2
s_add_u32 s37, s37, s36
s_xor_b32 s33, s62, 0
s_lshl_b32 s38, s43, 3
s_add_u32 s38, s38, s37
s_mov_b32 s99, 0
s_lshr_b32 s60, s32, 1
s_and_b32 s61, s32, 1
s_waitcnt lgkmcnt(0)
s_mov_b32 s8, s44
s_mov_b32 s9, s45
s_mov_b32 s10, 2097152
s_mov_b32 s11, 0x20000
s_mov_b32 s12, s46
s_mov_b32 s13, s47
s_mov_b32 s14, 2097152
s_mov_b32 s15, 0x20000
s_mov_b32 s16, s48
s_mov_b32 s17, s49
s_mov_b32 s18, 14680064
s_mov_b32 s19, 0x20000
s_mov_b32 s24, s52
s_mov_b32 s25, s53
s_mov_b32 s26, 68157440
s_mov_b32 s27, 0x20000
s_mov_b32 s28, s50
s_mov_b32 s29, s51
s_mov_b32 s30, 7168
s_mov_b32 s31, 0x20000
s_cmp_ge_u32 s32, 4
s_cbranch_scc1 K1_prod
s_mov_b32 s68, s56
s_mov_b32 s69, s57
s_mov_b32 s70, 4194304
s_mov_b32 s71, 0x20000
s_lshl_b32 s66, s2, 3
s_lshl_b32 s67, s32, 1
s_add_u32 s66, s66, s67
s_lshl_b32 s67, s66, 11
v_lshlrev_b32 v226, 4, v1
buffer_load_dwordx4 v[160:163], v226, s[68:71], s67 offen offset:0 nt
buffer_load_dwordx4 v[164:167], v226, s[68:71], s67 offen offset:1024 nt
buffer_load_dwordx4 v[168:171], v226, s[68:71], s67 offen offset:2048 nt
buffer_load_dwordx4 v[172:175], v226, s[68:71], s67 offen offset:3072 nt
s_barrier
s_bfe_u32 s64, s66, 0x30002
s_lshl_b32 s64, s64, 4
s_bfe_u32 s65, s66, 0x20005
s_lshl_b32 s65, s65, 2
s_add_u32 s64, s64, s65
s_and_b32 s65, s66, 0xffffff83
s_add_u32 s64, s64, s65
s_lshl_b32 s73, s64, 11
s_add_u32 s72, s67, 4194304
s_lshl_b32 s85, s42, 8
s_lshl_b32 s62, s41, 4
s_add_u32 s85, s85, s62
s_lshl_b32 s62, s32, 2
s_add_u32 s85, s85, s62
s_add_u32 s85, s85, 25427968
s_lshl_b32 s74, s38, 2
s_add_u32 s74, s74, s32
s_lshl_b32 s74, s74, 6
s_add_u32 s74, s74, 25436160
s_lshl_b32 s62, s40, 6
s_lshl_b32 s63, s61, 5
s_add_u32 s62, s62, s63
s_lshl_b32 s70, s39, 1
s_add_u32 s70, s70, s60
s_lshl_b32 s75, s70, 8
s_lshl_b32 s63, s40, 3
s_add_u32 s75, s75, s63
s_lshl_b32 s63, s61, 2
s_add_u32 s75, s75, s63
s_add_u32 s75, s75, 25432064
s_lshl_b32 s63, s62, 3
s_lshl_b32 s64, s70, 13
s_add_u32 s63, s63, s64
s_add_u32 s63, s63, 25231360
s_cmp_eq_u32 s34, 1
s_cselect_b32 s85, s75, s85
s_cselect_b32 s74, s63, s74
s_cselect_b32 s63, -1, 0
s_cselect_b32 s64, 0xffff, 1
s_mov_b32 s65, 0
v_mov_b32 v22, 0
v_mov_b32 v4, s63
v_mov_b32 v5, s63
v_mov_b32 v6, s63
v_mov_b32 v7, s63
v_lshlrev_b32 v8, 4, v1
s_mov_b64 exec, 1
buffer_store_dword v22, v22, s[24:27], s85 offen sc1
s_mov_b64 exec, s[64:65]
buffer_store_dwordx4 v[4:7], v8, s[24:27], s74 offen sc1
s_mov_b64 exec, -1
v_and_b32 v18, 31, v1
v_mul_u32_u24 v18, 16, v18
s_and_b32 s97, s2, 7
s_lshl_b32 s97, s97, 3
s_mul_i32 s98, s39, s34
s_add_u32 s97, s97, s98
s_mul_i32 s100, s97, 512
s_add_u32 s100, s100, 26214400
buffer_load_dword v19, v18, s[24:27], s100 offen sc1
s_waitcnt vmcnt(3)
K1_lnloop:
v_lshlrev_b32 v128, 16, v160
v_and_b32 v129, 0xffff0000, v160
v_lshlrev_b32 v130, 16, v161
v_and_b32 v131, 0xffff0000, v161
v_lshlrev_b32 v132, 16, v162
v_and_b32 v133, 0xffff0000, v162
v_lshlrev_b32 v134, 16, v163
v_and_b32 v135, 0xffff0000, v163
v_lshlrev_b32 v136, 16, v164
v_and_b32 v137, 0xffff0000, v164
v_lshlrev_b32 v138, 16, v165
v_and_b32 v139, 0xffff0000, v165
v_lshlrev_b32 v140, 16, v166
v_and_b32 v141, 0xffff0000, v166
v_lshlrev_b32 v142, 16, v167
v_and_b32 v143, 0xffff0000, v167
v_lshlrev_b32 v144, 16, v168
v_and_b32 v145, 0xffff0000, v168
v_lshlrev_b32 v146, 16, v169
v_and_b32 v147, 0xffff0000, v169
v_lshlrev_b32 v148, 16, v170
v_and_b32 v149, 0xffff0000, v170
v_lshlrev_b32 v150, 16, v171
v_and_b32 v151, 0xffff0000, v171
v_lshlrev_b32 v152, 16, v172
v_and_b32 v153, 0xffff0000, v172
v_lshlrev_b32 v154, 16, v173
v_and_b32 v155, 0xffff0000, v173
v_lshlrev_b32 v156, 16, v174
v_and_b32 v157, 0xffff0000, v174
v_lshlrev_b32 v158, 16, v175
v_and_b32 v159, 0xffff0000, v175
v_pk_add_f32 v[208:209], v[128:129], v[130:131]
v_pk_add_f32 v[210:211], v[132:133], v[134:135]
v_pk_add_f32 v[216:217], v[144:145], v[146:147]
v_pk_add_f32 v[218:219], v[148:149], v[150:151]
v_pk_add_f32 v[212:213], v[136:137], v[138:139]
v_pk_add_f32 v[214:215], v[140:141], v[142:143]
v_pk_add_f32 v[220:221], v[152:153], v[154:155]
v_pk_add_f32 v[222:223], v[156:157], v[158:159]
v_pk_add_f32 v[208:209], v[208:209], v[210:211]
v_pk_add_f32 v[212:213], v[212:213], v[214:215]
v_pk_add_f32 v[216:217], v[216:217], v[218:219]
v_pk_add_f32 v[220:221], v[220:221], v[222:223]
v_pk_add_f32 v[208:209], v[208:209], v[212:213]
v_pk_add_f32 v[216:217], v[216:217], v[220:221]
v_add_f32 v208, v208, v209
v_add_f32 v216, v216, v217
s_nop 0
v_add_f32_dpp v208, v208, v208 quad_perm:[1,0,3,2] row_mask:0xf bank_mask:0xf
v_add_f32_dpp v216, v216, v216 quad_perm:[1,0,3,2] row_mask:0xf bank_mask:0xf
s_nop 0
v_add_f32_dpp v208, v208, v208 quad_perm:[2,3,0,1] row_mask:0xf bank_mask:0xf
v_add_f32_dpp v216, v216, v216 quad_perm:[2,3,0,1] row_mask:0xf bank_mask:0xf
s_nop 0
v_add_f32_dpp v208, v208, v208 row_half_mirror row_mask:0xf bank_mask:0xf
v_add_f32_dpp v216, v216, v216 row_half_mirror row_mask:0xf bank_mask:0xf
s_nop 0
v_add_f32_dpp v208, v208, v208 row_mirror row_mask:0xf bank_mask:0xf
v_add_f32_dpp v216, v216, v216 row_mirror row_mask:0xf bank_mask:0xf
s_nop 0
v_add_f32_dpp v208, v208, v208 row_bcast:15 row_mask:0xa bank_mask:0xf
v_add_f32_dpp v216, v216, v216 row_bcast:15 row_mask:0xa bank_mask:0xf
s_nop 0
v_add_f32_dpp v208, v208, v208 row_bcast:31 row_mask:0xc bank_mask:0xf
v_add_f32_dpp v216, v216, v216 row_bcast:31 row_mask:0xc bank_mask:0xf
s_nop 1
v_readlane_b32 s64, v208, 63
v_readlane_b32 s65, v216, 63
s_nop 0
v_mov_b32 v214, 0xba800000
v_mul_f32 v214, s64, v214
v_mov_b32 v222, 0xba800000
v_mul_f32 v222, s65, v222
v_pk_add_f32 v[176:177], v[128:129], v[214:215] op_sel_hi:[1,0]
v_pk_add_f32 v[178:179], v[130:131], v[214:215] op_sel_hi:[1,0]
v_pk_add_f32 v[184:185], v[144:145], v[222:223] op_sel_hi:[1,0]
v_pk_add_f32 v[186:187], v[146:147], v[222:223] op_sel_hi:[1,0]
v_pk_mul_f32 v[208:209], v[176:177], v[176:177]
v_pk_mul_f32 v[210:211], v[178:179], v[178:179]
v_pk_mul_f32 v[216:217], v[184:185], v[184:185]
v_pk_mul_f32 v[218:219], v[186:187], v[186:187]
v_pk_add_f32 v[176:177], v[132:133], v[214:215] op_sel_hi:[1,0]
v_pk_add_f32 v[178:179], v[134:135], v[214:215] op_sel_hi:[1,0]
v_pk_add_f32 v[184:185], v[148:149], v[222:223] op_sel_hi:[1,0]
v_pk_add_f32 v[186:187], v[150:151], v[222:223] op_sel_hi:[1,0]
v_pk_fma_f32 v[208:209], v[176:177], v[176:177], v[208:209]
v_pk_fma_f32 v[210:211], v[178:179], v[178:179], v[210:211]
v_pk_fma_f32 v[216:217], v[184:185], v[184:185], v[216:217]
v_pk_fma_f32 v[218:219], v[186:187], v[186:187], v[218:219]
v_pk_add_f32 v[176:177], v[136:137], v[214:215] op_sel_hi:[1,0]
v_pk_add_f32 v[178:179], v[138:139], v[214:215] op_sel_hi:[1,0]
v_pk_add_f32 v[184:185], v[152:153], v[222:223] op_sel_hi:[1,0]
v_pk_add_f32 v[186:187], v[154:155], v[222:223] op_sel_hi:[1,0]
v_pk_fma_f32 v[208:209], v[176:177], v[176:177], v[208:209]
v_pk_fma_f32 v[210:211], v[178:179], v[178:179], v[210:211]
v_pk_fma_f32 v[216:217], v[184:185], v[184:185], v[216:217]
v_pk_fma_f32 v[218:219], v[186:187], v[186:187], v[218:219]
v_pk_add_f32 v[176:177], v[140:141], v[214:215] op_sel_hi:[1,0]
v_pk_add_f32 v[178:179], v[142:143], v[214:215] op_sel_hi:[1,0]
v_pk_add_f32 v[184:185], v[156:157], v[222:223] op_sel_hi:[1,0]
v_pk_add_f32 v[186:187], v[158:159], v[222:223] op_sel_hi:[1,0]
v_pk_fma_f32 v[208:209], v[176:177], v[176:177], v[208:209]
v_pk_fma_f32 v[210:211], v[178:179], v[178:179], v[210:211]
v_pk_fma_f32 v[216:217], v[184:185], v[184:185], v[216:217]
v_pk_fma_f32 v[218:219], v[186:187], v[186:187], v[218:219]
v_pk_add_f32 v[208:209], v[208:209], v[210:211]
v_pk_add_f32 v[216:217], v[216:217], v[218:219]
v_add_f32 v208, v208, v209
v_add_f32 v216, v216, v217
s_nop 0
v_add_f32_dpp v208, v208, v208 quad_perm:[1,0,3,2] row_mask:0xf bank_mask:0xf
v_add_f32_dpp v216, v216, v216 quad_perm:[1,0,3,2] row_mask:0xf bank_mask:0xf
s_nop 0
v_add_f32_dpp v208, v208, v208 quad_perm:[2,3,0,1] row_mask:0xf bank_mask:0xf
v_add_f32_dpp v216, v216, v216 quad_perm:[2,3,0,1] row_mask:0xf bank_mask:0xf
s_nop 0
v_add_f32_dpp v208, v208, v208 row_half_mirror row_mask:0xf bank_mask:0xf
v_add_f32_dpp v216, v216, v216 row_half_mirror row_mask:0xf bank_mask:0xf
s_nop 0
v_add_f32_dpp v208, v208, v208 row_mirror row_mask:0xf bank_mask:0xf
v_add_f32_dpp v216, v216, v216 row_mirror row_mask:0xf bank_mask:0xf
s_nop 0
v_add_f32_dpp v208, v208, v208 row_bcast:15 row_mask:0xa bank_mask:0xf
v_add_f32_dpp v216, v216, v216 row_bcast:15 row_mask:0xa bank_mask:0xf
s_nop 0
v_add_f32_dpp v208, v208, v208 row_bcast:31 row_mask:0xc bank_mask:0xf
v_add_f32_dpp v216, v216, v216 row_bcast:31 row_mask:0xc bank_mask:0xf
s_nop 1
v_readlane_b32 s64, v208, 63
v_readlane_b32 s65, v216, 63
v_cvt_pk_bf16_f32 v214, 0, v214
v_cvt_pk_bf16_f32 v222, 0, v222
v_mov_b32 v208, 0x3a800000
v_mul_f32 v208, s64, v208
v_mov_b32 v216, 0x3a800000
v_mul_f32 v216, s65, v216
v_cvt_pk_bf16_f32 v208, 0, v208
v_cvt_pk_bf16_f32 v216, 0, v216
v_add_f32 v208, 0x3727c5ac, v208
v_add_f32 v216, 0x3727c5ac, v216
v_cvt_pk_bf16_f32 v208, 0, v208
v_cvt_pk_bf16_f32 v216, 0, v216
v_sqrt_f32 v208, v208
v_sqrt_f32 v216, v216
v_pk_add_f32 v[128:129], v[128:129], v[214:215] op_sel_hi:[1,0]
v_pk_add_f32 v[144:145], v[144:145], v[222:223] op_sel_hi:[1,0]
v_pk_add_f32 v[130:131], v[130:131], v[214:215] op_sel_hi:[1,0]
v_pk_add_f32 v[146:147], v[146:147], v[222:223] op_sel_hi:[1,0]
v_pk_add_f32 v[132:133], v[132:133], v[214:215] op_sel_hi:[1,0]
v_pk_add_f32 v[148:149], v[148:149], v[222:223] op_sel_hi:[1,0]
v_pk_add_f32 v[134:135], v[134:135], v[214:215] op_sel_hi:[1,0]
v_pk_add_f32 v[150:151], v[150:151], v[222:223] op_sel_hi:[1,0]
v_pk_add_f32 v[136:137], v[136:137], v[214:215] op_sel_hi:[1,0]
v_pk_add_f32 v[152:153], v[152:153], v[222:223] op_sel_hi:[1,0]
v_pk_add_f32 v[138:139], v[138:139], v[214:215] op_sel_hi:[1,0]
v_pk_add_f32 v[154:155], v[154:155], v[222:223] op_sel_hi:[1,0]
v_pk_add_f32 v[140:141], v[140:141], v[214:215] op_sel_hi:[1,0]
v_pk_add_f32 v[156:157], v[156:157], v[222:223] op_sel_hi:[1,0]
v_pk_add_f32 v[142:143], v[142:143], v[214:215] op_sel_hi:[1,0]
v_pk_add_f32 v[158:159], v[158:159], v[222:223] op_sel_hi:[1,0]
v_cvt_pk_bf16_f32 v208, 0, v208
v_cvt_pk_bf16_f32 v216, 0, v216
v_rcp_f32 v210, v208
v_rcp_f32 v218, v216
v_cvt_pk_bf16_f32 v128, 0, v128
v_cvt_pk_bf16_f32 v144, 0, v144
v_cvt_pk_bf16_f32 v129, 0, v129
v_cvt_pk_bf16_f32 v145, 0, v145
v_cvt_pk_bf16_f32 v130, 0, v130
v_cvt_pk_bf16_f32 v146, 0, v146
v_cvt_pk_bf16_f32 v131, 0, v131
v_cvt_pk_bf16_f32 v147, 0, v147
v_cvt_pk_bf16_f32 v132, 0, v132
v_cvt_pk_bf16_f32 v148, 0, v148
v_cvt_pk_bf16_f32 v133, 0, v133
v_cvt_pk_bf16_f32 v149, 0, v149
v_cvt_pk_bf16_f32 v134, 0, v134
v_cvt_pk_bf16_f32 v150, 0, v150
v_cvt_pk_bf16_f32 v135, 0, v135
v_cvt_pk_bf16_f32 v151, 0, v151
v_cvt_pk_bf16_f32 v136, 0, v136
v_cvt_pk_bf16_f32 v152, 0, v152
v_cvt_pk_bf16_f32 v137, 0, v137
v_cvt_pk_bf16_f32 v153, 0, v153
v_cvt_pk_bf16_f32 v138, 0, v138
v_cvt_pk_bf16_f32 v154, 0, v154
v_cvt_pk_bf16_f32 v139, 0, v139
v_cvt_pk_bf16_f32 v155, 0, v155
v_cvt_pk_bf16_f32 v140, 0, v140
v_cvt_pk_bf16_f32 v156, 0, v156
v_cvt_pk_bf16_f32 v141, 0, v141
v_cvt_pk_bf16_f32 v157, 0, v157
v_cvt_pk_bf16_f32 v142, 0, v142
v_cvt_pk_bf16_f32 v158, 0, v158
v_cvt_pk_bf16_f32 v143, 0, v143
v_cvt_pk_bf16_f32 v159, 0, v159
v_fma_f32 v211, -v208, v210, 1.0
v_fma_f32 v219, -v216, v218, 1.0
v_fma_f32 v210, v210, v211, v210
v_fma_f32 v218, v218, v219, v218
v_pk_mul_f32 v[128:129], v[128:129], v[210:211] op_sel_hi:[1,0]
v_pk_mul_f32 v[144:145], v[144:145], v[218:219] op_sel_hi:[1,0]
v_pk_mul_f32 v[130:131], v[130:131], v[210:211] op_sel_hi:[1,0]
v_pk_mul_f32 v[146:147], v[146:147], v[218:219] op_sel_hi:[1,0]
v_pk_mul_f32 v[132:133], v[132:133], v[210:211] op_sel_hi:[1,0]
v_pk_mul_f32 v[148:149], v[148:149], v[218:219] op_sel_hi:[1,0]
v_pk_mul_f32 v[134:135], v[134:135], v[210:211] op_sel_hi:[1,0]
v_pk_mul_f32 v[150:151], v[150:151], v[218:219] op_sel_hi:[1,0]
v_pk_mul_f32 v[136:137], v[136:137], v[210:211] op_sel_hi:[1,0]
v_pk_mul_f32 v[152:153], v[152:153], v[218:219] op_sel_hi:[1,0]
v_pk_mul_f32 v[138:139], v[138:139], v[210:211] op_sel_hi:[1,0]
v_pk_mul_f32 v[154:155], v[154:155], v[218:219] op_sel_hi:[1,0]
v_pk_mul_f32 v[140:141], v[140:141], v[210:211] op_sel_hi:[1,0]
v_pk_mul_f32 v[156:157], v[156:157], v[218:219] op_sel_hi:[1,0]
v_pk_mul_f32 v[142:143], v[142:143], v[210:211] op_sel_hi:[1,0]
v_pk_mul_f32 v[158:159], v[158:159], v[218:219] op_sel_hi:[1,0]
v_cvt_pk_bf16_f32 v176, v128, v129
v_cvt_pk_bf16_f32 v184, v144, v145
v_cvt_pk_bf16_f32 v177, v130, v131
v_cvt_pk_bf16_f32 v185, v146, v147
v_cvt_pk_bf16_f32 v178, v132, v133
v_cvt_pk_bf16_f32 v186, v148, v149
v_cvt_pk_bf16_f32 v179, v134, v135
v_cvt_pk_bf16_f32 v187, v150, v151
v_cvt_pk_bf16_f32 v180, v136, v137
v_cvt_pk_bf16_f32 v188, v152, v153
v_cvt_pk_bf16_f32 v181, v138, v139
v_cvt_pk_bf16_f32 v189, v154, v155
v_cvt_pk_bf16_f32 v182, v140, v141
v_cvt_pk_bf16_f32 v190, v156, v157
v_cvt_pk_bf16_f32 v183, v142, v143
v_cvt_pk_bf16_f32 v191, v158, v159
v_lshlrev_b32 v128, 16, v176
v_and_b32 v129, 0xffff0000, v176
v_lshlrev_b32 v144, 16, v184
v_and_b32 v145, 0xffff0000, v184
v_lshlrev_b32 v130, 16, v177
v_and_b32 v131, 0xffff0000, v177
v_lshlrev_b32 v146, 16, v185
v_and_b32 v147, 0xffff0000, v185
v_lshlrev_b32 v132, 16, v178
v_and_b32 v133, 0xffff0000, v178
v_lshlrev_b32 v148, 16, v186
v_and_b32 v149, 0xffff0000, v186
v_lshlrev_b32 v134, 16, v179
v_and_b32 v135, 0xffff0000, v179
v_lshlrev_b32 v150, 16, v187
v_and_b32 v151, 0xffff0000, v187
v_lshlrev_b32 v136, 16, v180
v_and_b32 v137, 0xffff0000, v180
v_lshlrev_b32 v152, 16, v188
v_and_b32 v153, 0xffff0000, v188
v_lshlrev_b32 v138, 16, v181
v_and_b32 v139, 0xffff0000, v181
v_lshlrev_b32 v154, 16, v189
v_and_b32 v155, 0xffff0000, v189
v_lshlrev_b32 v140, 16, v182
v_and_b32 v141, 0xffff0000, v182
v_lshlrev_b32 v156, 16, v190
v_and_b32 v157, 0xffff0000, v190
v_lshlrev_b32 v142, 16, v183
v_and_b32 v143, 0xffff0000, v183
v_lshlrev_b32 v158, 16, v191
v_and_b32 v159, 0xffff0000, v191
v_mov_b32 v232, v214
v_mov_b32 v233, v210
v_mov_b32 v234, v222
v_mov_b32 v235, v218
s_lshl_b32 s64, s66, 5
s_add_u32 s64, s64, 25690112
v_mov_b32 v225, 0
s_mov_b64 exec, 1
buffer_store_dwordx4 v[232:235], v225, s[24:27], s64 offen sc1
s_mov_b64 exec, -1
buffer_store_dwordx4 v[176:179], v226, s[24:27], s73 offen offset:0 sc1
buffer_store_dwordx4 v[180:183], v226, s[24:27], s73 offen offset:1024 sc1
buffer_store_dwordx4 v[184:187], v226, s[24:27], s73 offen offset:2048 sc1
buffer_store_dwordx4 v[188:191], v226, s[24:27], s73 offen offset:3072 sc1
v_pk_add_f32 v[208:209], v[128:129], v[130:131]
v_pk_add_f32 v[210:211], v[132:133], v[134:135]
v_pk_add_f32 v[216:217], v[144:145], v[146:147]
v_pk_add_f32 v[218:219], v[148:149], v[150:151]
v_pk_add_f32 v[212:213], v[136:137], v[138:139]
v_pk_add_f32 v[214:215], v[140:141], v[142:143]
v_pk_add_f32 v[220:221], v[152:153], v[154:155]
v_pk_add_f32 v[222:223], v[156:157], v[158:159]
v_pk_add_f32 v[208:209], v[208:209], v[210:211]
v_pk_add_f32 v[212:213], v[212:213], v[214:215]
v_pk_add_f32 v[216:217], v[216:217], v[218:219]
v_pk_add_f32 v[220:221], v[220:221], v[222:223]
v_pk_add_f32 v[208:209], v[208:209], v[212:213]
v_pk_add_f32 v[216:217], v[216:217], v[220:221]
v_add_f32 v208, v208, v209
v_add_f32 v216, v216, v217
s_nop 0
v_add_f32_dpp v208, v208, v208 quad_perm:[1,0,3,2] row_mask:0xf bank_mask:0xf
v_add_f32_dpp v216, v216, v216 quad_perm:[1,0,3,2] row_mask:0xf bank_mask:0xf
s_nop 0
v_add_f32_dpp v208, v208, v208 quad_perm:[2,3,0,1] row_mask:0xf bank_mask:0xf
v_add_f32_dpp v216, v216, v216 quad_perm:[2,3,0,1] row_mask:0xf bank_mask:0xf
s_nop 0
v_add_f32_dpp v208, v208, v208 row_half_mirror row_mask:0xf bank_mask:0xf
v_add_f32_dpp v216, v216, v216 row_half_mirror row_mask:0xf bank_mask:0xf
s_nop 0
v_add_f32_dpp v208, v208, v208 row_mirror row_mask:0xf bank_mask:0xf
v_add_f32_dpp v216, v216, v216 row_mirror row_mask:0xf bank_mask:0xf
s_nop 0
v_add_f32_dpp v208, v208, v208 row_bcast:15 row_mask:0xa bank_mask:0xf
v_add_f32_dpp v216, v216, v216 row_bcast:15 row_mask:0xa bank_mask:0xf
s_nop 0
v_add_f32_dpp v208, v208, v208 row_bcast:31 row_mask:0xc bank_mask:0xf
v_add_f32_dpp v216, v216, v216 row_bcast:31 row_mask:0xc bank_mask:0xf
s_nop 1
v_readlane_b32 s64, v208, 63
v_readlane_b32 s65, v216, 63
s_nop 0
v_mov_b32 v214, 0xba800000
v_mul_f32 v214, s64, v214
v_mov_b32 v222, 0xba800000
v_mul_f32 v222, s65, v222
v_pk_add_f32 v[192:193], v[128:129], v[214:215] op_sel_hi:[1,0]
v_pk_add_f32 v[194:195], v[130:131], v[214:215] op_sel_hi:[1,0]
v_pk_add_f32 v[200:201], v[144:145], v[222:223] op_sel_hi:[1,0]
v_pk_add_f32 v[202:203], v[146:147], v[222:223] op_sel_hi:[1,0]
v_pk_mul_f32 v[208:209], v[192:193], v[192:193]
v_pk_mul_f32 v[210:211], v[194:195], v[194:195]
v_pk_mul_f32 v[216:217], v[200:201], v[200:201]
v_pk_mul_f32 v[218:219], v[202:203], v[202:203]
v_pk_add_f32 v[192:193], v[132:133], v[214:215] op_sel_hi:[1,0]
v_pk_add_f32 v[194:195], v[134:135], v[214:215] op_sel_hi:[1,0]
v_pk_add_f32 v[200:201], v[148:149], v[222:223] op_sel_hi:[1,0]
v_pk_add_f32 v[202:203], v[150:151], v[222:223] op_sel_hi:[1,0]
v_pk_fma_f32 v[208:209], v[192:193], v[192:193], v[208:209]
v_pk_fma_f32 v[210:211], v[194:195], v[194:195], v[210:211]
v_pk_fma_f32 v[216:217], v[200:201], v[200:201], v[216:217]
v_pk_fma_f32 v[218:219], v[202:203], v[202:203], v[218:219]
v_pk_add_f32 v[192:193], v[136:137], v[214:215] op_sel_hi:[1,0]
v_pk_add_f32 v[194:195], v[138:139], v[214:215] op_sel_hi:[1,0]
v_pk_add_f32 v[200:201], v[152:153], v[222:223] op_sel_hi:[1,0]
v_pk_add_f32 v[202:203], v[154:155], v[222:223] op_sel_hi:[1,0]
v_pk_fma_f32 v[208:209], v[192:193], v[192:193], v[208:209]
v_pk_fma_f32 v[210:211], v[194:195], v[194:195], v[210:211]
v_pk_fma_f32 v[216:217], v[200:201], v[200:201], v[216:217]
v_pk_fma_f32 v[218:219], v[202:203], v[202:203], v[218:219]
v_pk_add_f32 v[192:193], v[140:141], v[214:215] op_sel_hi:[1,0]
v_pk_add_f32 v[194:195], v[142:143], v[214:215] op_sel_hi:[1,0]
v_pk_add_f32 v[200:201], v[156:157], v[222:223] op_sel_hi:[1,0]
v_pk_add_f32 v[202:203], v[158:159], v[222:223] op_sel_hi:[1,0]
v_pk_fma_f32 v[208:209], v[192:193], v[192:193], v[208:209]
v_pk_fma_f32 v[210:211], v[194:195], v[194:195], v[210:211]
v_pk_fma_f32 v[216:217], v[200:201], v[200:201], v[216:217]
v_pk_fma_f32 v[218:219], v[202:203], v[202:203], v[218:219]
v_pk_add_f32 v[208:209], v[208:209], v[210:211]
v_pk_add_f32 v[216:217], v[216:217], v[218:219]
v_add_f32 v208, v208, v209
v_add_f32 v216, v216, v217
s_nop 0
v_add_f32_dpp v208, v208, v208 quad_perm:[1,0,3,2] row_mask:0xf bank_mask:0xf
v_add_f32_dpp v216, v216, v216 quad_perm:[1,0,3,2] row_mask:0xf bank_mask:0xf
s_nop 0
v_add_f32_dpp v208, v208, v208 quad_perm:[2,3,0,1] row_mask:0xf bank_mask:0xf
v_add_f32_dpp v216, v216, v216 quad_perm:[2,3,0,1] row_mask:0xf bank_mask:0xf
s_nop 0
v_add_f32_dpp v208, v208, v208 row_half_mirror row_mask:0xf bank_mask:0xf
v_add_f32_dpp v216, v216, v216 row_half_mirror row_mask:0xf bank_mask:0xf
s_nop 0
v_add_f32_dpp v208, v208, v208 row_mirror row_mask:0xf bank_mask:0xf
v_add_f32_dpp v216, v216, v216 row_mirror row_mask:0xf bank_mask:0xf
s_nop 0
v_add_f32_dpp v208, v208, v208 row_bcast:15 row_mask:0xa bank_mask:0xf
v_add_f32_dpp v216, v216, v216 row_bcast:15 row_mask:0xa bank_mask:0xf
s_nop 0
v_add_f32_dpp v208, v208, v208 row_bcast:31 row_mask:0xc bank_mask:0xf
v_add_f32_dpp v216, v216, v216 row_bcast:31 row_mask:0xc bank_mask:0xf
s_nop 1
v_readlane_b32 s64, v208, 63
v_readlane_b32 s65, v216, 63
v_cvt_pk_bf16_f32 v214, 0, v214
v_cvt_pk_bf16_f32 v222, 0, v222
v_mov_b32 v208, 0x3a800000
v_mul_f32 v208, s64, v208
v_mov_b32 v216, 0x3a800000
v_mul_f32 v216, s65, v216
v_cvt_pk_bf16_f32 v208, 0, v208
v_cvt_pk_bf16_f32 v216, 0, v216
v_add_f32 v208, 0x3727c5ac, v208
v_add_f32 v216, 0x3727c5ac, v216
v_cvt_pk_bf16_f32 v208, 0, v208
v_cvt_pk_bf16_f32 v216, 0, v216
v_sqrt_f32 v208, v208
v_sqrt_f32 v216, v216
v_pk_add_f32 v[128:129], v[128:129], v[214:215] op_sel_hi:[1,0]
v_pk_add_f32 v[144:145], v[144:145], v[222:223] op_sel_hi:[1,0]
v_pk_add_f32 v[130:131], v[130:131], v[214:215] op_sel_hi:[1,0]
v_pk_add_f32 v[146:147], v[146:147], v[222:223] op_sel_hi:[1,0]
v_pk_add_f32 v[132:133], v[132:133], v[214:215] op_sel_hi:[1,0]
v_pk_add_f32 v[148:149], v[148:149], v[222:223] op_sel_hi:[1,0]
v_pk_add_f32 v[134:135], v[134:135], v[214:215] op_sel_hi:[1,0]
v_pk_add_f32 v[150:151], v[150:151], v[222:223] op_sel_hi:[1,0]
v_pk_add_f32 v[136:137], v[136:137], v[214:215] op_sel_hi:[1,0]
v_pk_add_f32 v[152:153], v[152:153], v[222:223] op_sel_hi:[1,0]
v_pk_add_f32 v[138:139], v[138:139], v[214:215] op_sel_hi:[1,0]
v_pk_add_f32 v[154:155], v[154:155], v[222:223] op_sel_hi:[1,0]
v_pk_add_f32 v[140:141], v[140:141], v[214:215] op_sel_hi:[1,0]
v_pk_add_f32 v[156:157], v[156:157], v[222:223] op_sel_hi:[1,0]
v_pk_add_f32 v[142:143], v[142:143], v[214:215] op_sel_hi:[1,0]
v_pk_add_f32 v[158:159], v[158:159], v[222:223] op_sel_hi:[1,0]
v_cvt_pk_bf16_f32 v208, 0, v208
v_cvt_pk_bf16_f32 v216, 0, v216
v_rcp_f32 v210, v208
v_rcp_f32 v218, v216
v_cvt_pk_bf16_f32 v128, 0, v128
v_cvt_pk_bf16_f32 v144, 0, v144
v_cvt_pk_bf16_f32 v129, 0, v129
v_cvt_pk_bf16_f32 v145, 0, v145
v_cvt_pk_bf16_f32 v130, 0, v130
v_cvt_pk_bf16_f32 v146, 0, v146
v_cvt_pk_bf16_f32 v131, 0, v131
v_cvt_pk_bf16_f32 v147, 0, v147
v_cvt_pk_bf16_f32 v132, 0, v132
v_cvt_pk_bf16_f32 v148, 0, v148
v_cvt_pk_bf16_f32 v133, 0, v133
v_cvt_pk_bf16_f32 v149, 0, v149
v_cvt_pk_bf16_f32 v134, 0, v134
v_cvt_pk_bf16_f32 v150, 0, v150
v_cvt_pk_bf16_f32 v135, 0, v135
v_cvt_pk_bf16_f32 v151, 0, v151
v_cvt_pk_bf16_f32 v136, 0, v136
v_cvt_pk_bf16_f32 v152, 0, v152
v_cvt_pk_bf16_f32 v137, 0, v137
v_cvt_pk_bf16_f32 v153, 0, v153
v_cvt_pk_bf16_f32 v138, 0, v138
v_cvt_pk_bf16_f32 v154, 0, v154
v_cvt_pk_bf16_f32 v139, 0, v139
v_cvt_pk_bf16_f32 v155, 0, v155
v_cvt_pk_bf16_f32 v140, 0, v140
v_cvt_pk_bf16_f32 v156, 0, v156
v_cvt_pk_bf16_f32 v141, 0, v141
v_cvt_pk_bf16_f32 v157, 0, v157
v_cvt_pk_bf16_f32 v142, 0, v142
v_cvt_pk_bf16_f32 v158, 0, v158
v_cvt_pk_bf16_f32 v143, 0, v143
v_cvt_pk_bf16_f32 v159, 0, v159
v_fma_f32 v211, -v208, v210, 1.0
v_fma_f32 v219, -v216, v218, 1.0
v_fma_f32 v210, v210, v211, v210
v_fma_f32 v218, v218, v219, v218
v_pk_mul_f32 v[128:129], v[128:129], v[210:211] op_sel_hi:[1,0]
v_pk_mul_f32 v[144:145], v[144:145], v[218:219] op_sel_hi:[1,0]
v_pk_mul_f32 v[130:131], v[130:131], v[210:211] op_sel_hi:[1,0]
v_pk_mul_f32 v[146:147], v[146:147], v[218:219] op_sel_hi:[1,0]
v_pk_mul_f32 v[132:133], v[132:133], v[210:211] op_sel_hi:[1,0]
v_pk_mul_f32 v[148:149], v[148:149], v[218:219] op_sel_hi:[1,0]
v_pk_mul_f32 v[134:135], v[134:135], v[210:211] op_sel_hi:[1,0]
v_pk_mul_f32 v[150:151], v[150:151], v[218:219] op_sel_hi:[1,0]
v_pk_mul_f32 v[136:137], v[136:137], v[210:211] op_sel_hi:[1,0]
v_pk_mul_f32 v[152:153], v[152:153], v[218:219] op_sel_hi:[1,0]
v_pk_mul_f32 v[138:139], v[138:139], v[210:211] op_sel_hi:[1,0]
v_pk_mul_f32 v[154:155], v[154:155], v[218:219] op_sel_hi:[1,0]
v_pk_mul_f32 v[140:141], v[140:141], v[210:211] op_sel_hi:[1,0]
v_pk_mul_f32 v[156:157], v[156:157], v[218:219] op_sel_hi:[1,0]
v_pk_mul_f32 v[142:143], v[142:143], v[210:211] op_sel_hi:[1,0]
v_pk_mul_f32 v[158:159], v[158:159], v[218:219] op_sel_hi:[1,0]
v_cvt_pk_bf16_f32 v192, v128, v129
v_cvt_pk_bf16_f32 v200, v144, v145
v_cvt_pk_bf16_f32 v193, v130, v131
v_cvt_pk_bf16_f32 v201, v146, v147
v_cvt_pk_bf16_f32 v194, v132, v133
v_cvt_pk_bf16_f32 v202, v148, v149
v_cvt_pk_bf16_f32 v195, v134, v135
v_cvt_pk_bf16_f32 v203, v150, v151
v_cvt_pk_bf16_f32 v196, v136, v137
v_cvt_pk_bf16_f32 v204, v152, v153
v_cvt_pk_bf16_f32 v197, v138, v139
v_cvt_pk_bf16_f32 v205, v154, v155
v_cvt_pk_bf16_f32 v198, v140, v141
v_cvt_pk_bf16_f32 v206, v156, v157
v_cvt_pk_bf16_f32 v199, v142, v143
v_cvt_pk_bf16_f32 v207, v158, v159
buffer_store_dwordx4 v[192:195], v226, s[24:27], s72 offen offset:0 sc1
buffer_store_dwordx4 v[196:199], v226, s[24:27], s72 offen offset:1024 sc1
buffer_store_dwordx4 v[200:203], v226, s[24:27], s72 offen offset:2048 sc1
buffer_store_dwordx4 v[204:207], v226, s[24:27], s72 offen offset:3072 sc1
s_waitcnt vmcnt(0)
s_barrier
s_cmp_eq_u32 s34, 1
s_cbranch_scc1 K1_g1
s_mul_i32 s62, s41, 448
s_lshl_b32 s63, s60, 8
s_add_u32 s63, s63, s62
v_lshrrev_b32 v16, 4, v1
v_lshlrev_b32 v17, 3, v16
buffer_load_dwordx2 v[240:241], v17, s[28:31], s63 offen offset:0
buffer_load_dwordx2 v[242:243], v17, s[28:31], s63 offen offset:32
buffer_load_dwordx2 v[244:245], v17, s[28:31], s63 offen offset:64
buffer_load_dwordx2 v[246:247], v17, s[28:31], s63 offen offset:96
buffer_load_dwordx2 v[248:249], v17, s[28:31], s63 offen offset:128
buffer_load_dwordx2 v[250:251], v17, s[28:31], s63 offen offset:160
buffer_load_dwordx2 v[252:253], v17, s[28:31], s62 offen offset:192
buffer_load_dwordx2 v[254:255], v17, s[28:31], s62 offen offset:224
s_mov_b32 s8, s22
s_mov_b32 s9, s23
s_mov_b32 s10, 4096
s_mov_b32 s11, 0x20000
s_lshl_b32 s62, s43, 8
s_lshl_b32 s63, s61, 7
s_add_u32 s62, s62, s63
v_and_b32 v16, 15, v1
v_lshlrev_b32 v16, 1, v16
buffer_load_ushort v24, v16, s[8:11], s62 offen offset:0
buffer_load_ushort v25, v16, s[8:11], s62 offen offset:32
buffer_load_ushort v26, v16, s[8:11], s62 offen offset:64
buffer_load_ushort v27, v16, s[8:11], s62 offen offset:96
s_lshl_b32 s71, s60, 1
v_and_b32 v2, 15, v1
v_lshrrev_b32 v3, 4, v1
v_lshrrev_b32 v5, 2, v1
v_and_b32 v6, 3, v1
v_lshlrev_b32 v6, 3, v6
v_mul_u32_u24 v7, 448, v5
v_add_u32 v7, v7, v6
v_and_b32 v4, 1, v3
v_lshlrev_b32 v4, 5, v4
s_lshl_b32 s90, s60, 8
v_add_u32 v2, s90, v7
v_add_u32 v8, v2, v4
v_sub_u32 v9, v2, v4
v_add_u32 v9, 32, v9
v_add_u32 v10, v7, v4
v_add_u32 v10, 192, v10
v_sub_u32 v11, v7, v4
v_add_u32 v11, 224, v11
v_and_b32 v4, 7, v5
s_lshl_b32 s90, s61, 2
s_add_u32 s90, s90, s71
v_xor_b32 v4, s90, v4
v_lshlrev_b32 v4, 5, v4
v_lshlrev_b32 v7, 8, v5
v_add_u32 v7, v7, v6
v_add_u32 v7, 28672, v7
v_xor_b32 v2, 0, v4
v_add_u32 v12, v7, v2
v_xor_b32 v2, 32, v4
v_add_u32 v13, v7, v2
v_xor_b32 v2, 64, v4
v_add_u32 v14, v7, v2
v_xor_b32 v2, 96, v4
v_add_u32 v15, v7, v2
v_mov_b32 v128, 0
v_mov_b32 v129, 0
v_mov_b32 v130, 0
v_mov_b32 v131, 0
v_mov_b32 v132, 0
v_mov_b32 v133, 0
v_mov_b32 v134, 0
v_mov_b32 v135, 0
v_mov_b32 v136, 0
v_mov_b32 v137, 0
v_mov_b32 v138, 0
v_mov_b32 v139, 0
v_mov_b32 v140, 0
v_mov_b32 v141, 0
v_mov_b32 v142, 0
v_mov_b32 v143, 0
v_mov_b32 v144, 0
v_mov_b32 v145, 0
v_mov_b32 v146, 0
v_mov_b32 v147, 0
v_mov_b32 v148, 0
v_mov_b32 v149, 0
v_mov_b32 v150, 0
v_mov_b32 v151, 0
v_mov_b32 v152, 0
v_mov_b32 v153, 0
v_mov_b32 v154, 0
v_mov_b32 v155, 0
v_mov_b32 v156, 0
v_mov_b32 v157, 0
v_mov_b32 v158, 0
v_mov_b32 v159, 0
v_mov_b32 v160, 0
v_mov_b32 v161, 0
v_mov_b32 v162, 0
v_mov_b32 v163, 0
v_mov_b32 v164, 0
v_mov_b32 v165, 0
v_mov_b32 v166, 0
v_mov_b32 v167, 0
v_mov_b32 v168, 0
v_mov_b32 v169, 0
v_mov_b32 v170, 0
v_mov_b32 v171, 0
v_mov_b32 v172, 0
v_mov_b32 v173, 0
v_mov_b32 v174, 0
v_mov_b32 v175, 0
v_mov_b32 v176, 0
v_mov_b32 v177, 0
v_mov_b32 v178, 0
v_mov_b32 v179, 0
v_mov_b32 v180, 0
v_mov_b32 v181, 0
v_mov_b32 v182, 0
v_mov_b32 v183, 0
v_mov_b32 v184, 0
v_mov_b32 v185, 0
v_mov_b32 v186, 0
v_mov_b32 v187, 0
v_mov_b32 v188, 0
v_mov_b32 v189, 0
v_mov_b32 v190, 0
v_mov_b32 v191, 0
v_mov_b32 v192, 0
v_mov_b32 v193, 0
v_mov_b32 v194, 0
v_mov_b32 v195, 0
v_mov_b32 v196, 0
v_mov_b32 v197, 0
v_mov_b32 v198, 0
v_mov_b32 v199, 0
v_mov_b32 v200, 0
v_mov_b32 v201, 0
v_mov_b32 v202, 0
v_mov_b32 v203, 0
v_mov_b32 v204, 0
v_mov_b32 v205, 0
v_mov_b32 v206, 0
v_mov_b32 v207, 0
v_mov_b32 v208, 0
v_mov_b32 v209, 0
v_mov_b32 v210, 0
v_mov_b32 v211, 0
v_mov_b32 v212, 0
v_mov_b32 v213, 0
v_mov_b32 v214, 0
v_mov_b32 v215, 0
v_mov_b32 v216, 0
v_mov_b32 v217, 0
v_mov_b32 v218, 0
v_mov_b32 v219, 0
v_mov_b32 v220, 0
v_mov_b32 v221, 0
v_mov_b32 v222, 0
v_mov_b32 v223, 0
v_mov_b32 v224, 0
v_mov_b32 v225, 0
v_mov_b32 v226, 0
v_mov_b32 v227, 0
v_mov_b32 v228, 0
v_mov_b32 v229, 0
v_mov_b32 v230, 0
v_mov_b32 v231, 0
v_mov_b32 v232, 0
v_mov_b32 v233, 0
v_mov_b32 v234, 0
v_mov_b32 v235, 0
v_mov_b32 v236, 0
v_mov_b32 v237, 0
v_mov_b32 v238, 0
v_mov_b32 v239, 0
s_mul_i32 s70, s42, 917504
s_lshl_b32 s72, s61, 13
s_add_u32 s70, s70, s72
s_add_u32 s70, s70, 16777216
s_mul_i32 s72, s41, 7
s_lshl_b32 s73, s60, 2
s_add_u32 s73, s73, s72
s_add_u32 s74, s73, 0
s_lshr_b32 s75, s74, 1
s_lshl_b32 s75, s75, 14
s_and_b32 s74, s74, 1
s_lshl_b32 s74, s74, 10
s_add_u32 s74, s74, s75
s_add_u32 s76, s74, s70
s_add_u32 s74, s73, 1
s_lshr_b32 s75, s74, 1
s_lshl_b32 s75, s75, 14
s_and_b32 s74, s74, 1
s_lshl_b32 s74, s74, 10
s_add_u32 s74, s74, s75
s_add_u32 s77, s74, s70
s_add_u32 s74, s73, 2
s_lshr_b32 s75, s74, 1
s_lshl_b32 s75, s75, 14
s_and_b32 s74, s74, 1
s_lshl_b32 s74, s74, 10
s_add_u32 s74, s74, s75
s_add_u32 s78, s74, s70
s_add_u32 s74, s72, 3
s_lshr_b32 s75, s74, 1
s_lshl_b32 s75, s75, 14
s_and_b32 s74, s74, 1
s_lshl_b32 s74, s74, 10
s_add_u32 s74, s74, s75
s_add_u32 s79, s74, s70
s_xor_b32 s80, s71, 0
s_lshl_b32 s80, s80, 11
s_xor_b32 s81, s71, 1
s_lshl_b32 s81, s81, 11
s_xor_b32 s82, s71, 2
s_lshl_b32 s82, s82, 11
s_xor_b32 s83, s71, 3
s_lshl_b32 s83, s83, 11
v_mov_b32 v28, 0xbdd2d3e8
v_mov_b32 v29, 0xc0135761
v_mov_b32 v30, 1.0
v_mov_b32 v31, 1.0
v_lshlrev_b32 v21, 4, v1
s_mov_b32 s86, 23
s_mov_b32 s87, 3
s_cmp_lg_u32 s32, 3
s_cbranch_scc1 K1_g3c_aok
s_mov_b32 s101, 0x40000
K1_g3c_apoll:
buffer_load_dword v20, v18, s[24:27], s100 offen sc1
s_waitcnt vmcnt(0)
v_cmp_eq_u32 vcc, v20, v19
s_cmp_eq_u64 vcc, 0
s_cbranch_scc1 K1_g3c_aok
s_sleep 1
s_sub_u32 s101, s101, 1
s_cmp_lg_u32 s101, 0
s_cbranch_scc1 K1_g3c_apoll
K1_g3c_aok:
s_barrier
s_mov_b32 s93, 0
s_mov_b32 s95, 45056
s_barrier
ds_read_b64_tr_b16 v[32:33], v8 offset:0
ds_read_b64_tr_b16 v[34:35], v8 offset:7168
ds_read_b64_tr_b16 v[64:65], v12 offset:0
ds_read_b64_tr_b16 v[66:67], v12 offset:4096
ds_read_b64_tr_b16 v[68:69], v13 offset:0
ds_read_b64_tr_b16 v[70:71], v13 offset:4096
ds_read_b64_tr_b16 v[72:73], v14 offset:0
ds_read_b64_tr_b16 v[74:75], v14 offset:4096
ds_read_b64_tr_b16 v[76:77], v15 offset:0
ds_read_b64_tr_b16 v[78:79], v15 offset:4096
ds_read_b64_tr_b16 v[36:37], v9 offset:0
ds_read_b64_tr_b16 v[38:39], v9 offset:7168
ds_read_b64_tr_b16 v[40:41], v8 offset:64
ds_read_b64_tr_b16 v[42:43], v8 offset:7232
ds_read_b64_tr_b16 v[44:45], v9 offset:64
ds_read_b64_tr_b16 v[46:47], v9 offset:7232
ds_read_b64_tr_b16 v[48:49], v8 offset:128
ds_read_b64_tr_b16 v[50:51], v8 offset:7296
ds_read_b64_tr_b16 v[52:53], v9 offset:128
ds_read_b64_tr_b16 v[54:55], v9 offset:7296
ds_read_b64_tr_b16 v[56:57], v10 offset:0
ds_read_b64_tr_b16 v[58:59], v10 offset:7168
ds_read_b64_tr_b16 v[60:61], v11 offset:0
ds_read_b64_tr_b16 v[62:63], v11 offset:7168
s_mov_b32 s92, 31
K1_g3_loop:
s_waitcnt lgkmcnt(0)
v_mfma_f32_16x16x32_bf16 v[128:131], v[32:35], v[64:67], v[128:131]
ds_read_b64_tr_b16 v[80:81], v8 offset:14336
ds_read_b64_tr_b16 v[82:83], v8 offset:21504
v_mfma_f32_16x16x32_bf16 v[132:135], v[32:35], v[68:71], v[132:135]
ds_read_b64_tr_b16 v[112:113], v12 offset:8192
v_mfma_f32_16x16x32_bf16 v[136:139], v[32:35], v[72:75], v[136:139]
ds_read_b64_tr_b16 v[114:115], v12 offset:12288
v_mfma_f32_16x16x32_bf16 v[140:143], v[32:35], v[76:79], v[140:143]
ds_read_b64_tr_b16 v[116:117], v13 offset:8192
v_mfma_f32_16x16x32_bf16 v[156:159], v[36:39], v[76:79], v[156:159]
ds_read_b64_tr_b16 v[118:119], v13 offset:12288
v_mfma_f32_16x16x32_bf16 v[152:155], v[36:39], v[72:75], v[152:155]
ds_read_b64_tr_b16 v[120:121], v14 offset:8192
v_mfma_f32_16x16x32_bf16 v[148:151], v[36:39], v[68:71], v[148:151]
ds_read_b64_tr_b16 v[122:123], v14 offset:12288
v_mfma_f32_16x16x32_bf16 v[144:147], v[36:39], v[64:67], v[144:147]
ds_read_b64_tr_b16 v[124:125], v15 offset:8192
v_mfma_f32_16x16x32_bf16 v[160:163], v[40:43], v[64:67], v[160:163]
ds_read_b64_tr_b16 v[126:127], v15 offset:12288
v_mfma_f32_16x16x32_bf16 v[164:167], v[40:43], v[68:71], v[164:167]
ds_read_b64_tr_b16 v[84:85], v9 offset:14336
v_mfma_f32_16x16x32_bf16 v[168:171], v[40:43], v[72:75], v[168:171]
ds_read_b64_tr_b16 v[86:87], v9 offset:21504
v_mfma_f32_16x16x32_bf16 v[172:175], v[40:43], v[76:79], v[172:175]
ds_read_b64_tr_b16 v[88:89], v8 offset:14400
ds_read_b64_tr_b16 v[90:91], v8 offset:21568
v_mfma_f32_16x16x32_bf16 v[188:191], v[44:47], v[76:79], v[188:191]
ds_read_b64_tr_b16 v[92:93], v9 offset:14400
v_mfma_f32_16x16x32_bf16 v[184:187], v[44:47], v[72:75], v[184:187]
ds_read_b64_tr_b16 v[94:95], v9 offset:21568
v_mfma_f32_16x16x32_bf16 v[180:183], v[44:47], v[68:71], v[180:183]
ds_read_b64_tr_b16 v[96:97], v8 offset:14464
v_mfma_f32_16x16x32_bf16 v[176:179], v[44:47], v[64:67], v[176:179]
ds_read_b64_tr_b16 v[98:99], v8 offset:21632
v_mfma_f32_16x16x32_bf16 v[192:195], v[48:51], v[64:67], v[192:195]
ds_read_b64_tr_b16 v[100:101], v9 offset:14464
v_mfma_f32_16x16x32_bf16 v[196:199], v[48:51], v[68:71], v[196:199]
ds_read_b64_tr_b16 v[102:103], v9 offset:21632
v_mfma_f32_16x16x32_bf16 v[200:203], v[48:51], v[72:75], v[200:203]
ds_read_b64_tr_b16 v[104:105], v10 offset:14336
v_mfma_f32_16x16x32_bf16 v[204:207], v[48:51], v[76:79], v[204:207]
ds_read_b64_tr_b16 v[106:107], v10 offset:21504
v_mfma_f32_16x16x32_bf16 v[220:223], v[52:55], v[76:79], v[220:223]
ds_read_b64_tr_b16 v[108:109], v11 offset:14336
v_mfma_f32_16x16x32_bf16 v[216:219], v[52:55], v[72:75], v[216:219]
ds_read_b64_tr_b16 v[110:111], v11 offset:21504
v_mfma_f32_16x16x32_bf16 v[212:215], v[52:55], v[68:71], v[212:215]
v_mfma_f32_16x16x32_bf16 v[208:211], v[52:55], v[64:67], v[208:211]
v_mfma_f32_16x16x32_bf16 v[224:227], v[56:59], v[64:67], v[224:227]
v_mfma_f32_16x16x32_bf16 v[228:231], v[56:59], v[68:71], v[228:231]
v_mfma_f32_16x16x32_bf16 v[236:239], v[60:63], v[68:71], v[236:239]
v_mfma_f32_16x16x32_bf16 v[232:235], v[60:63], v[64:67], v[232:235]
s_waitcnt lgkmcnt(0)
v_mfma_f32_16x16x32_bf16 v[128:131], v[80:83], v[112:115], v[128:131]
s_add_u32 s93, s93, 1
s_cmp_eq_u32 s93, 3
s_cselect_b32 s94, 4294877184, s95
s_cselect_b32 s93, 0, s93
v_mfma_f32_16x16x32_bf16 v[132:135], v[80:83], v[116:119], v[132:135]
v_add_u32 v8, s94, v8
v_add_u32 v9, s94, v9
v_add_u32 v10, s94, v10
v_add_u32 v11, s94, v11
v_mfma_f32_16x16x32_bf16 v[136:139], v[80:83], v[120:123], v[136:139]
v_add_u32 v12, s94, v12
v_add_u32 v13, s94, v13
v_add_u32 v14, s94, v14
v_add_u32 v15, s94, v15
v_mfma_f32_16x16x32_bf16 v[140:143], v[80:83], v[124:127], v[140:143]
s_barrier
ds_read_b64_tr_b16 v[32:33], v8 offset:0
ds_read_b64_tr_b16 v[34:35], v8 offset:7168
v_mfma_f32_16x16x32_bf16 v[156:159], v[84:87], v[124:127], v[156:159]
ds_read_b64_tr_b16 v[64:65], v12 offset:0
v_mfma_f32_16x16x32_bf16 v[152:155], v[84:87], v[120:123], v[152:155]
ds_read_b64_tr_b16 v[66:67], v12 offset:4096
v_mfma_f32_16x16x32_bf16 v[148:151], v[84:87], v[116:119], v[148:151]
ds_read_b64_tr_b16 v[68:69], v13 offset:0
ds_read_b64_tr_b16 v[70:71], v13 offset:4096
v_mfma_f32_16x16x32_bf16 v[144:147], v[84:87], v[112:115], v[144:147]
ds_read_b64_tr_b16 v[72:73], v14 offset:0
v_mfma_f32_16x16x32_bf16 v[160:163], v[88:91], v[112:115], v[160:163]
ds_read_b64_tr_b16 v[74:75], v14 offset:4096
v_mfma_f32_16x16x32_bf16 v[164:167], v[88:91], v[116:119], v[164:167]
ds_read_b64_tr_b16 v[76:77], v15 offset:0
v_mfma_f32_16x16x32_bf16 v[168:171], v[88:91], v[120:123], v[168:171]
ds_read_b64_tr_b16 v[78:79], v15 offset:4096
ds_read_b64_tr_b16 v[36:37], v9 offset:0
v_mfma_f32_16x16x32_bf16 v[172:175], v[88:91], v[124:127], v[172:175]
ds_read_b64_tr_b16 v[38:39], v9 offset:7168
v_mfma_f32_16x16x32_bf16 v[188:191], v[92:95], v[124:127], v[188:191]
ds_read_b64_tr_b16 v[40:41], v8 offset:64
v_mfma_f32_16x16x32_bf16 v[184:187], v[92:95], v[120:123], v[184:187]
ds_read_b64_tr_b16 v[42:43], v8 offset:7232
v_mfma_f32_16x16x32_bf16 v[180:183], v[92:95], v[116:119], v[180:183]
ds_read_b64_tr_b16 v[44:45], v9 offset:64
ds_read_b64_tr_b16 v[46:47], v9 offset:7232
v_mfma_f32_16x16x32_bf16 v[176:179], v[92:95], v[112:115], v[176:179]
ds_read_b64_tr_b16 v[48:49], v8 offset:128
v_mfma_f32_16x16x32_bf16 v[192:195], v[96:99], v[112:115], v[192:195]
ds_read_b64_tr_b16 v[50:51], v8 offset:7296
v_mfma_f32_16x16x32_bf16 v[196:199], v[96:99], v[116:119], v[196:199]
ds_read_b64_tr_b16 v[52:53], v9 offset:128
v_mfma_f32_16x16x32_bf16 v[200:203], v[96:99], v[120:123], v[200:203]
ds_read_b64_tr_b16 v[54:55], v9 offset:7296
ds_read_b64_tr_b16 v[56:57], v10 offset:0
v_mfma_f32_16x16x32_bf16 v[204:207], v[96:99], v[124:127], v[204:207]
ds_read_b64_tr_b16 v[58:59], v10 offset:7168
v_mfma_f32_16x16x32_bf16 v[220:223], v[100:103], v[124:127], v[220:223]
ds_read_b64_tr_b16 v[60:61], v11 offset:0
v_mfma_f32_16x16x32_bf16 v[216:219], v[100:103], v[120:123], v[216:219]
ds_read_b64_tr_b16 v[62:63], v11 offset:7168
v_mfma_f32_16x16x32_bf16 v[212:215], v[100:103], v[116:119], v[212:215]
v_mfma_f32_16x16x32_bf16 v[208:211], v[100:103], v[112:115], v[208:211]
v_mfma_f32_16x16x32_bf16 v[224:227], v[104:107], v[112:115], v[224:227]
v_mfma_f32_16x16x32_bf16 v[228:231], v[104:107], v[116:119], v[228:231]
v_mfma_f32_16x16x32_bf16 v[236:239], v[108:111], v[116:119], v[236:239]
v_mfma_f32_16x16x32_bf16 v[232:235], v[108:111], v[112:115], v[232:235]
s_sub_u32 s92, s92, 1
s_cmp_lg_u32 s92, 0
s_cbranch_scc1 K1_g3_loop
s_waitcnt lgkmcnt(0)
v_mfma_f32_16x16x32_bf16 v[128:131], v[32:35], v[64:67], v[128:131]
ds_read_b64_tr_b16 v[80:81], v8 offset:14336
ds_read_b64_tr_b16 v[82:83], v8 offset:21504
v_mfma_f32_16x16x32_bf16 v[132:135], v[32:35], v[68:71], v[132:135]
ds_read_b64_tr_b16 v[112:113], v12 offset:8192
v_mfma_f32_16x16x32_bf16 v[136:139], v[32:35], v[72:75], v[136:139]
ds_read_b64_tr_b16 v[114:115], v12 offset:12288
v_mfma_f32_16x16x32_bf16 v[140:143], v[32:35], v[76:79], v[140:143]
ds_read_b64_tr_b16 v[116:117], v13 offset:8192
v_mfma_f32_16x16x32_bf16 v[156:159], v[36:39], v[76:79], v[156:159]
ds_read_b64_tr_b16 v[118:119], v13 offset:12288
v_mfma_f32_16x16x32_bf16 v[152:155], v[36:39], v[72:75], v[152:155]
ds_read_b64_tr_b16 v[120:121], v14 offset:8192
v_mfma_f32_16x16x32_bf16 v[148:151], v[36:39], v[68:71], v[148:151]
ds_read_b64_tr_b16 v[122:123], v14 offset:12288
v_mfma_f32_16x16x32_bf16 v[144:147], v[36:39], v[64:67], v[144:147]
ds_read_b64_tr_b16 v[124:125], v15 offset:8192
v_mfma_f32_16x16x32_bf16 v[160:163], v[40:43], v[64:67], v[160:163]
ds_read_b64_tr_b16 v[126:127], v15 offset:12288
v_mfma_f32_16x16x32_bf16 v[164:167], v[40:43], v[68:71], v[164:167]
ds_read_b64_tr_b16 v[84:85], v9 offset:14336
v_mfma_f32_16x16x32_bf16 v[168:171], v[40:43], v[72:75], v[168:171]
ds_read_b64_tr_b16 v[86:87], v9 offset:21504
v_mfma_f32_16x16x32_bf16 v[172:175], v[40:43], v[76:79], v[172:175]
ds_read_b64_tr_b16 v[88:89], v8 offset:14400
ds_read_b64_tr_b16 v[90:91], v8 offset:21568
v_mfma_f32_16x16x32_bf16 v[188:191], v[44:47], v[76:79], v[188:191]
ds_read_b64_tr_b16 v[92:93], v9 offset:14400
v_mfma_f32_16x16x32_bf16 v[184:187], v[44:47], v[72:75], v[184:187]
ds_read_b64_tr_b16 v[94:95], v9 offset:21568
v_mfma_f32_16x16x32_bf16 v[180:183], v[44:47], v[68:71], v[180:183]
ds_read_b64_tr_b16 v[96:97], v8 offset:14464
v_mfma_f32_16x16x32_bf16 v[176:179], v[44:47], v[64:67], v[176:179]
ds_read_b64_tr_b16 v[98:99], v8 offset:21632
v_mfma_f32_16x16x32_bf16 v[192:195], v[48:51], v[64:67], v[192:195]
ds_read_b64_tr_b16 v[100:101], v9 offset:14464
v_mfma_f32_16x16x32_bf16 v[196:199], v[48:51], v[68:71], v[196:199]
ds_read_b64_tr_b16 v[102:103], v9 offset:21632
v_mfma_f32_16x16x32_bf16 v[200:203], v[48:51], v[72:75], v[200:203]
ds_read_b64_tr_b16 v[104:105], v10 offset:14336
v_mfma_f32_16x16x32_bf16 v[204:207], v[48:51], v[76:79], v[204:207]
ds_read_b64_tr_b16 v[106:107], v10 offset:21504
v_mfma_f32_16x16x32_bf16 v[220:223], v[52:55], v[76:79], v[220:223]
ds_read_b64_tr_b16 v[108:109], v11 offset:14336
v_mfma_f32_16x16x32_bf16 v[216:219], v[52:55], v[72:75], v[216:219]
ds_read_b64_tr_b16 v[110:111], v11 offset:21504
v_mfma_f32_16x16x32_bf16 v[212:215], v[52:55], v[68:71], v[212:215]
v_mfma_f32_16x16x32_bf16 v[208:211], v[52:55], v[64:67], v[208:211]
v_mfma_f32_16x16x32_bf16 v[224:227], v[56:59], v[64:67], v[224:227]
v_mfma_f32_16x16x32_bf16 v[228:231], v[56:59], v[68:71], v[228:231]
v_mfma_f32_16x16x32_bf16 v[236:239], v[60:63], v[68:71], v[236:239]
v_mfma_f32_16x16x32_bf16 v[232:235], v[60:63], v[64:67], v[232:235]
s_waitcnt lgkmcnt(0)
v_mfma_f32_16x16x32_bf16 v[128:131], v[80:83], v[112:115], v[128:131]
v_mfma_f32_16x16x32_bf16 v[132:135], v[80:83], v[116:119], v[132:135]
v_mfma_f32_16x16x32_bf16 v[136:139], v[80:83], v[120:123], v[136:139]
v_mfma_f32_16x16x32_bf16 v[140:143], v[80:83], v[124:127], v[140:143]
s_barrier
v_mfma_f32_16x16x32_bf16 v[156:159], v[84:87], v[124:127], v[156:159]
v_mfma_f32_16x16x32_bf16 v[152:155], v[84:87], v[120:123], v[152:155]
v_mfma_f32_16x16x32_bf16 v[148:151], v[84:87], v[116:119], v[148:151]
v_mfma_f32_16x16x32_bf16 v[144:147], v[84:87], v[112:115], v[144:147]
v_mfma_f32_16x16x32_bf16 v[160:163], v[88:91], v[112:115], v[160:163]
v_mfma_f32_16x16x32_bf16 v[164:167], v[88:91], v[116:119], v[164:167]
v_mfma_f32_16x16x32_bf16 v[168:171], v[88:91], v[120:123], v[168:171]
v_mfma_f32_16x16x32_bf16 v[172:175], v[88:91], v[124:127], v[172:175]
v_mfma_f32_16x16x32_bf16 v[188:191], v[92:95], v[124:127], v[188:191]
v_mfma_f32_16x16x32_bf16 v[184:187], v[92:95], v[120:123], v[184:187]
v_mfma_f32_16x16x32_bf16 v[180:183], v[92:95], v[116:119], v[180:183]
v_mfma_f32_16x16x32_bf16 v[176:179], v[92:95], v[112:115], v[176:179]
v_mfma_f32_16x16x32_bf16 v[192:195], v[96:99], v[112:115], v[192:195]
v_mfma_f32_16x16x32_bf16 v[196:199], v[96:99], v[116:119], v[196:199]
v_mfma_f32_16x16x32_bf16 v[200:203], v[96:99], v[120:123], v[200:203]
v_mfma_f32_16x16x32_bf16 v[204:207], v[96:99], v[124:127], v[204:207]
v_mfma_f32_16x16x32_bf16 v[220:223], v[100:103], v[124:127], v[220:223]
v_mfma_f32_16x16x32_bf16 v[216:219], v[100:103], v[120:123], v[216:219]
v_mfma_f32_16x16x32_bf16 v[212:215], v[100:103], v[116:119], v[212:215]
v_mfma_f32_16x16x32_bf16 v[208:211], v[100:103], v[112:115], v[208:211]
v_mfma_f32_16x16x32_bf16 v[224:227], v[104:107], v[112:115], v[224:227]
v_mfma_f32_16x16x32_bf16 v[228:231], v[104:107], v[116:119], v[228:231]
v_mfma_f32_16x16x32_bf16 v[236:239], v[108:111], v[116:119], v[236:239]
v_mfma_f32_16x16x32_bf16 v[232:235], v[108:111], v[112:115], v[232:235]
s_waitcnt vmcnt(0)
v_lshlrev_b32 v32, 16, v240
v_and_b32 v33, 0xffff0000, v240
v_lshlrev_b32 v34, 16, v241
v_and_b32 v35, 0xffff0000, v241
v_lshlrev_b32 v36, 16, v242
v_and_b32 v37, 0xffff0000, v242
v_lshlrev_b32 v38, 16, v243
v_and_b32 v39, 0xffff0000, v243
v_lshlrev_b32 v40, 16, v244
v_and_b32 v41, 0xffff0000, v244
v_lshlrev_b32 v42, 16, v245
v_and_b32 v43, 0xffff0000, v245
v_lshlrev_b32 v44, 16, v246
v_and_b32 v45, 0xffff0000, v246
v_lshlrev_b32 v46, 16, v247
v_and_b32 v47, 0xffff0000, v247
v_lshlrev_b32 v112, 16, v248
v_and_b32 v113, 0xffff0000, v248
v_lshlrev_b32 v114, 16, v249
v_and_b32 v115, 0xffff0000, v249
v_lshlrev_b32 v116, 16, v250
v_and_b32 v117, 0xffff0000, v250
v_lshlrev_b32 v118, 16, v251
v_and_b32 v119, 0xffff0000, v251
v_lshlrev_b32 v120, 16, v252
v_and_b32 v121, 0xffff0000, v252
v_lshlrev_b32 v122, 16, v253
v_and_b32 v123, 0xffff0000, v253
v_lshlrev_b32 v124, 16, v254
v_and_b32 v125, 0xffff0000, v254
v_lshlrev_b32 v126, 16, v255
v_and_b32 v127, 0xffff0000, v255
v_cvt_pk_bf16_f32 v64, 0, v128
v_cvt_pk_bf16_f32 v65, 0, v129
v_cvt_pk_bf16_f32 v68, 0, v130
v_cvt_pk_bf16_f32 v69, 0, v131
v_cvt_pk_bf16_f32 v72, 0, v144
v_cvt_pk_bf16_f32 v73, 0, v145
v_cvt_pk_bf16_f32 v76, 0, v146
v_cvt_pk_bf16_f32 v77, 0, v147
v_pk_add_f32 v[64:65], v[64:65], v[32:33]
v_pk_add_f32 v[68:69], v[68:69], v[34:35]
v_pk_add_f32 v[72:73], v[72:73], v[36:37]
v_pk_add_f32 v[76:77], v[76:77], v[38:39]
v_cvt_pk_bf16_f32 v64, 0, v64
v_cvt_pk_bf16_f32 v65, 0, v65
v_cvt_pk_bf16_f32 v68, 0, v68
v_cvt_pk_bf16_f32 v69, 0, v69
v_cvt_pk_bf16_f32 v72, 0, v72
v_cvt_pk_bf16_f32 v73, 0, v73
v_cvt_pk_bf16_f32 v76, 0, v76
v_cvt_pk_bf16_f32 v77, 0, v77
v_pk_mul_f32 v[66:67], v[64:65], v[64:65]
v_pk_mul_f32 v[70:71], v[68:69], v[68:69]
v_pk_mul_f32 v[74:75], v[72:73], v[72:73]
v_pk_mul_f32 v[78:79], v[76:77], v[76:77]
v_pk_fma_f32 v[66:67], v[66:67], v[28:29], v[28:29] op_sel:[0,0,1] op_sel_hi:[1,0,1]
v_pk_fma_f32 v[70:71], v[70:71], v[28:29], v[28:29] op_sel:[0,0,1] op_sel_hi:[1,0,1]
v_pk_fma_f32 v[74:75], v[74:75], v[28:29], v[28:29] op_sel:[0,0,1] op_sel_hi:[1,0,1]
v_pk_fma_f32 v[78:79], v[78:79], v[28:29], v[28:29] op_sel:[0,0,1] op_sel_hi:[1,0,1]
v_pk_mul_f32 v[66:67], v[66:67], v[64:65]
v_pk_mul_f32 v[70:71], v[70:71], v[68:69]
v_pk_mul_f32 v[74:75], v[74:75], v[72:73]
v_pk_mul_f32 v[78:79], v[78:79], v[76:77]
v_exp_f32 v66, v66
v_exp_f32 v67, v67
v_exp_f32 v70, v70
v_exp_f32 v71, v71
v_exp_f32 v74, v74
v_exp_f32 v75, v75
v_exp_f32 v78, v78
v_exp_f32 v79, v79
v_pk_add_f32 v[66:67], v[66:67], v[30:31] op_sel:[0,0] op_sel_hi:[1,0]
v_pk_add_f32 v[70:71], v[70:71], v[30:31] op_sel:[0,0] op_sel_hi:[1,0]
v_pk_add_f32 v[74:75], v[74:75], v[30:31] op_sel:[0,0] op_sel_hi:[1,0]
v_pk_add_f32 v[78:79], v[78:79], v[30:31] op_sel:[0,0] op_sel_hi:[1,0]
v_rcp_f32 v66, v66
v_rcp_f32 v67, v67
v_rcp_f32 v70, v70
v_rcp_f32 v71, v71
v_rcp_f32 v74, v74
v_rcp_f32 v75, v75
v_rcp_f32 v78, v78
v_rcp_f32 v79, v79
v_pk_mul_f32 v[64:65], v[64:65], v[66:67]
v_pk_mul_f32 v[68:69], v[68:69], v[70:71]
v_pk_mul_f32 v[72:73], v[72:73], v[74:75]
v_pk_mul_f32 v[76:77], v[76:77], v[78:79]
v_cvt_pk_bf16_f32 v128, v64, v65
v_cvt_pk_bf16_f32 v129, v68, v69
v_cvt_pk_bf16_f32 v130, v72, v73
v_cvt_pk_bf16_f32 v131, v76, v77
s_add_u32 s84, s76, s80
buffer_store_dwordx4 v[128:131], v21, s[24:27], s84 offen sc1
v_cvt_pk_bf16_f32 v80, 0, v132
v_cvt_pk_bf16_f32 v81, 0, v133
v_cvt_pk_bf16_f32 v84, 0, v134
v_cvt_pk_bf16_f32 v85, 0, v135
v_cvt_pk_bf16_f32 v88, 0, v148
v_cvt_pk_bf16_f32 v89, 0, v149
v_cvt_pk_bf16_f32 v92, 0, v150
v_cvt_pk_bf16_f32 v93, 0, v151
v_pk_add_f32 v[80:81], v[80:81], v[32:33]
v_pk_add_f32 v[84:85], v[84:85], v[34:35]
v_pk_add_f32 v[88:89], v[88:89], v[36:37]
v_pk_add_f32 v[92:93], v[92:93], v[38:39]
v_cvt_pk_bf16_f32 v80, 0, v80
v_cvt_pk_bf16_f32 v81, 0, v81
v_cvt_pk_bf16_f32 v84, 0, v84
v_cvt_pk_bf16_f32 v85, 0, v85
v_cvt_pk_bf16_f32 v88, 0, v88
v_cvt_pk_bf16_f32 v89, 0, v89
v_cvt_pk_bf16_f32 v92, 0, v92
v_cvt_pk_bf16_f32 v93, 0, v93
v_pk_mul_f32 v[82:83], v[80:81], v[80:81]
v_pk_mul_f32 v[86:87], v[84:85], v[84:85]
v_pk_mul_f32 v[90:91], v[88:89], v[88:89]
v_pk_mul_f32 v[94:95], v[92:93], v[92:93]
v_pk_fma_f32 v[82:83], v[82:83], v[28:29], v[28:29] op_sel:[0,0,1] op_sel_hi:[1,0,1]
v_pk_fma_f32 v[86:87], v[86:87], v[28:29], v[28:29] op_sel:[0,0,1] op_sel_hi:[1,0,1]
v_pk_fma_f32 v[90:91], v[90:91], v[28:29], v[28:29] op_sel:[0,0,1] op_sel_hi:[1,0,1]
v_pk_fma_f32 v[94:95], v[94:95], v[28:29], v[28:29] op_sel:[0,0,1] op_sel_hi:[1,0,1]
v_pk_mul_f32 v[82:83], v[82:83], v[80:81]
v_pk_mul_f32 v[86:87], v[86:87], v[84:85]
v_pk_mul_f32 v[90:91], v[90:91], v[88:89]
v_pk_mul_f32 v[94:95], v[94:95], v[92:93]
v_exp_f32 v82, v82
v_exp_f32 v83, v83
v_exp_f32 v86, v86
v_exp_f32 v87, v87
v_exp_f32 v90, v90
v_exp_f32 v91, v91
v_exp_f32 v94, v94
v_exp_f32 v95, v95
v_pk_add_f32 v[82:83], v[82:83], v[30:31] op_sel:[0,0] op_sel_hi:[1,0]
v_pk_add_f32 v[86:87], v[86:87], v[30:31] op_sel:[0,0] op_sel_hi:[1,0]
v_pk_add_f32 v[90:91], v[90:91], v[30:31] op_sel:[0,0] op_sel_hi:[1,0]
v_pk_add_f32 v[94:95], v[94:95], v[30:31] op_sel:[0,0] op_sel_hi:[1,0]
v_rcp_f32 v82, v82
v_rcp_f32 v83, v83
v_rcp_f32 v86, v86
v_rcp_f32 v87, v87
v_rcp_f32 v90, v90
v_rcp_f32 v91, v91
v_rcp_f32 v94, v94
v_rcp_f32 v95, v95
v_pk_mul_f32 v[80:81], v[80:81], v[82:83]
v_pk_mul_f32 v[84:85], v[84:85], v[86:87]
v_pk_mul_f32 v[88:89], v[88:89], v[90:91]
v_pk_mul_f32 v[92:93], v[92:93], v[94:95]
v_cvt_pk_bf16_f32 v132, v80, v81
v_cvt_pk_bf16_f32 v133, v84, v85
v_cvt_pk_bf16_f32 v134, v88, v89
v_cvt_pk_bf16_f32 v135, v92, v93
s_add_u32 s84, s76, s81
buffer_store_dwordx4 v[132:135], v21, s[24:27], s84 offen sc1
v_cvt_pk_bf16_f32 v64, 0, v136
v_cvt_pk_bf16_f32 v65, 0, v137
v_cvt_pk_bf16_f32 v68, 0, v138
v_cvt_pk_bf16_f32 v69, 0, v139
v_cvt_pk_bf16_f32 v72, 0, v152
v_cvt_pk_bf16_f32 v73, 0, v153
v_cvt_pk_bf16_f32 v76, 0, v154
v_cvt_pk_bf16_f32 v77, 0, v155
v_pk_add_f32 v[64:65], v[64:65], v[32:33]
v_pk_add_f32 v[68:69], v[68:69], v[34:35]
v_pk_add_f32 v[72:73], v[72:73], v[36:37]
v_pk_add_f32 v[76:77], v[76:77], v[38:39]
v_cvt_pk_bf16_f32 v64, 0, v64
v_cvt_pk_bf16_f32 v65, 0, v65
v_cvt_pk_bf16_f32 v68, 0, v68
v_cvt_pk_bf16_f32 v69, 0, v69
v_cvt_pk_bf16_f32 v72, 0, v72
v_cvt_pk_bf16_f32 v73, 0, v73
v_cvt_pk_bf16_f32 v76, 0, v76
v_cvt_pk_bf16_f32 v77, 0, v77
v_pk_mul_f32 v[66:67], v[64:65], v[64:65]
v_pk_mul_f32 v[70:71], v[68:69], v[68:69]
v_pk_mul_f32 v[74:75], v[72:73], v[72:73]
v_pk_mul_f32 v[78:79], v[76:77], v[76:77]
v_pk_fma_f32 v[66:67], v[66:67], v[28:29], v[28:29] op_sel:[0,0,1] op_sel_hi:[1,0,1]
v_pk_fma_f32 v[70:71], v[70:71], v[28:29], v[28:29] op_sel:[0,0,1] op_sel_hi:[1,0,1]
v_pk_fma_f32 v[74:75], v[74:75], v[28:29], v[28:29] op_sel:[0,0,1] op_sel_hi:[1,0,1]
v_pk_fma_f32 v[78:79], v[78:79], v[28:29], v[28:29] op_sel:[0,0,1] op_sel_hi:[1,0,1]
v_pk_mul_f32 v[66:67], v[66:67], v[64:65]
v_pk_mul_f32 v[70:71], v[70:71], v[68:69]
v_pk_mul_f32 v[74:75], v[74:75], v[72:73]
v_pk_mul_f32 v[78:79], v[78:79], v[76:77]
v_exp_f32 v66, v66
v_exp_f32 v67, v67
v_exp_f32 v70, v70
v_exp_f32 v71, v71
v_exp_f32 v74, v74
v_exp_f32 v75, v75
v_exp_f32 v78, v78
v_exp_f32 v79, v79
v_pk_add_f32 v[66:67], v[66:67], v[30:31] op_sel:[0,0] op_sel_hi:[1,0]
v_pk_add_f32 v[70:71], v[70:71], v[30:31] op_sel:[0,0] op_sel_hi:[1,0]
v_pk_add_f32 v[74:75], v[74:75], v[30:31] op_sel:[0,0] op_sel_hi:[1,0]
v_pk_add_f32 v[78:79], v[78:79], v[30:31] op_sel:[0,0] op_sel_hi:[1,0]
v_rcp_f32 v66, v66
v_rcp_f32 v67, v67
v_rcp_f32 v70, v70
v_rcp_f32 v71, v71
v_rcp_f32 v74, v74
v_rcp_f32 v75, v75
v_rcp_f32 v78, v78
v_rcp_f32 v79, v79
v_pk_mul_f32 v[64:65], v[64:65], v[66:67]
v_pk_mul_f32 v[68:69], v[68:69], v[70:71]
v_pk_mul_f32 v[72:73], v[72:73], v[74:75]
v_pk_mul_f32 v[76:77], v[76:77], v[78:79]
v_cvt_pk_bf16_f32 v136, v64, v65
v_cvt_pk_bf16_f32 v137, v68, v69
v_cvt_pk_bf16_f32 v138, v72, v73
v_cvt_pk_bf16_f32 v139, v76, v77
s_add_u32 s84, s76, s82
buffer_store_dwordx4 v[136:139], v21, s[24:27], s84 offen sc1
v_cvt_pk_bf16_f32 v80, 0, v140
v_cvt_pk_bf16_f32 v81, 0, v141
v_cvt_pk_bf16_f32 v84, 0, v142
v_cvt_pk_bf16_f32 v85, 0, v143
v_cvt_pk_bf16_f32 v88, 0, v156
v_cvt_pk_bf16_f32 v89, 0, v157
v_cvt_pk_bf16_f32 v92, 0, v158
v_cvt_pk_bf16_f32 v93, 0, v159
v_pk_add_f32 v[80:81], v[80:81], v[32:33]
v_pk_add_f32 v[84:85], v[84:85], v[34:35]
v_pk_add_f32 v[88:89], v[88:89], v[36:37]
v_pk_add_f32 v[92:93], v[92:93], v[38:39]
v_cvt_pk_bf16_f32 v80, 0, v80
v_cvt_pk_bf16_f32 v81, 0, v81
v_cvt_pk_bf16_f32 v84, 0, v84
v_cvt_pk_bf16_f32 v85, 0, v85
v_cvt_pk_bf16_f32 v88, 0, v88
v_cvt_pk_bf16_f32 v89, 0, v89
v_cvt_pk_bf16_f32 v92, 0, v92
v_cvt_pk_bf16_f32 v93, 0, v93
v_pk_mul_f32 v[82:83], v[80:81], v[80:81]
v_pk_mul_f32 v[86:87], v[84:85], v[84:85]
v_pk_mul_f32 v[90:91], v[88:89], v[88:89]
v_pk_mul_f32 v[94:95], v[92:93], v[92:93]
v_pk_fma_f32 v[82:83], v[82:83], v[28:29], v[28:29] op_sel:[0,0,1] op_sel_hi:[1,0,1]
v_pk_fma_f32 v[86:87], v[86:87], v[28:29], v[28:29] op_sel:[0,0,1] op_sel_hi:[1,0,1]
v_pk_fma_f32 v[90:91], v[90:91], v[28:29], v[28:29] op_sel:[0,0,1] op_sel_hi:[1,0,1]
v_pk_fma_f32 v[94:95], v[94:95], v[28:29], v[28:29] op_sel:[0,0,1] op_sel_hi:[1,0,1]
v_pk_mul_f32 v[82:83], v[82:83], v[80:81]
v_pk_mul_f32 v[86:87], v[86:87], v[84:85]
v_pk_mul_f32 v[90:91], v[90:91], v[88:89]
v_pk_mul_f32 v[94:95], v[94:95], v[92:93]
v_exp_f32 v82, v82
v_exp_f32 v83, v83
v_exp_f32 v86, v86
v_exp_f32 v87, v87
v_exp_f32 v90, v90
v_exp_f32 v91, v91
v_exp_f32 v94, v94
v_exp_f32 v95, v95
v_pk_add_f32 v[82:83], v[82:83], v[30:31] op_sel:[0,0] op_sel_hi:[1,0]
v_pk_add_f32 v[86:87], v[86:87], v[30:31] op_sel:[0,0] op_sel_hi:[1,0]
v_pk_add_f32 v[90:91], v[90:91], v[30:31] op_sel:[0,0] op_sel_hi:[1,0]
v_pk_add_f32 v[94:95], v[94:95], v[30:31] op_sel:[0,0] op_sel_hi:[1,0]
v_rcp_f32 v82, v82
v_rcp_f32 v83, v83
v_rcp_f32 v86, v86
v_rcp_f32 v87, v87
v_rcp_f32 v90, v90
v_rcp_f32 v91, v91
v_rcp_f32 v94, v94
v_rcp_f32 v95, v95
v_pk_mul_f32 v[80:81], v[80:81], v[82:83]
v_pk_mul_f32 v[84:85], v[84:85], v[86:87]
v_pk_mul_f32 v[88:89], v[88:89], v[90:91]
v_pk_mul_f32 v[92:93], v[92:93], v[94:95]
v_cvt_pk_bf16_f32 v140, v80, v81
v_cvt_pk_bf16_f32 v141, v84, v85
v_cvt_pk_bf16_f32 v142, v88, v89
v_cvt_pk_bf16_f32 v143, v92, v93
s_add_u32 s84, s76, s83
buffer_store_dwordx4 v[140:143], v21, s[24:27], s84 offen sc1
v_cvt_pk_bf16_f32 v64, 0, v160
v_cvt_pk_bf16_f32 v65, 0, v161
v_cvt_pk_bf16_f32 v68, 0, v162
v_cvt_pk_bf16_f32 v69, 0, v163
v_cvt_pk_bf16_f32 v72, 0, v176
v_cvt_pk_bf16_f32 v73, 0, v177
v_cvt_pk_bf16_f32 v76, 0, v178
v_cvt_pk_bf16_f32 v77, 0, v179
v_pk_add_f32 v[64:65], v[64:65], v[40:41]
v_pk_add_f32 v[68:69], v[68:69], v[42:43]
v_pk_add_f32 v[72:73], v[72:73], v[44:45]
v_pk_add_f32 v[76:77], v[76:77], v[46:47]
v_cvt_pk_bf16_f32 v64, 0, v64
v_cvt_pk_bf16_f32 v65, 0, v65
v_cvt_pk_bf16_f32 v68, 0, v68
v_cvt_pk_bf16_f32 v69, 0, v69
v_cvt_pk_bf16_f32 v72, 0, v72
v_cvt_pk_bf16_f32 v73, 0, v73
v_cvt_pk_bf16_f32 v76, 0, v76
v_cvt_pk_bf16_f32 v77, 0, v77
v_pk_mul_f32 v[66:67], v[64:65], v[64:65]
v_pk_mul_f32 v[70:71], v[68:69], v[68:69]
v_pk_mul_f32 v[74:75], v[72:73], v[72:73]
v_pk_mul_f32 v[78:79], v[76:77], v[76:77]
v_pk_fma_f32 v[66:67], v[66:67], v[28:29], v[28:29] op_sel:[0,0,1] op_sel_hi:[1,0,1]
v_pk_fma_f32 v[70:71], v[70:71], v[28:29], v[28:29] op_sel:[0,0,1] op_sel_hi:[1,0,1]
v_pk_fma_f32 v[74:75], v[74:75], v[28:29], v[28:29] op_sel:[0,0,1] op_sel_hi:[1,0,1]
v_pk_fma_f32 v[78:79], v[78:79], v[28:29], v[28:29] op_sel:[0,0,1] op_sel_hi:[1,0,1]
v_pk_mul_f32 v[66:67], v[66:67], v[64:65]
v_pk_mul_f32 v[70:71], v[70:71], v[68:69]
v_pk_mul_f32 v[74:75], v[74:75], v[72:73]
v_pk_mul_f32 v[78:79], v[78:79], v[76:77]
v_exp_f32 v66, v66
v_exp_f32 v67, v67
v_exp_f32 v70, v70
v_exp_f32 v71, v71
v_exp_f32 v74, v74
v_exp_f32 v75, v75
v_exp_f32 v78, v78
v_exp_f32 v79, v79
v_pk_add_f32 v[66:67], v[66:67], v[30:31] op_sel:[0,0] op_sel_hi:[1,0]
v_pk_add_f32 v[70:71], v[70:71], v[30:31] op_sel:[0,0] op_sel_hi:[1,0]
v_pk_add_f32 v[74:75], v[74:75], v[30:31] op_sel:[0,0] op_sel_hi:[1,0]
v_pk_add_f32 v[78:79], v[78:79], v[30:31] op_sel:[0,0] op_sel_hi:[1,0]
v_rcp_f32 v66, v66
v_rcp_f32 v67, v67
v_rcp_f32 v70, v70
v_rcp_f32 v71, v71
v_rcp_f32 v74, v74
v_rcp_f32 v75, v75
v_rcp_f32 v78, v78
v_rcp_f32 v79, v79
v_pk_mul_f32 v[64:65], v[64:65], v[66:67]
v_pk_mul_f32 v[68:69], v[68:69], v[70:71]
v_pk_mul_f32 v[72:73], v[72:73], v[74:75]
v_pk_mul_f32 v[76:77], v[76:77], v[78:79]
v_cvt_pk_bf16_f32 v160, v64, v65
v_cvt_pk_bf16_f32 v161, v68, v69
v_cvt_pk_bf16_f32 v162, v72, v73
v_cvt_pk_bf16_f32 v163, v76, v77
s_add_u32 s84, s77, s80
buffer_store_dwordx4 v[160:163], v21, s[24:27], s84 offen sc1
v_cvt_pk_bf16_f32 v80, 0, v164
v_cvt_pk_bf16_f32 v81, 0, v165
v_cvt_pk_bf16_f32 v84, 0, v166
v_cvt_pk_bf16_f32 v85, 0, v167
v_cvt_pk_bf16_f32 v88, 0, v180
v_cvt_pk_bf16_f32 v89, 0, v181
v_cvt_pk_bf16_f32 v92, 0, v182
v_cvt_pk_bf16_f32 v93, 0, v183
v_pk_add_f32 v[80:81], v[80:81], v[40:41]
v_pk_add_f32 v[84:85], v[84:85], v[42:43]
v_pk_add_f32 v[88:89], v[88:89], v[44:45]
v_pk_add_f32 v[92:93], v[92:93], v[46:47]
v_cvt_pk_bf16_f32 v80, 0, v80
v_cvt_pk_bf16_f32 v81, 0, v81
v_cvt_pk_bf16_f32 v84, 0, v84
v_cvt_pk_bf16_f32 v85, 0, v85
v_cvt_pk_bf16_f32 v88, 0, v88
v_cvt_pk_bf16_f32 v89, 0, v89
v_cvt_pk_bf16_f32 v92, 0, v92
v_cvt_pk_bf16_f32 v93, 0, v93
v_pk_mul_f32 v[82:83], v[80:81], v[80:81]
v_pk_mul_f32 v[86:87], v[84:85], v[84:85]
v_pk_mul_f32 v[90:91], v[88:89], v[88:89]
v_pk_mul_f32 v[94:95], v[92:93], v[92:93]
v_pk_fma_f32 v[82:83], v[82:83], v[28:29], v[28:29] op_sel:[0,0,1] op_sel_hi:[1,0,1]
v_pk_fma_f32 v[86:87], v[86:87], v[28:29], v[28:29] op_sel:[0,0,1] op_sel_hi:[1,0,1]
v_pk_fma_f32 v[90:91], v[90:91], v[28:29], v[28:29] op_sel:[0,0,1] op_sel_hi:[1,0,1]
v_pk_fma_f32 v[94:95], v[94:95], v[28:29], v[28:29] op_sel:[0,0,1] op_sel_hi:[1,0,1]
v_pk_mul_f32 v[82:83], v[82:83], v[80:81]
v_pk_mul_f32 v[86:87], v[86:87], v[84:85]
v_pk_mul_f32 v[90:91], v[90:91], v[88:89]
v_pk_mul_f32 v[94:95], v[94:95], v[92:93]
v_exp_f32 v82, v82
v_exp_f32 v83, v83
v_exp_f32 v86, v86
v_exp_f32 v87, v87
v_exp_f32 v90, v90
v_exp_f32 v91, v91
v_exp_f32 v94, v94
v_exp_f32 v95, v95
v_pk_add_f32 v[82:83], v[82:83], v[30:31] op_sel:[0,0] op_sel_hi:[1,0]
v_pk_add_f32 v[86:87], v[86:87], v[30:31] op_sel:[0,0] op_sel_hi:[1,0]
v_pk_add_f32 v[90:91], v[90:91], v[30:31] op_sel:[0,0] op_sel_hi:[1,0]
v_pk_add_f32 v[94:95], v[94:95], v[30:31] op_sel:[0,0] op_sel_hi:[1,0]
v_rcp_f32 v82, v82
v_rcp_f32 v83, v83
v_rcp_f32 v86, v86
v_rcp_f32 v87, v87
v_rcp_f32 v90, v90
v_rcp_f32 v91, v91
v_rcp_f32 v94, v94
v_rcp_f32 v95, v95
v_pk_mul_f32 v[80:81], v[80:81], v[82:83]
v_pk_mul_f32 v[84:85], v[84:85], v[86:87]
v_pk_mul_f32 v[88:89], v[88:89], v[90:91]
v_pk_mul_f32 v[92:93], v[92:93], v[94:95]
v_cvt_pk_bf16_f32 v164, v80, v81
v_cvt_pk_bf16_f32 v165, v84, v85
v_cvt_pk_bf16_f32 v166, v88, v89
v_cvt_pk_bf16_f32 v167, v92, v93
s_add_u32 s84, s77, s81
buffer_store_dwordx4 v[164:167], v21, s[24:27], s84 offen sc1
v_cvt_pk_bf16_f32 v64, 0, v168
v_cvt_pk_bf16_f32 v65, 0, v169
v_cvt_pk_bf16_f32 v68, 0, v170
v_cvt_pk_bf16_f32 v69, 0, v171
v_cvt_pk_bf16_f32 v72, 0, v184
v_cvt_pk_bf16_f32 v73, 0, v185
v_cvt_pk_bf16_f32 v76, 0, v186
v_cvt_pk_bf16_f32 v77, 0, v187
v_pk_add_f32 v[64:65], v[64:65], v[40:41]
v_pk_add_f32 v[68:69], v[68:69], v[42:43]
v_pk_add_f32 v[72:73], v[72:73], v[44:45]
v_pk_add_f32 v[76:77], v[76:77], v[46:47]
v_cvt_pk_bf16_f32 v64, 0, v64
v_cvt_pk_bf16_f32 v65, 0, v65
v_cvt_pk_bf16_f32 v68, 0, v68
v_cvt_pk_bf16_f32 v69, 0, v69
v_cvt_pk_bf16_f32 v72, 0, v72
v_cvt_pk_bf16_f32 v73, 0, v73
v_cvt_pk_bf16_f32 v76, 0, v76
v_cvt_pk_bf16_f32 v77, 0, v77
v_pk_mul_f32 v[66:67], v[64:65], v[64:65]
v_pk_mul_f32 v[70:71], v[68:69], v[68:69]
v_pk_mul_f32 v[74:75], v[72:73], v[72:73]
v_pk_mul_f32 v[78:79], v[76:77], v[76:77]
v_pk_fma_f32 v[66:67], v[66:67], v[28:29], v[28:29] op_sel:[0,0,1] op_sel_hi:[1,0,1]
v_pk_fma_f32 v[70:71], v[70:71], v[28:29], v[28:29] op_sel:[0,0,1] op_sel_hi:[1,0,1]
v_pk_fma_f32 v[74:75], v[74:75], v[28:29], v[28:29] op_sel:[0,0,1] op_sel_hi:[1,0,1]
v_pk_fma_f32 v[78:79], v[78:79], v[28:29], v[28:29] op_sel:[0,0,1] op_sel_hi:[1,0,1]
v_pk_mul_f32 v[66:67], v[66:67], v[64:65]
v_pk_mul_f32 v[70:71], v[70:71], v[68:69]
v_pk_mul_f32 v[74:75], v[74:75], v[72:73]
v_pk_mul_f32 v[78:79], v[78:79], v[76:77]
v_exp_f32 v66, v66
v_exp_f32 v67, v67
v_exp_f32 v70, v70
v_exp_f32 v71, v71
v_exp_f32 v74, v74
v_exp_f32 v75, v75
v_exp_f32 v78, v78
v_exp_f32 v79, v79
v_pk_add_f32 v[66:67], v[66:67], v[30:31] op_sel:[0,0] op_sel_hi:[1,0]
v_pk_add_f32 v[70:71], v[70:71], v[30:31] op_sel:[0,0] op_sel_hi:[1,0]
v_pk_add_f32 v[74:75], v[74:75], v[30:31] op_sel:[0,0] op_sel_hi:[1,0]
v_pk_add_f32 v[78:79], v[78:79], v[30:31] op_sel:[0,0] op_sel_hi:[1,0]
v_rcp_f32 v66, v66
v_rcp_f32 v67, v67
v_rcp_f32 v70, v70
v_rcp_f32 v71, v71
v_rcp_f32 v74, v74
v_rcp_f32 v75, v75
v_rcp_f32 v78, v78
v_rcp_f32 v79, v79
v_pk_mul_f32 v[64:65], v[64:65], v[66:67]
v_pk_mul_f32 v[68:69], v[68:69], v[70:71]
v_pk_mul_f32 v[72:73], v[72:73], v[74:75]
v_pk_mul_f32 v[76:77], v[76:77], v[78:79]
v_cvt_pk_bf16_f32 v168, v64, v65
v_cvt_pk_bf16_f32 v169, v68, v69
v_cvt_pk_bf16_f32 v170, v72, v73
v_cvt_pk_bf16_f32 v171, v76, v77
s_add_u32 s84, s77, s82
buffer_store_dwordx4 v[168:171], v21, s[24:27], s84 offen sc1
v_cvt_pk_bf16_f32 v80, 0, v172
v_cvt_pk_bf16_f32 v81, 0, v173
v_cvt_pk_bf16_f32 v84, 0, v174
v_cvt_pk_bf16_f32 v85, 0, v175
v_cvt_pk_bf16_f32 v88, 0, v188
v_cvt_pk_bf16_f32 v89, 0, v189
v_cvt_pk_bf16_f32 v92, 0, v190
v_cvt_pk_bf16_f32 v93, 0, v191
v_pk_add_f32 v[80:81], v[80:81], v[40:41]
v_pk_add_f32 v[84:85], v[84:85], v[42:43]
v_pk_add_f32 v[88:89], v[88:89], v[44:45]
v_pk_add_f32 v[92:93], v[92:93], v[46:47]
v_cvt_pk_bf16_f32 v80, 0, v80
v_cvt_pk_bf16_f32 v81, 0, v81
v_cvt_pk_bf16_f32 v84, 0, v84
v_cvt_pk_bf16_f32 v85, 0, v85
v_cvt_pk_bf16_f32 v88, 0, v88
v_cvt_pk_bf16_f32 v89, 0, v89
v_cvt_pk_bf16_f32 v92, 0, v92
v_cvt_pk_bf16_f32 v93, 0, v93
v_pk_mul_f32 v[82:83], v[80:81], v[80:81]
v_pk_mul_f32 v[86:87], v[84:85], v[84:85]
v_pk_mul_f32 v[90:91], v[88:89], v[88:89]
v_pk_mul_f32 v[94:95], v[92:93], v[92:93]
v_pk_fma_f32 v[82:83], v[82:83], v[28:29], v[28:29] op_sel:[0,0,1] op_sel_hi:[1,0,1]
v_pk_fma_f32 v[86:87], v[86:87], v[28:29], v[28:29] op_sel:[0,0,1] op_sel_hi:[1,0,1]
v_pk_fma_f32 v[90:91], v[90:91], v[28:29], v[28:29] op_sel:[0,0,1] op_sel_hi:[1,0,1]
v_pk_fma_f32 v[94:95], v[94:95], v[28:29], v[28:29] op_sel:[0,0,1] op_sel_hi:[1,0,1]
v_pk_mul_f32 v[82:83], v[82:83], v[80:81]
v_pk_mul_f32 v[86:87], v[86:87], v[84:85]
v_pk_mul_f32 v[90:91], v[90:91], v[88:89]
v_pk_mul_f32 v[94:95], v[94:95], v[92:93]
v_exp_f32 v82, v82
v_exp_f32 v83, v83
v_exp_f32 v86, v86
v_exp_f32 v87, v87
v_exp_f32 v90, v90
v_exp_f32 v91, v91
v_exp_f32 v94, v94
v_exp_f32 v95, v95
v_pk_add_f32 v[82:83], v[82:83], v[30:31] op_sel:[0,0] op_sel_hi:[1,0]
v_pk_add_f32 v[86:87], v[86:87], v[30:31] op_sel:[0,0] op_sel_hi:[1,0]
v_pk_add_f32 v[90:91], v[90:91], v[30:31] op_sel:[0,0] op_sel_hi:[1,0]
v_pk_add_f32 v[94:95], v[94:95], v[30:31] op_sel:[0,0] op_sel_hi:[1,0]
v_rcp_f32 v82, v82
v_rcp_f32 v83, v83
v_rcp_f32 v86, v86
v_rcp_f32 v87, v87
v_rcp_f32 v90, v90
v_rcp_f32 v91, v91
v_rcp_f32 v94, v94
v_rcp_f32 v95, v95
v_pk_mul_f32 v[80:81], v[80:81], v[82:83]
v_pk_mul_f32 v[84:85], v[84:85], v[86:87]
v_pk_mul_f32 v[88:89], v[88:89], v[90:91]
v_pk_mul_f32 v[92:93], v[92:93], v[94:95]
v_cvt_pk_bf16_f32 v172, v80, v81
v_cvt_pk_bf16_f32 v173, v84, v85
v_cvt_pk_bf16_f32 v174, v88, v89
v_cvt_pk_bf16_f32 v175, v92, v93
s_add_u32 s84, s77, s83
buffer_store_dwordx4 v[172:175], v21, s[24:27], s84 offen sc1
v_cvt_pk_bf16_f32 v64, 0, v192
v_cvt_pk_bf16_f32 v65, 0, v193
v_cvt_pk_bf16_f32 v68, 0, v194
v_cvt_pk_bf16_f32 v69, 0, v195
v_cvt_pk_bf16_f32 v72, 0, v208
v_cvt_pk_bf16_f32 v73, 0, v209
v_cvt_pk_bf16_f32 v76, 0, v210
v_cvt_pk_bf16_f32 v77, 0, v211
v_pk_add_f32 v[64:65], v[64:65], v[112:113]
v_pk_add_f32 v[68:69], v[68:69], v[114:115]
v_pk_add_f32 v[72:73], v[72:73], v[116:117]
v_pk_add_f32 v[76:77], v[76:77], v[118:119]
v_cvt_pk_bf16_f32 v64, 0, v64
v_cvt_pk_bf16_f32 v65, 0, v65
v_cvt_pk_bf16_f32 v68, 0, v68
v_cvt_pk_bf16_f32 v69, 0, v69
v_cvt_pk_bf16_f32 v72, 0, v72
v_cvt_pk_bf16_f32 v73, 0, v73
v_cvt_pk_bf16_f32 v76, 0, v76
v_cvt_pk_bf16_f32 v77, 0, v77
v_pk_mul_f32 v[66:67], v[64:65], v[64:65]
v_pk_mul_f32 v[70:71], v[68:69], v[68:69]
v_pk_mul_f32 v[74:75], v[72:73], v[72:73]
v_pk_mul_f32 v[78:79], v[76:77], v[76:77]
v_pk_fma_f32 v[66:67], v[66:67], v[28:29], v[28:29] op_sel:[0,0,1] op_sel_hi:[1,0,1]
v_pk_fma_f32 v[70:71], v[70:71], v[28:29], v[28:29] op_sel:[0,0,1] op_sel_hi:[1,0,1]
v_pk_fma_f32 v[74:75], v[74:75], v[28:29], v[28:29] op_sel:[0,0,1] op_sel_hi:[1,0,1]
v_pk_fma_f32 v[78:79], v[78:79], v[28:29], v[28:29] op_sel:[0,0,1] op_sel_hi:[1,0,1]
v_pk_mul_f32 v[66:67], v[66:67], v[64:65]
v_pk_mul_f32 v[70:71], v[70:71], v[68:69]
v_pk_mul_f32 v[74:75], v[74:75], v[72:73]
v_pk_mul_f32 v[78:79], v[78:79], v[76:77]
v_exp_f32 v66, v66
v_exp_f32 v67, v67
v_exp_f32 v70, v70
v_exp_f32 v71, v71
v_exp_f32 v74, v74
v_exp_f32 v75, v75
v_exp_f32 v78, v78
v_exp_f32 v79, v79
v_pk_add_f32 v[66:67], v[66:67], v[30:31] op_sel:[0,0] op_sel_hi:[1,0]
v_pk_add_f32 v[70:71], v[70:71], v[30:31] op_sel:[0,0] op_sel_hi:[1,0]
v_pk_add_f32 v[74:75], v[74:75], v[30:31] op_sel:[0,0] op_sel_hi:[1,0]
v_pk_add_f32 v[78:79], v[78:79], v[30:31] op_sel:[0,0] op_sel_hi:[1,0]
v_rcp_f32 v66, v66
v_rcp_f32 v67, v67
v_rcp_f32 v70, v70
v_rcp_f32 v71, v71
v_rcp_f32 v74, v74
v_rcp_f32 v75, v75
v_rcp_f32 v78, v78
v_rcp_f32 v79, v79
v_pk_mul_f32 v[64:65], v[64:65], v[66:67]
v_pk_mul_f32 v[68:69], v[68:69], v[70:71]
v_pk_mul_f32 v[72:73], v[72:73], v[74:75]
v_pk_mul_f32 v[76:77], v[76:77], v[78:79]
v_cvt_pk_bf16_f32 v192, v64, v65
v_cvt_pk_bf16_f32 v193, v68, v69
v_cvt_pk_bf16_f32 v194, v72, v73
v_cvt_pk_bf16_f32 v195, v76, v77
s_add_u32 s84, s78, s80
buffer_store_dwordx4 v[192:195], v21, s[24:27], s84 offen sc1
v_cvt_pk_bf16_f32 v80, 0, v196
v_cvt_pk_bf16_f32 v81, 0, v197
v_cvt_pk_bf16_f32 v84, 0, v198
v_cvt_pk_bf16_f32 v85, 0, v199
v_cvt_pk_bf16_f32 v88, 0, v212
v_cvt_pk_bf16_f32 v89, 0, v213
v_cvt_pk_bf16_f32 v92, 0, v214
v_cvt_pk_bf16_f32 v93, 0, v215
v_pk_add_f32 v[80:81], v[80:81], v[112:113]
v_pk_add_f32 v[84:85], v[84:85], v[114:115]
v_pk_add_f32 v[88:89], v[88:89], v[116:117]
v_pk_add_f32 v[92:93], v[92:93], v[118:119]
v_cvt_pk_bf16_f32 v80, 0, v80
v_cvt_pk_bf16_f32 v81, 0, v81
v_cvt_pk_bf16_f32 v84, 0, v84
v_cvt_pk_bf16_f32 v85, 0, v85
v_cvt_pk_bf16_f32 v88, 0, v88
v_cvt_pk_bf16_f32 v89, 0, v89
v_cvt_pk_bf16_f32 v92, 0, v92
v_cvt_pk_bf16_f32 v93, 0, v93
v_pk_mul_f32 v[82:83], v[80:81], v[80:81]
v_pk_mul_f32 v[86:87], v[84:85], v[84:85]
v_pk_mul_f32 v[90:91], v[88:89], v[88:89]
v_pk_mul_f32 v[94:95], v[92:93], v[92:93]
v_pk_fma_f32 v[82:83], v[82:83], v[28:29], v[28:29] op_sel:[0,0,1] op_sel_hi:[1,0,1]
v_pk_fma_f32 v[86:87], v[86:87], v[28:29], v[28:29] op_sel:[0,0,1] op_sel_hi:[1,0,1]
v_pk_fma_f32 v[90:91], v[90:91], v[28:29], v[28:29] op_sel:[0,0,1] op_sel_hi:[1,0,1]
v_pk_fma_f32 v[94:95], v[94:95], v[28:29], v[28:29] op_sel:[0,0,1] op_sel_hi:[1,0,1]
v_pk_mul_f32 v[82:83], v[82:83], v[80:81]
v_pk_mul_f32 v[86:87], v[86:87], v[84:85]
v_pk_mul_f32 v[90:91], v[90:91], v[88:89]
v_pk_mul_f32 v[94:95], v[94:95], v[92:93]
v_exp_f32 v82, v82
v_exp_f32 v83, v83
v_exp_f32 v86, v86
v_exp_f32 v87, v87
v_exp_f32 v90, v90
v_exp_f32 v91, v91
v_exp_f32 v94, v94
v_exp_f32 v95, v95
v_pk_add_f32 v[82:83], v[82:83], v[30:31] op_sel:[0,0] op_sel_hi:[1,0]
v_pk_add_f32 v[86:87], v[86:87], v[30:31] op_sel:[0,0] op_sel_hi:[1,0]
v_pk_add_f32 v[90:91], v[90:91], v[30:31] op_sel:[0,0] op_sel_hi:[1,0]
v_pk_add_f32 v[94:95], v[94:95], v[30:31] op_sel:[0,0] op_sel_hi:[1,0]
v_rcp_f32 v82, v82
v_rcp_f32 v83, v83
v_rcp_f32 v86, v86
v_rcp_f32 v87, v87
v_rcp_f32 v90, v90
v_rcp_f32 v91, v91
v_rcp_f32 v94, v94
v_rcp_f32 v95, v95
v_pk_mul_f32 v[80:81], v[80:81], v[82:83]
v_pk_mul_f32 v[84:85], v[84:85], v[86:87]
v_pk_mul_f32 v[88:89], v[88:89], v[90:91]
v_pk_mul_f32 v[92:93], v[92:93], v[94:95]
v_cvt_pk_bf16_f32 v196, v80, v81
v_cvt_pk_bf16_f32 v197, v84, v85
v_cvt_pk_bf16_f32 v198, v88, v89
v_cvt_pk_bf16_f32 v199, v92, v93
s_add_u32 s84, s78, s81
buffer_store_dwordx4 v[196:199], v21, s[24:27], s84 offen sc1
v_cvt_pk_bf16_f32 v64, 0, v200
v_cvt_pk_bf16_f32 v65, 0, v201
v_cvt_pk_bf16_f32 v68, 0, v202
v_cvt_pk_bf16_f32 v69, 0, v203
v_cvt_pk_bf16_f32 v72, 0, v216
v_cvt_pk_bf16_f32 v73, 0, v217
v_cvt_pk_bf16_f32 v76, 0, v218
v_cvt_pk_bf16_f32 v77, 0, v219
v_pk_add_f32 v[64:65], v[64:65], v[112:113]
v_pk_add_f32 v[68:69], v[68:69], v[114:115]
v_pk_add_f32 v[72:73], v[72:73], v[116:117]
v_pk_add_f32 v[76:77], v[76:77], v[118:119]
v_cvt_pk_bf16_f32 v64, 0, v64
v_cvt_pk_bf16_f32 v65, 0, v65
v_cvt_pk_bf16_f32 v68, 0, v68
v_cvt_pk_bf16_f32 v69, 0, v69
v_cvt_pk_bf16_f32 v72, 0, v72
v_cvt_pk_bf16_f32 v73, 0, v73
v_cvt_pk_bf16_f32 v76, 0, v76
v_cvt_pk_bf16_f32 v77, 0, v77
v_pk_mul_f32 v[66:67], v[64:65], v[64:65]
v_pk_mul_f32 v[70:71], v[68:69], v[68:69]
v_pk_mul_f32 v[74:75], v[72:73], v[72:73]
v_pk_mul_f32 v[78:79], v[76:77], v[76:77]
v_pk_fma_f32 v[66:67], v[66:67], v[28:29], v[28:29] op_sel:[0,0,1] op_sel_hi:[1,0,1]
v_pk_fma_f32 v[70:71], v[70:71], v[28:29], v[28:29] op_sel:[0,0,1] op_sel_hi:[1,0,1]
v_pk_fma_f32 v[74:75], v[74:75], v[28:29], v[28:29] op_sel:[0,0,1] op_sel_hi:[1,0,1]
v_pk_fma_f32 v[78:79], v[78:79], v[28:29], v[28:29] op_sel:[0,0,1] op_sel_hi:[1,0,1]
v_pk_mul_f32 v[66:67], v[66:67], v[64:65]
v_pk_mul_f32 v[70:71], v[70:71], v[68:69]
v_pk_mul_f32 v[74:75], v[74:75], v[72:73]
v_pk_mul_f32 v[78:79], v[78:79], v[76:77]
v_exp_f32 v66, v66
v_exp_f32 v67, v67
v_exp_f32 v70, v70
v_exp_f32 v71, v71
v_exp_f32 v74, v74
v_exp_f32 v75, v75
v_exp_f32 v78, v78
v_exp_f32 v79, v79
v_pk_add_f32 v[66:67], v[66:67], v[30:31] op_sel:[0,0] op_sel_hi:[1,0]
v_pk_add_f32 v[70:71], v[70:71], v[30:31] op_sel:[0,0] op_sel_hi:[1,0]
v_pk_add_f32 v[74:75], v[74:75], v[30:31] op_sel:[0,0] op_sel_hi:[1,0]
v_pk_add_f32 v[78:79], v[78:79], v[30:31] op_sel:[0,0] op_sel_hi:[1,0]
v_rcp_f32 v66, v66
v_rcp_f32 v67, v67
v_rcp_f32 v70, v70
v_rcp_f32 v71, v71
v_rcp_f32 v74, v74
v_rcp_f32 v75, v75
v_rcp_f32 v78, v78
v_rcp_f32 v79, v79
v_pk_mul_f32 v[64:65], v[64:65], v[66:67]
v_pk_mul_f32 v[68:69], v[68:69], v[70:71]
v_pk_mul_f32 v[72:73], v[72:73], v[74:75]
v_pk_mul_f32 v[76:77], v[76:77], v[78:79]
v_cvt_pk_bf16_f32 v200, v64, v65
v_cvt_pk_bf16_f32 v201, v68, v69
v_cvt_pk_bf16_f32 v202, v72, v73
v_cvt_pk_bf16_f32 v203, v76, v77
s_add_u32 s84, s78, s82
buffer_store_dwordx4 v[200:203], v21, s[24:27], s84 offen sc1
v_cvt_pk_bf16_f32 v80, 0, v204
v_cvt_pk_bf16_f32 v81, 0, v205
v_cvt_pk_bf16_f32 v84, 0, v206
v_cvt_pk_bf16_f32 v85, 0, v207
v_cvt_pk_bf16_f32 v88, 0, v220
v_cvt_pk_bf16_f32 v89, 0, v221
v_cvt_pk_bf16_f32 v92, 0, v222
v_cvt_pk_bf16_f32 v93, 0, v223
v_pk_add_f32 v[80:81], v[80:81], v[112:113]
v_pk_add_f32 v[84:85], v[84:85], v[114:115]
v_pk_add_f32 v[88:89], v[88:89], v[116:117]
v_pk_add_f32 v[92:93], v[92:93], v[118:119]
v_cvt_pk_bf16_f32 v80, 0, v80
v_cvt_pk_bf16_f32 v81, 0, v81
v_cvt_pk_bf16_f32 v84, 0, v84
v_cvt_pk_bf16_f32 v85, 0, v85
v_cvt_pk_bf16_f32 v88, 0, v88
v_cvt_pk_bf16_f32 v89, 0, v89
v_cvt_pk_bf16_f32 v92, 0, v92
v_cvt_pk_bf16_f32 v93, 0, v93
v_pk_mul_f32 v[82:83], v[80:81], v[80:81]
v_pk_mul_f32 v[86:87], v[84:85], v[84:85]
v_pk_mul_f32 v[90:91], v[88:89], v[88:89]
v_pk_mul_f32 v[94:95], v[92:93], v[92:93]
v_pk_fma_f32 v[82:83], v[82:83], v[28:29], v[28:29] op_sel:[0,0,1] op_sel_hi:[1,0,1]
v_pk_fma_f32 v[86:87], v[86:87], v[28:29], v[28:29] op_sel:[0,0,1] op_sel_hi:[1,0,1]
v_pk_fma_f32 v[90:91], v[90:91], v[28:29], v[28:29] op_sel:[0,0,1] op_sel_hi:[1,0,1]
v_pk_fma_f32 v[94:95], v[94:95], v[28:29], v[28:29] op_sel:[0,0,1] op_sel_hi:[1,0,1]
v_pk_mul_f32 v[82:83], v[82:83], v[80:81]
v_pk_mul_f32 v[86:87], v[86:87], v[84:85]
v_pk_mul_f32 v[90:91], v[90:91], v[88:89]
v_pk_mul_f32 v[94:95], v[94:95], v[92:93]
v_exp_f32 v82, v82
v_exp_f32 v83, v83
v_exp_f32 v86, v86
v_exp_f32 v87, v87
v_exp_f32 v90, v90
v_exp_f32 v91, v91
v_exp_f32 v94, v94
v_exp_f32 v95, v95
v_pk_add_f32 v[82:83], v[82:83], v[30:31] op_sel:[0,0] op_sel_hi:[1,0]
v_pk_add_f32 v[86:87], v[86:87], v[30:31] op_sel:[0,0] op_sel_hi:[1,0]
v_pk_add_f32 v[90:91], v[90:91], v[30:31] op_sel:[0,0] op_sel_hi:[1,0]
v_pk_add_f32 v[94:95], v[94:95], v[30:31] op_sel:[0,0] op_sel_hi:[1,0]
v_rcp_f32 v82, v82
v_rcp_f32 v83, v83
v_rcp_f32 v86, v86
v_rcp_f32 v87, v87
v_rcp_f32 v90, v90
v_rcp_f32 v91, v91
v_rcp_f32 v94, v94
v_rcp_f32 v95, v95
v_pk_mul_f32 v[80:81], v[80:81], v[82:83]
v_pk_mul_f32 v[84:85], v[84:85], v[86:87]
v_pk_mul_f32 v[88:89], v[88:89], v[90:91]
v_pk_mul_f32 v[92:93], v[92:93], v[94:95]
v_cvt_pk_bf16_f32 v204, v80, v81
v_cvt_pk_bf16_f32 v205, v84, v85
v_cvt_pk_bf16_f32 v206, v88, v89
v_cvt_pk_bf16_f32 v207, v92, v93
s_add_u32 s84, s78, s83
buffer_store_dwordx4 v[204:207], v21, s[24:27], s84 offen sc1
v_cvt_pk_bf16_f32 v64, 0, v224
v_cvt_pk_bf16_f32 v65, 0, v225
v_cvt_pk_bf16_f32 v68, 0, v226
v_cvt_pk_bf16_f32 v69, 0, v227
v_cvt_pk_bf16_f32 v72, 0, v232
v_cvt_pk_bf16_f32 v73, 0, v233
v_cvt_pk_bf16_f32 v76, 0, v234
v_cvt_pk_bf16_f32 v77, 0, v235
v_pk_add_f32 v[64:65], v[64:65], v[120:121]
v_pk_add_f32 v[68:69], v[68:69], v[122:123]
v_pk_add_f32 v[72:73], v[72:73], v[124:125]
v_pk_add_f32 v[76:77], v[76:77], v[126:127]
v_cvt_pk_bf16_f32 v64, 0, v64
v_cvt_pk_bf16_f32 v65, 0, v65
v_cvt_pk_bf16_f32 v68, 0, v68
v_cvt_pk_bf16_f32 v69, 0, v69
v_cvt_pk_bf16_f32 v72, 0, v72
v_cvt_pk_bf16_f32 v73, 0, v73
v_cvt_pk_bf16_f32 v76, 0, v76
v_cvt_pk_bf16_f32 v77, 0, v77
v_pk_mul_f32 v[66:67], v[64:65], v[64:65]
v_pk_mul_f32 v[70:71], v[68:69], v[68:69]
v_pk_mul_f32 v[74:75], v[72:73], v[72:73]
v_pk_mul_f32 v[78:79], v[76:77], v[76:77]
v_pk_fma_f32 v[66:67], v[66:67], v[28:29], v[28:29] op_sel:[0,0,1] op_sel_hi:[1,0,1]
v_pk_fma_f32 v[70:71], v[70:71], v[28:29], v[28:29] op_sel:[0,0,1] op_sel_hi:[1,0,1]
v_pk_fma_f32 v[74:75], v[74:75], v[28:29], v[28:29] op_sel:[0,0,1] op_sel_hi:[1,0,1]
v_pk_fma_f32 v[78:79], v[78:79], v[28:29], v[28:29] op_sel:[0,0,1] op_sel_hi:[1,0,1]
v_pk_mul_f32 v[66:67], v[66:67], v[64:65]
v_pk_mul_f32 v[70:71], v[70:71], v[68:69]
v_pk_mul_f32 v[74:75], v[74:75], v[72:73]
v_pk_mul_f32 v[78:79], v[78:79], v[76:77]
v_exp_f32 v66, v66
v_exp_f32 v67, v67
v_exp_f32 v70, v70
v_exp_f32 v71, v71
v_exp_f32 v74, v74
v_exp_f32 v75, v75
v_exp_f32 v78, v78
v_exp_f32 v79, v79
v_pk_add_f32 v[66:67], v[66:67], v[30:31] op_sel:[0,0] op_sel_hi:[1,0]
v_pk_add_f32 v[70:71], v[70:71], v[30:31] op_sel:[0,0] op_sel_hi:[1,0]
v_pk_add_f32 v[74:75], v[74:75], v[30:31] op_sel:[0,0] op_sel_hi:[1,0]
v_pk_add_f32 v[78:79], v[78:79], v[30:31] op_sel:[0,0] op_sel_hi:[1,0]
v_rcp_f32 v66, v66
v_rcp_f32 v67, v67
v_rcp_f32 v70, v70
v_rcp_f32 v71, v71
v_rcp_f32 v74, v74
v_rcp_f32 v75, v75
v_rcp_f32 v78, v78
v_rcp_f32 v79, v79
v_pk_mul_f32 v[64:65], v[64:65], v[66:67]
v_pk_mul_f32 v[68:69], v[68:69], v[70:71]
v_pk_mul_f32 v[72:73], v[72:73], v[74:75]
v_pk_mul_f32 v[76:77], v[76:77], v[78:79]
v_cvt_pk_bf16_f32 v224, v64, v65
v_cvt_pk_bf16_f32 v225, v68, v69
v_cvt_pk_bf16_f32 v226, v72, v73
v_cvt_pk_bf16_f32 v227, v76, v77
s_add_u32 s84, s79, s80
buffer_store_dwordx4 v[224:227], v21, s[24:27], s84 offen sc1
v_cvt_pk_bf16_f32 v80, 0, v228
v_cvt_pk_bf16_f32 v81, 0, v229
v_cvt_pk_bf16_f32 v84, 0, v230
v_cvt_pk_bf16_f32 v85, 0, v231
v_cvt_pk_bf16_f32 v88, 0, v236
v_cvt_pk_bf16_f32 v89, 0, v237
v_cvt_pk_bf16_f32 v92, 0, v238
v_cvt_pk_bf16_f32 v93, 0, v239
v_pk_add_f32 v[80:81], v[80:81], v[120:121]
v_pk_add_f32 v[84:85], v[84:85], v[122:123]
v_pk_add_f32 v[88:89], v[88:89], v[124:125]
v_pk_add_f32 v[92:93], v[92:93], v[126:127]
v_cvt_pk_bf16_f32 v80, 0, v80
v_cvt_pk_bf16_f32 v81, 0, v81
v_cvt_pk_bf16_f32 v84, 0, v84
v_cvt_pk_bf16_f32 v85, 0, v85
v_cvt_pk_bf16_f32 v88, 0, v88
v_cvt_pk_bf16_f32 v89, 0, v89
v_cvt_pk_bf16_f32 v92, 0, v92
v_cvt_pk_bf16_f32 v93, 0, v93
v_pk_mul_f32 v[82:83], v[80:81], v[80:81]
v_pk_mul_f32 v[86:87], v[84:85], v[84:85]
v_pk_mul_f32 v[90:91], v[88:89], v[88:89]
v_pk_mul_f32 v[94:95], v[92:93], v[92:93]
v_pk_fma_f32 v[82:83], v[82:83], v[28:29], v[28:29] op_sel:[0,0,1] op_sel_hi:[1,0,1]
v_pk_fma_f32 v[86:87], v[86:87], v[28:29], v[28:29] op_sel:[0,0,1] op_sel_hi:[1,0,1]
v_pk_fma_f32 v[90:91], v[90:91], v[28:29], v[28:29] op_sel:[0,0,1] op_sel_hi:[1,0,1]
v_pk_fma_f32 v[94:95], v[94:95], v[28:29], v[28:29] op_sel:[0,0,1] op_sel_hi:[1,0,1]
v_pk_mul_f32 v[82:83], v[82:83], v[80:81]
v_pk_mul_f32 v[86:87], v[86:87], v[84:85]
v_pk_mul_f32 v[90:91], v[90:91], v[88:89]
v_pk_mul_f32 v[94:95], v[94:95], v[92:93]
v_exp_f32 v82, v82
v_exp_f32 v83, v83
v_exp_f32 v86, v86
v_exp_f32 v87, v87
v_exp_f32 v90, v90
v_exp_f32 v91, v91
v_exp_f32 v94, v94
v_exp_f32 v95, v95
v_pk_add_f32 v[82:83], v[82:83], v[30:31] op_sel:[0,0] op_sel_hi:[1,0]
v_pk_add_f32 v[86:87], v[86:87], v[30:31] op_sel:[0,0] op_sel_hi:[1,0]
v_pk_add_f32 v[90:91], v[90:91], v[30:31] op_sel:[0,0] op_sel_hi:[1,0]
v_pk_add_f32 v[94:95], v[94:95], v[30:31] op_sel:[0,0] op_sel_hi:[1,0]
v_rcp_f32 v82, v82
v_rcp_f32 v83, v83
v_rcp_f32 v86, v86
v_rcp_f32 v87, v87
v_rcp_f32 v90, v90
v_rcp_f32 v91, v91
v_rcp_f32 v94, v94
v_rcp_f32 v95, v95
v_pk_mul_f32 v[80:81], v[80:81], v[82:83]
v_pk_mul_f32 v[84:85], v[84:85], v[86:87]
v_pk_mul_f32 v[88:89], v[88:89], v[90:91]
v_pk_mul_f32 v[92:93], v[92:93], v[94:95]
v_cvt_pk_bf16_f32 v228, v80, v81
v_cvt_pk_bf16_f32 v229, v84, v85
v_cvt_pk_bf16_f32 v230, v88, v89
v_cvt_pk_bf16_f32 v231, v92, v93
s_add_u32 s84, s79, s81
buffer_store_dwordx4 v[228:231], v21, s[24:27], s84 offen sc1
v_lshlrev_b32 v240, 16, v24
v_lshlrev_b32 v241, 16, v24
v_lshlrev_b32 v242, 16, v24
v_lshlrev_b32 v243, 16, v24
v_lshlrev_b32 v244, 16, v25
v_lshlrev_b32 v245, 16, v25
v_lshlrev_b32 v246, 16, v25
v_lshlrev_b32 v247, 16, v25
v_lshlrev_b32 v248, 16, v26
v_lshlrev_b32 v249, 16, v26
v_lshlrev_b32 v250, 16, v26
v_lshlrev_b32 v251, 16, v26
v_lshlrev_b32 v252, 16, v27
v_lshlrev_b32 v253, 16, v27
v_lshlrev_b32 v254, 16, v27
v_lshlrev_b32 v255, 16, v27
v_mov_b32 v22, 0
v_mov_b32 v23, 1
v_lshlrev_b32 v21, 4, v1
s_lshl_b32 s69, s38, 2
s_add_u32 s69, s69, s32
s_lshl_b32 s70, s69, 6
s_add_u32 s70, s70, 25436160
s_lshl_b32 s69, s69, 14
s_add_u32 s69, s69, 33554432
s_mov_b32 s63, 0
s_cmp_eq_u32 s32, 1
s_cselect_b32 s63, 17408, s63
s_cmp_eq_u32 s32, 2
s_cselect_b32 s63, 34816, s63
s_cmp_eq_u32 s32, 3
s_cselect_b32 s63, 52224, s63
s_mul_i32 s65, s32, 4352
s_add_u32 s65, s65, 131072
v_and_b32 v2, 15, v1
v_lshrrev_b32 v3, 4, v1
v_mul_u32_u24 v5, 272, v2
v_lshlrev_b32 v4, 4, v3
v_add3_u32 v25, v5, v4, s63
v_mul_u32_u24 v5, 272, v3
v_lshlrev_b32 v4, 4, v2
v_add3_u32 v26, v5, v4, s63
v_lshlrev_b32 v20, 12, v3
v_add_u32 v20, v20, v4
s_lshl_b32 s62, s43, 7
s_lshl_b32 s63, s61, 6
s_add_u32 s62, s62, s63
s_lshl_b32 s64, s37, 7
s_lshl_b32 s63, s60, 6
s_add_u32 s64, s64, s63
s_mov_b32 s28, s54
s_mov_b32 s29, s55
s_mov_b32 s30, 8388608
s_mov_b32 s31, 0x20000
v_and_b32 v2, 15, v1
v_lshrrev_b32 v3, 4, v1
s_mul_i32 s90, s60, 8192
v_lshlrev_b32 v4, 4, v1
v_add_u32 v10, s90, v4
v_lshrrev_b32 v5, 2, v1
v_and_b32 v6, 3, v1
v_lshlrev_b32 v6, 3, v6
v_and_b32 v4, 7, v5
s_lshl_b32 s90, s61, 2
v_xor_b32 v4, s90, v4
v_lshlrev_b32 v4, 5, v4
v_lshlrev_b32 v7, 8, v5
v_add_u32 v7, v7, v6
v_add_u32 v7, 16384, v7
v_xor_b32 v2, 0, v4
v_add_u32 v12, v7, v2
v_xor_b32 v2, 32, v4
v_add_u32 v13, v7, v2
v_xor_b32 v2, 64, v4
v_add_u32 v14, v7, v2
v_xor_b32 v2, 96, v4
v_add_u32 v15, v7, v2
v_and_b32 v2, 15, v1
v_lshrrev_b32 v3, 4, v1
v_lshrrev_b32 v4, 1, v2
v_xor_b32 v4, v4, v3
v_lshlrev_b32 v4, 4, v4
v_lshlrev_b32 v5, 7, v2
v_add_u32 v4, v4, v5
s_mul_i32 s90, s60, 8192
v_add_u32 v8, s90, v4
v_xor_b32 v9, 64, v8
v_lshrrev_b32 v5, 2, v1
v_and_b32 v6, 3, v1
v_lshlrev_b32 v6, 3, v6
v_lshrrev_b32 v4, 1, v3
v_lshlrev_b32 v4, 12, v4
v_bfe_u32 v7, v1, 1, 1
v_mul_u32_u24 v7, 1088, v7
v_add_u32 v4, v4, v7
v_and_b32 v7, 1, v3
v_lshlrev_b32 v7, 7, v7
v_add_u32 v4, v4, v7
v_and_b32 v7, 3, v5
v_lshlrev_b32 v7, 4, v7
v_add_u32 v4, v4, v7
v_and_b32 v7, 1, v1
v_lshlrev_b32 v7, 3, v7
v_add_u32 v4, v4, v7
s_lshl_b32 s90, s61, 9
s_add_u32 s90, s90, 16384
v_add_u32 v16, s90, v4
v_xor_b32 v17, 64, v16
s_mov_b32 s93, 0
s_mov_b32 s95, 32768
s_barrier
ds_read_b128 v[32:35], v8 offset:0
ds_read_b64_tr_b16 v[48:49], v16 offset:0
ds_read_b64_tr_b16 v[50:51], v17 offset:0
ds_read_b64_tr_b16 v[52:53], v16 offset:2048
ds_read_b64_tr_b16 v[54:55], v17 offset:2048
ds_read_b64_tr_b16 v[56:57], v16 offset:256
ds_read_b64_tr_b16 v[58:59], v17 offset:256
ds_read_b64_tr_b16 v[60:61], v16 offset:2304
ds_read_b64_tr_b16 v[62:63], v17 offset:2304
ds_read_b128 v[36:39], v8 offset:2048
ds_read_b128 v[40:43], v8 offset:4096
ds_read_b128 v[44:47], v8 offset:6144
s_waitcnt lgkmcnt(0)
v_mfma_f32_16x16x32_bf16 v[128:131], v[32:35], v[48:51], v[240:243]
ds_read_b128 v[64:67], v9 offset:0
ds_read_b64_tr_b16 v[80:81], v16 offset:8192
v_mfma_f32_16x16x32_bf16 v[132:135], v[32:35], v[52:55], v[244:247]
ds_read_b64_tr_b16 v[82:83], v17 offset:8192
v_mfma_f32_16x16x32_bf16 v[136:139], v[32:35], v[56:59], v[248:251]
ds_read_b64_tr_b16 v[84:85], v16 offset:10240
v_mfma_f32_16x16x32_bf16 v[140:143], v[32:35], v[60:63], v[252:255]
ds_read_b64_tr_b16 v[86:87], v17 offset:10240
v_mfma_f32_16x16x32_bf16 v[156:159], v[36:39], v[60:63], v[252:255]
ds_read_b64_tr_b16 v[88:89], v16 offset:8448
v_mfma_f32_16x16x32_bf16 v[152:155], v[36:39], v[56:59], v[248:251]
ds_read_b64_tr_b16 v[90:91], v17 offset:8448
ds_read_b64_tr_b16 v[92:93], v16 offset:10496
v_mfma_f32_16x16x32_bf16 v[148:151], v[36:39], v[52:55], v[244:247]
ds_read_b64_tr_b16 v[94:95], v17 offset:10496
v_mfma_f32_16x16x32_bf16 v[144:147], v[36:39], v[48:51], v[240:243]
ds_read_b128 v[68:71], v9 offset:2048
v_mfma_f32_16x16x32_bf16 v[160:163], v[40:43], v[48:51], v[240:243]
ds_read_b128 v[72:75], v9 offset:4096
v_mfma_f32_16x16x32_bf16 v[164:167], v[40:43], v[52:55], v[244:247]
ds_read_b128 v[76:79], v9 offset:6144
v_mfma_f32_16x16x32_bf16 v[168:171], v[40:43], v[56:59], v[248:251]
v_mfma_f32_16x16x32_bf16 v[172:175], v[40:43], v[60:63], v[252:255]
v_mfma_f32_16x16x32_bf16 v[188:191], v[44:47], v[60:63], v[252:255]
v_mfma_f32_16x16x32_bf16 v[184:187], v[44:47], v[56:59], v[248:251]
v_mfma_f32_16x16x32_bf16 v[180:183], v[44:47], v[52:55], v[244:247]
v_mfma_f32_16x16x32_bf16 v[176:179], v[44:47], v[48:51], v[240:243]
s_waitcnt lgkmcnt(0)
v_mfma_f32_16x16x32_bf16 v[128:131], v[64:67], v[80:83], v[128:131]
s_add_u32 s93, s93, 1
s_cmp_eq_u32 s93, 4
s_cselect_b32 s94, 4294868992, s95
s_cselect_b32 s93, 0, s93
v_mfma_f32_16x16x32_bf16 v[132:135], v[64:67], v[84:87], v[132:135]
v_add_u32 v8, s94, v8
v_add_u32 v9, s94, v9
v_mfma_f32_16x16x32_bf16 v[136:139], v[64:67], v[88:91], v[136:139]
v_add_u32 v16, s94, v16
v_add_u32 v17, s94, v17
v_mfma_f32_16x16x32_bf16 v[140:143], v[64:67], v[92:95], v[140:143]
s_barrier
ds_read_b128 v[32:35], v8 offset:0
ds_read_b64_tr_b16 v[48:49], v16 offset:0
v_mfma_f32_16x16x32_bf16 v[156:159], v[68:71], v[92:95], v[156:159]
ds_read_b64_tr_b16 v[50:51], v17 offset:0
ds_read_b64_tr_b16 v[52:53], v16 offset:2048
v_mfma_f32_16x16x32_bf16 v[152:155], v[68:71], v[88:91], v[152:155]
ds_read_b64_tr_b16 v[54:55], v17 offset:2048
ds_read_b64_tr_b16 v[56:57], v16 offset:256
v_mfma_f32_16x16x32_bf16 v[148:151], v[68:71], v[84:87], v[148:151]
ds_read_b64_tr_b16 v[58:59], v17 offset:256
v_mfma_f32_16x16x32_bf16 v[144:147], v[68:71], v[80:83], v[144:147]
ds_read_b64_tr_b16 v[60:61], v16 offset:2304
ds_read_b64_tr_b16 v[62:63], v17 offset:2304
v_mfma_f32_16x16x32_bf16 v[160:163], v[72:75], v[80:83], v[160:163]
ds_read_b128 v[36:39], v8 offset:2048
ds_read_b128 v[40:43], v8 offset:4096
v_mfma_f32_16x16x32_bf16 v[164:167], v[72:75], v[84:87], v[164:167]
ds_read_b128 v[44:47], v8 offset:6144
v_mfma_f32_16x16x32_bf16 v[168:171], v[72:75], v[88:91], v[168:171]
v_mfma_f32_16x16x32_bf16 v[172:175], v[72:75], v[92:95], v[172:175]
v_mfma_f32_16x16x32_bf16 v[188:191], v[76:79], v[92:95], v[188:191]
s_waitcnt vmcnt(0)
s_mov_b64 s[74:75], exec
s_mov_b64 exec, 1
buffer_store_dword v23, v22, s[24:27], s85 offen sc1
s_mov_b64 exec, s[74:75]
v_mfma_f32_16x16x32_bf16 v[184:187], v[76:79], v[88:91], v[184:187]
v_mfma_f32_16x16x32_bf16 v[180:183], v[76:79], v[84:87], v[180:183]
v_mfma_f32_16x16x32_bf16 v[176:179], v[76:79], v[80:83], v[176:179]
s_mov_b32 s92, 10
s_branch K1_yA_loop
K1_prod:
s_cmp_eq_u32 s34, 1
s_cbranch_scc1 K1_g1prod
s_mov_b32 s90, 7168
v_add_u32 v2, 0, v1
v_mul_u32_u24 v3, 2341, v2
v_lshrrev_b32 v3, 16, v3
v_mul_u32_u24 v4, 28, v3
v_sub_u32 v2, v2, v4
v_bfe_u32 v4, v3, 2, 1
v_lshlrev_b32 v4, 1, v4
v_xor_b32 v2, v2, v4
v_lshlrev_b32 v2, 4, v2
v_mul_lo_u32 v3, v3, s90
v_add_u32 v8, v3, v2
v_add_u32 v2, 64, v1
v_mul_u32_u24 v3, 2341, v2
v_lshrrev_b32 v3, 16, v3
v_mul_u32_u24 v4, 28, v3
v_sub_u32 v2, v2, v4
v_bfe_u32 v4, v3, 2, 1
v_lshlrev_b32 v4, 1, v4
v_xor_b32 v2, v2, v4
v_lshlrev_b32 v2, 4, v2
v_mul_lo_u32 v3, v3, s90
v_add_u32 v9, v3, v2
v_add_u32 v2, 128, v1
v_mul_u32_u24 v3, 2341, v2
v_lshrrev_b32 v3, 16, v3
v_mul_u32_u24 v4, 28, v3
v_sub_u32 v2, v2, v4
v_bfe_u32 v4, v3, 2, 1
v_lshlrev_b32 v4, 1, v4
v_xor_b32 v2, v2, v4
v_lshlrev_b32 v2, 4, v2
v_mul_lo_u32 v3, v3, s90
v_add_u32 v10, v3, v2
v_add_u32 v2, 192, v1
v_mul_u32_u24 v3, 2341, v2
v_lshrrev_b32 v3, 16, v3
v_mul_u32_u24 v4, 28, v3
v_sub_u32 v2, v2, v4
v_bfe_u32 v4, v3, 2, 1
v_lshlrev_b32 v4, 1, v4
v_xor_b32 v2, v2, v4
v_lshlrev_b32 v2, 4, v2
v_mul_lo_u32 v3, v3, s90
v_add_u32 v11, v3, v2
v_add_u32 v2, 256, v1
v_mul_u32_u24 v3, 2341, v2
v_lshrrev_b32 v3, 16, v3
v_mul_u32_u24 v4, 28, v3
v_sub_u32 v2, v2, v4
v_bfe_u32 v4, v3, 2, 1
v_lshlrev_b32 v4, 1, v4
v_xor_b32 v2, v2, v4
v_lshlrev_b32 v2, 4, v2
v_mul_lo_u32 v3, v3, s90
v_add_u32 v12, v3, v2
v_add_u32 v2, 320, v1
v_mul_u32_u24 v3, 2341, v2
v_lshrrev_b32 v3, 16, v3
v_mul_u32_u24 v4, 28, v3
v_sub_u32 v2, v2, v4
v_bfe_u32 v4, v3, 2, 1
v_lshlrev_b32 v4, 1, v4
v_xor_b32 v2, v2, v4
v_lshlrev_b32 v2, 4, v2
v_mul_lo_u32 v3, v3, s90
v_add_u32 v13, v3, v2
v_add_u32 v2, 384, v1
v_mul_u32_u24 v3, 2341, v2
v_lshrrev_b32 v3, 16, v3
v_mul_u32_u24 v4, 28, v3
v_sub_u32 v2, v2, v4
v_bfe_u32 v4, v3, 2, 1
v_lshlrev_b32 v4, 1, v4
v_xor_b32 v2, v2, v4
v_lshlrev_b32 v2, 4, v2
v_mul_lo_u32 v3, v3, s90
v_add_u32 v14, v3, v2
v_lshrrev_b32 v2, 4, v1
v_and_b32 v3, 15, v1
v_lshlrev_b32 v4, 1, v2
v_xor_b32 v3, v3, v4
s_mov_b32 s90, 2048
v_mul_lo_u32 v2, v2, s90
v_lshlrev_b32 v3, 4, v3
v_add_u32 v16, v2, v3
v_xor_b32 v3, 128, v3
v_add_u32 v17, v2, v3
s_mul_i32 s86, s41, 448
s_lshl_b32 s89, s42, 8
s_add_u32 s89, s89, 4194304
s_and_b32 s78, s33, 1
s_mul_i32 s66, s78, 20
s_mul_i32 s78, s78, 32
s_sub_u32 s78, s78, 12
s_mov_b32 s79, 36
s_mov_b32 s69, 36
s_mov_b32 s67, 8
s_mov_b32 s68, 24
s_cmp_eq_u32 s32, 5
s_cbranch_scc1 K1_g3p1
s_barrier
s_barrier
s_mov_b32 s80, 0
s_mov_b32 s87, 0
s_add_u32 s85, s87, s88
s_and_b32 s85, s85, 3
s_andn2_b32 s83, s87, 3
s_or_b32 s85, s85, s83
s_add_u32 s87, s87, 1
s_mul_i32 s81, s85, 458752
s_add_u32 s81, s81, s86
s_lshl_b32 s82, s85, 17
s_add_u32 s82, s82, s89
s_add_u32 m0, s80, 0
s_add_u32 s83, s81, 0
buffer_load_dwordx4 v8, s[16:19], s83 offen lds
s_add_u32 m0, m0, 1024
s_add_u32 s83, s81, 0
buffer_load_dwordx4 v9, s[16:19], s83 offen lds
s_add_u32 m0, m0, 1024
s_add_u32 s83, s81, 0
buffer_load_dwordx4 v10, s[16:19], s83 offen lds
s_add_u32 m0, m0, 1024
s_add_u32 s83, s81, 0
buffer_load_dwordx4 v11, s[16:19], s83 offen lds
s_add_u32 m0, m0, 1024
s_add_u32 s83, s81, 0
buffer_load_dwordx4 v12, s[16:19], s83 offen lds
s_add_u32 m0, m0, 1024
s_add_u32 s83, s81, 0
buffer_load_dwordx4 v13, s[16:19], s83 offen lds
s_add_u32 m0, m0, 1024
s_add_u32 s83, s81, 0
buffer_load_dwordx4 v14, s[16:19], s83 offen lds
s_add_u32 m0, m0, 1024
s_add_u32 s83, s81, 114688
buffer_load_dwordx4 v8, s[16:19], s83 offen lds
s_add_u32 m0, m0, 1024
s_add_u32 s83, s81, 114688
buffer_load_dwordx4 v9, s[16:19], s83 offen lds
s_add_u32 m0, m0, 1024
s_add_u32 s83, s81, 114688
buffer_load_dwordx4 v10, s[16:19], s83 offen lds
s_add_u32 m0, m0, 1024
s_add_u32 s83, s81, 114688
buffer_load_dwordx4 v11, s[16:19], s83 offen lds
s_add_u32 m0, m0, 1024
s_add_u32 s83, s81, 114688
buffer_load_dwordx4 v12, s[16:19], s83 offen lds
s_add_u32 m0, m0, 1024
s_add_u32 s83, s81, 114688
buffer_load_dwordx4 v13, s[16:19], s83 offen lds
s_add_u32 m0, m0, 1024
s_add_u32 s83, s81, 114688
buffer_load_dwordx4 v14, s[16:19], s83 offen lds
s_add_u32 m0, m0, 1024
s_add_u32 s83, s81, 229376
buffer_load_dwordx4 v8, s[16:19], s83 offen lds
s_add_u32 m0, m0, 1024
s_add_u32 s83, s81, 229376
buffer_load_dwordx4 v9, s[16:19], s83 offen lds
s_add_u32 m0, m0, 1024
s_add_u32 s83, s81, 229376
buffer_load_dwordx4 v10, s[16:19], s83 offen lds
s_add_u32 m0, m0, 1024
s_add_u32 s83, s81, 229376
buffer_load_dwordx4 v11, s[16:19], s83 offen lds
s_add_u32 m0, m0, 1024
s_add_u32 s83, s81, 229376
buffer_load_dwordx4 v12, s[16:19], s83 offen lds
s_add_u32 m0, m0, 1024
s_add_u32 s83, s81, 229376
buffer_load_dwordx4 v13, s[16:19], s83 offen lds
s_add_u32 m0, m0, 1024
s_add_u32 s83, s81, 229376
buffer_load_dwordx4 v14, s[16:19], s83 offen lds
s_add_u32 m0, m0, 1024
s_add_u32 s83, s81, 344064
buffer_load_dwordx4 v8, s[16:19], s83 offen lds
s_add_u32 s80, s80, 45056
s_cmp_eq_u32 s80, 135168
s_cselect_b32 s80, 0, s80
s_barrier
s_mov_b32 s80, 45056
s_mov_b32 s87, 1
s_add_u32 s85, s87, s88
s_and_b32 s85, s85, 3
s_andn2_b32 s83, s87, 3
s_or_b32 s85, s85, s83
s_add_u32 s87, s87, 1
s_mul_i32 s81, s85, 458752
s_add_u32 s81, s81, s86
s_lshl_b32 s82, s85, 17
s_add_u32 s82, s82, s89
s_add_u32 m0, s80, 0
s_add_u32 s83, s81, 0
buffer_load_dwordx4 v8, s[16:19], s83 offen lds
s_add_u32 m0, m0, 1024
s_add_u32 s83, s81, 0
buffer_load_dwordx4 v9, s[16:19], s83 offen lds
s_add_u32 m0, m0, 1024
s_add_u32 s83, s81, 0
buffer_load_dwordx4 v10, s[16:19], s83 offen lds
s_add_u32 m0, m0, 1024
s_add_u32 s83, s81, 0
buffer_load_dwordx4 v11, s[16:19], s83 offen lds
s_add_u32 m0, m0, 1024
s_add_u32 s83, s81, 0
buffer_load_dwordx4 v12, s[16:19], s83 offen lds
s_add_u32 m0, m0, 1024
s_add_u32 s83, s81, 0
buffer_load_dwordx4 v13, s[16:19], s83 offen lds
s_add_u32 m0, m0, 1024
s_add_u32 s83, s81, 0
buffer_load_dwordx4 v14, s[16:19], s83 offen lds
s_add_u32 m0, m0, 1024
s_add_u32 s83, s81, 114688
buffer_load_dwordx4 v8, s[16:19], s83 offen lds
s_add_u32 m0, m0, 1024
s_add_u32 s83, s81, 114688
buffer_load_dwordx4 v9, s[16:19], s83 offen lds
s_add_u32 m0, m0, 1024
s_add_u32 s83, s81, 114688
buffer_load_dwordx4 v10, s[16:19], s83 offen lds
s_add_u32 m0, m0, 1024
s_add_u32 s83, s81, 114688
buffer_load_dwordx4 v11, s[16:19], s83 offen lds
s_add_u32 m0, m0, 1024
s_add_u32 s83, s81, 114688
buffer_load_dwordx4 v12, s[16:19], s83 offen lds
s_add_u32 m0, m0, 1024
s_add_u32 s83, s81, 114688
buffer_load_dwordx4 v13, s[16:19], s83 offen lds
s_add_u32 m0, m0, 1024
s_add_u32 s83, s81, 114688
buffer_load_dwordx4 v14, s[16:19], s83 offen lds
s_add_u32 m0, m0, 1024
s_add_u32 s83, s81, 229376
buffer_load_dwordx4 v8, s[16:19], s83 offen lds
s_add_u32 m0, m0, 1024
s_add_u32 s83, s81, 229376
buffer_load_dwordx4 v9, s[16:19], s83 offen lds
s_add_u32 m0, m0, 1024
s_add_u32 s83, s81, 229376
buffer_load_dwordx4 v10, s[16:19], s83 offen lds
s_add_u32 m0, m0, 1024
s_add_u32 s83, s81, 229376
buffer_load_dwordx4 v11, s[16:19], s83 offen lds
s_add_u32 m0, m0, 1024
s_add_u32 s83, s81, 229376
buffer_load_dwordx4 v12, s[16:19], s83 offen lds
s_add_u32 m0, m0, 1024
s_add_u32 s83, s81, 229376
buffer_load_dwordx4 v13, s[16:19], s83 offen lds
s_add_u32 m0, m0, 1024
s_add_u32 s83, s81, 229376
buffer_load_dwordx4 v14, s[16:19], s83 offen lds
s_add_u32 m0, m0, 1024
s_add_u32 s83, s81, 344064
buffer_load_dwordx4 v8, s[16:19], s83 offen lds
s_add_u32 s80, s80, 45056
s_cmp_eq_u32 s80, 135168
s_cselect_b32 s80, 0, s80
s_waitcnt vmcnt(41)
s_mov_b32 s80, 90112
s_mov_b32 s87, 2
s_add_u32 s85, s87, s88
s_and_b32 s85, s85, 3
s_andn2_b32 s83, s87, 3
s_or_b32 s85, s85, s83
s_add_u32 s87, s87, 1
s_mul_i32 s81, s85, 458752
s_add_u32 s81, s81, s86
s_lshl_b32 s82, s85, 17
s_add_u32 s82, s82, s89
s_add_u32 m0, s80, 0
s_add_u32 s83, s81, 0
buffer_load_dwordx4 v8, s[16:19], s83 offen lds
s_add_u32 m0, m0, 1024
s_add_u32 s83, s81, 0
buffer_load_dwordx4 v9, s[16:19], s83 offen lds
s_add_u32 m0, m0, 1024
s_add_u32 s83, s81, 0
buffer_load_dwordx4 v10, s[16:19], s83 offen lds
s_add_u32 m0, m0, 1024
s_add_u32 s83, s81, 0
buffer_load_dwordx4 v11, s[16:19], s83 offen lds
s_add_u32 m0, m0, 1024
s_add_u32 s83, s81, 0
buffer_load_dwordx4 v12, s[16:19], s83 offen lds
s_add_u32 m0, m0, 1024
s_add_u32 s83, s81, 0
buffer_load_dwordx4 v13, s[16:19], s83 offen lds
s_add_u32 m0, m0, 1024
s_add_u32 s83, s81, 0
buffer_load_dwordx4 v14, s[16:19], s83 offen lds
s_add_u32 m0, m0, 1024
s_add_u32 s83, s81, 114688
buffer_load_dwordx4 v8, s[16:19], s83 offen lds
s_add_u32 m0, m0, 1024
s_add_u32 s83, s81, 114688
buffer_load_dwordx4 v9, s[16:19], s83 offen lds
s_add_u32 m0, m0, 1024
s_add_u32 s83, s81, 114688
buffer_load_dwordx4 v10, s[16:19], s83 offen lds
s_add_u32 m0, m0, 1024
s_add_u32 s83, s81, 114688
buffer_load_dwordx4 v11, s[16:19], s83 offen lds
s_add_u32 m0, m0, 1024
s_add_u32 s83, s81, 114688
buffer_load_dwordx4 v12, s[16:19], s83 offen lds
s_add_u32 m0, m0, 1024
s_add_u32 s83, s81, 114688
buffer_load_dwordx4 v13, s[16:19], s83 offen lds
s_add_u32 m0, m0, 1024
s_add_u32 s83, s81, 114688
buffer_load_dwordx4 v14, s[16:19], s83 offen lds
s_add_u32 m0, m0, 1024
s_add_u32 s83, s81, 229376
buffer_load_dwordx4 v8, s[16:19], s83 offen lds
s_add_u32 m0, m0, 1024
s_add_u32 s83, s81, 229376
buffer_load_dwordx4 v9, s[16:19], s83 offen lds
s_add_u32 m0, m0, 1024
s_add_u32 s83, s81, 229376
buffer_load_dwordx4 v10, s[16:19], s83 offen lds
s_add_u32 m0, m0, 1024
s_add_u32 s83, s81, 229376
buffer_load_dwordx4 v11, s[16:19], s83 offen lds
s_add_u32 m0, m0, 1024
s_add_u32 s83, s81, 229376
buffer_load_dwordx4 v12, s[16:19], s83 offen lds
s_add_u32 m0, m0, 1024
s_add_u32 s83, s81, 229376
buffer_load_dwordx4 v13, s[16:19], s83 offen lds
s_add_u32 m0, m0, 1024
s_add_u32 s83, s81, 229376
buffer_load_dwordx4 v14, s[16:19], s83 offen lds
s_add_u32 m0, m0, 1024
s_add_u32 s83, s81, 344064
buffer_load_dwordx4 v8, s[16:19], s83 offen lds
s_add_u32 s80, s80, 45056
s_cmp_eq_u32 s80, 135168
s_cselect_b32 s80, 0, s80
s_mov_b32 s80, 0
s_mov_b32 s87, 3
s_waitcnt vmcnt(44)
s_barrier
s_waitcnt vmcnt(22)
s_barrier
s_add_u32 s85, s87, s88
s_and_b32 s85, s85, 3
s_andn2_b32 s83, s87, 3
s_or_b32 s85, s85, s83
s_add_u32 s87, s87, 1
s_mul_i32 s81, s85, 458752
s_add_u32 s81, s81, s86
s_lshl_b32 s82, s85, 17
s_add_u32 s82, s82, s89
s_add_u32 m0, s80, 0
s_add_u32 s83, s81, 0
buffer_load_dwordx4 v8, s[16:19], s83 offen lds
s_add_u32 m0, m0, 1024
s_add_u32 s83, s81, 0
buffer_load_dwordx4 v9, s[16:19], s83 offen lds
s_add_u32 m0, m0, 1024
s_add_u32 s83, s81, 0
buffer_load_dwordx4 v10, s[16:19], s83 offen lds
s_add_u32 m0, m0, 1024
s_add_u32 s83, s81, 0
buffer_load_dwordx4 v11, s[16:19], s83 offen lds
s_add_u32 m0, m0, 1024
s_add_u32 s83, s81, 0
buffer_load_dwordx4 v12, s[16:19], s83 offen lds
s_add_u32 m0, m0, 1024
s_add_u32 s83, s81, 0
buffer_load_dwordx4 v13, s[16:19], s83 offen lds
s_add_u32 m0, m0, 1024
s_add_u32 s83, s81, 0
buffer_load_dwordx4 v14, s[16:19], s83 offen lds
s_add_u32 m0, m0, 1024
s_add_u32 s83, s81, 114688
buffer_load_dwordx4 v8, s[16:19], s83 offen lds
s_add_u32 m0, m0, 1024
s_add_u32 s83, s81, 114688
buffer_load_dwordx4 v9, s[16:19], s83 offen lds
s_add_u32 m0, m0, 1024
s_add_u32 s83, s81, 114688
buffer_load_dwordx4 v10, s[16:19], s83 offen lds
s_add_u32 m0, m0, 1024
s_add_u32 s83, s81, 114688
buffer_load_dwordx4 v11, s[16:19], s83 offen lds
s_add_u32 m0, m0, 1024
s_add_u32 s83, s81, 114688
buffer_load_dwordx4 v12, s[16:19], s83 offen lds
s_add_u32 m0, m0, 1024
s_add_u32 s83, s81, 114688
buffer_load_dwordx4 v13, s[16:19], s83 offen lds
s_add_u32 m0, m0, 1024
s_add_u32 s83, s81, 114688
buffer_load_dwordx4 v14, s[16:19], s83 offen lds
s_add_u32 m0, m0, 1024
s_add_u32 s83, s81, 229376
buffer_load_dwordx4 v8, s[16:19], s83 offen lds
s_add_u32 m0, m0, 1024
s_add_u32 s83, s81, 229376
buffer_load_dwordx4 v9, s[16:19], s83 offen lds
s_add_u32 m0, m0, 1024
s_add_u32 s83, s81, 229376
buffer_load_dwordx4 v10, s[16:19], s83 offen lds
s_add_u32 m0, m0, 1024
s_add_u32 s83, s81, 229376
buffer_load_dwordx4 v11, s[16:19], s83 offen lds
s_add_u32 m0, m0, 1024
s_add_u32 s83, s81, 229376
buffer_load_dwordx4 v12, s[16:19], s83 offen lds
s_add_u32 m0, m0, 1024
s_add_u32 s83, s81, 229376
buffer_load_dwordx4 v13, s[16:19], s83 offen lds
s_add_u32 m0, m0, 1024
s_add_u32 s83, s81, 229376
buffer_load_dwordx4 v14, s[16:19], s83 offen lds
s_add_u32 m0, m0, 1024
s_add_u32 s83, s81, 344064
buffer_load_dwordx4 v8, s[16:19], s83 offen lds
s_add_u32 s80, s80, 45056
s_cmp_eq_u32 s80, 135168
s_cselect_b32 s80, 0, s80
s_mov_b32 s84, 28
K1_g3p0_loop:
s_waitcnt vmcnt(22)
s_barrier
s_add_u32 s85, s87, s88
s_and_b32 s85, s85, 3
s_andn2_b32 s83, s87, 3
s_or_b32 s85, s85, s83
s_add_u32 s87, s87, 1
s_mul_i32 s81, s85, 458752
s_add_u32 s81, s81, s86
s_lshl_b32 s82, s85, 17
s_add_u32 s82, s82, s89
s_add_u32 m0, s80, 0
s_add_u32 s83, s81, 0
buffer_load_dwordx4 v8, s[16:19], s83 offen lds
s_add_u32 m0, m0, 1024
s_add_u32 s83, s81, 0
buffer_load_dwordx4 v9, s[16:19], s83 offen lds
s_add_u32 m0, m0, 1024
s_add_u32 s83, s81, 0
buffer_load_dwordx4 v10, s[16:19], s83 offen lds
s_add_u32 m0, m0, 1024
s_add_u32 s83, s81, 0
buffer_load_dwordx4 v11, s[16:19], s83 offen lds
s_add_u32 m0, m0, 1024
s_add_u32 s83, s81, 0
buffer_load_dwordx4 v12, s[16:19], s83 offen lds
s_add_u32 m0, m0, 1024
s_add_u32 s83, s81, 0
buffer_load_dwordx4 v13, s[16:19], s83 offen lds
s_add_u32 m0, m0, 1024
s_add_u32 s83, s81, 0
buffer_load_dwordx4 v14, s[16:19], s83 offen lds
s_add_u32 m0, m0, 1024
s_add_u32 s83, s81, 114688
buffer_load_dwordx4 v8, s[16:19], s83 offen lds
s_add_u32 m0, m0, 1024
s_add_u32 s83, s81, 114688
buffer_load_dwordx4 v9, s[16:19], s83 offen lds
s_add_u32 m0, m0, 1024
s_add_u32 s83, s81, 114688
buffer_load_dwordx4 v10, s[16:19], s83 offen lds
s_add_u32 m0, m0, 1024
s_add_u32 s83, s81, 114688
buffer_load_dwordx4 v11, s[16:19], s83 offen lds
s_add_u32 m0, m0, 1024
s_add_u32 s83, s81, 114688
buffer_load_dwordx4 v12, s[16:19], s83 offen lds
s_add_u32 m0, m0, 1024
s_add_u32 s83, s81, 114688
buffer_load_dwordx4 v13, s[16:19], s83 offen lds
s_add_u32 m0, m0, 1024
s_add_u32 s83, s81, 114688
buffer_load_dwordx4 v14, s[16:19], s83 offen lds
s_add_u32 m0, m0, 1024
s_add_u32 s83, s81, 229376
buffer_load_dwordx4 v8, s[16:19], s83 offen lds
s_add_u32 m0, m0, 1024
s_add_u32 s83, s81, 229376
buffer_load_dwordx4 v9, s[16:19], s83 offen lds
s_add_u32 m0, m0, 1024
s_add_u32 s83, s81, 229376
buffer_load_dwordx4 v10, s[16:19], s83 offen lds
s_add_u32 m0, m0, 1024
s_add_u32 s83, s81, 229376
buffer_load_dwordx4 v11, s[16:19], s83 offen lds
s_add_u32 m0, m0, 1024
s_add_u32 s83, s81, 229376
buffer_load_dwordx4 v12, s[16:19], s83 offen lds
s_add_u32 m0, m0, 1024
s_add_u32 s83, s81, 229376
buffer_load_dwordx4 v13, s[16:19], s83 offen lds
s_add_u32 m0, m0, 1024
s_add_u32 s83, s81, 229376
buffer_load_dwordx4 v14, s[16:19], s83 offen lds
s_add_u32 m0, m0, 1024
s_add_u32 s83, s81, 344064
buffer_load_dwordx4 v8, s[16:19], s83 offen lds
s_add_u32 s80, s80, 45056
s_cmp_eq_u32 s80, 135168
s_cselect_b32 s80, 0, s80
s_sub_u32 s84, s84, 1
s_cmp_lg_u32 s84, 0
s_cbranch_scc1 K1_g3p0_loop
s_waitcnt vmcnt(22)
s_barrier
s_waitcnt vmcnt(0)
s_barrier
v_lshrrev_b32 v2, 3, v1
v_and_b32 v3, 7, v1
v_lshrrev_b32 v4, 1, v2
v_xor_b32 v3, v3, v4
s_mov_b32 s90, 2048
v_mul_lo_u32 v2, v2, s90
v_lshlrev_b32 v3, 4, v3
v_add_u32 v8, v2, v3
v_xor_b32 v3, 64, v3
v_add_u32 v9, v2, v3
s_branch K1_pb_a
K1_g3p1:
v_mul_u32_u24 v45, 16, v1
s_and_b32 s62, s2, 7
s_mul_i32 s62, s62, 4096
s_add_u32 s62, s62, 26214400
s_add_u32 s64, s62, 0
buffer_load_dword v40, v45, s[24:27], s64 offen sc1
s_add_u32 s64, s62, 1024
buffer_load_dword v41, v45, s[24:27], s64 offen sc1
s_add_u32 s64, s62, 2048
buffer_load_dword v42, v45, s[24:27], s64 offen sc1
s_add_u32 s64, s62, 3072
buffer_load_dword v43, v45, s[24:27], s64 offen sc1
v_and_b32 v46, 7, v1
v_mul_u32_u24 v46, 4096, v46
s_mul_i32 s63, s2, 16
s_add_u32 s63, s63, 26214400
buffer_load_dword v44, v46, s[24:27], s63 offen sc1
s_barrier
s_barrier
s_waitcnt vmcnt(0)
v_xor_b32 v47, 1, v44
s_mov_b64 exec, 255
buffer_store_dword v47, v46, s[24:27], s63 offen sc1
s_mov_b64 exec, -1
s_mov_b32 s80, 0
s_mov_b32 s87, 0
s_add_u32 s85, s87, s88
s_and_b32 s85, s85, 3
s_andn2_b32 s83, s87, 3
s_or_b32 s85, s85, s83
s_add_u32 s87, s87, 1
s_mul_i32 s81, s85, 458752
s_add_u32 s81, s81, s86
s_lshl_b32 s82, s85, 17
s_add_u32 s82, s82, s89
s_add_u32 m0, s80, 22528
s_add_u32 s83, s81, 344064
buffer_load_dwordx4 v9, s[16:19], s83 offen lds
s_add_u32 m0, m0, 1024
s_add_u32 s83, s81, 344064
buffer_load_dwordx4 v10, s[16:19], s83 offen lds
s_add_u32 m0, m0, 1024
s_add_u32 s83, s81, 344064
buffer_load_dwordx4 v11, s[16:19], s83 offen lds
s_add_u32 m0, m0, 1024
s_add_u32 s83, s81, 344064
buffer_load_dwordx4 v12, s[16:19], s83 offen lds
s_add_u32 m0, m0, 1024
s_add_u32 s83, s81, 344064
buffer_load_dwordx4 v13, s[16:19], s83 offen lds
s_add_u32 m0, m0, 1024
s_add_u32 s83, s81, 344064
buffer_load_dwordx4 v14, s[16:19], s83 offen lds
s_add_u32 s80, s80, 45056
s_cmp_eq_u32 s80, 135168
s_cselect_b32 s80, 0, s80
s_barrier
s_mov_b32 s80, 0
s_mov_b32 s87, 0
s_add_u32 s85, s87, s88
s_and_b32 s85, s85, 3
s_andn2_b32 s83, s87, 3
s_or_b32 s85, s85, s83
s_add_u32 s87, s87, 1
s_mul_i32 s81, s85, 458752
s_add_u32 s81, s81, s86
s_lshl_b32 s82, s85, 17
s_add_u32 s82, s82, s89
s_add_u32 m0, s80, 28672
s_add_u32 s83, s82, 0
buffer_load_dwordx4 v16, s[24:27], s83 offen lds
s_add_u32 m0, m0, 1024
s_add_u32 s83, s82, 8192
buffer_load_dwordx4 v17, s[24:27], s83 offen lds
s_add_u32 m0, m0, 1024
s_add_u32 s83, s82, 16384
buffer_load_dwordx4 v16, s[24:27], s83 offen lds
s_add_u32 m0, m0, 1024
s_add_u32 s83, s82, 24576
buffer_load_dwordx4 v17, s[24:27], s83 offen lds
s_add_u32 m0, m0, 1024
s_add_u32 s83, s82, 32768
buffer_load_dwordx4 v16, s[24:27], s83 offen lds
s_add_u32 m0, m0, 1024
s_add_u32 s83, s82, 40960
buffer_load_dwordx4 v17, s[24:27], s83 offen lds
s_add_u32 m0, m0, 1024
s_add_u32 s83, s82, 49152
buffer_load_dwordx4 v16, s[24:27], s83 offen lds
s_add_u32 m0, m0, 1024
s_add_u32 s83, s82, 57344
buffer_load_dwordx4 v17, s[24:27], s83 offen lds
s_add_u32 m0, m0, 1024
s_add_u32 s83, s82, 65536
buffer_load_dwordx4 v16, s[24:27], s83 offen lds
s_add_u32 m0, m0, 1024
s_add_u32 s83, s82, 73728
buffer_load_dwordx4 v17, s[24:27], s83 offen lds
s_add_u32 m0, m0, 1024
s_add_u32 s83, s82, 81920
buffer_load_dwordx4 v16, s[24:27], s83 offen lds
s_add_u32 m0, m0, 1024
s_add_u32 s83, s82, 90112
buffer_load_dwordx4 v17, s[24:27], s83 offen lds
s_add_u32 m0, m0, 1024
s_add_u32 s83, s82, 98304
buffer_load_dwordx4 v16, s[24:27], s83 offen lds
s_add_u32 m0, m0, 1024
s_add_u32 s83, s82, 106496
buffer_load_dwordx4 v17, s[24:27], s83 offen lds
s_add_u32 m0, m0, 1024
s_add_u32 s83, s82, 114688
buffer_load_dwordx4 v16, s[24:27], s83 offen lds
s_add_u32 m0, m0, 1024
s_add_u32 s83, s82, 122880
buffer_load_dwordx4 v17, s[24:27], s83 offen lds
s_add_u32 s80, s80, 45056
s_cmp_eq_u32 s80, 135168
s_cselect_b32 s80, 0, s80
s_mov_b32 s80, 45056
s_mov_b32 s87, 1
s_add_u32 s85, s87, s88
s_and_b32 s85, s85, 3
s_andn2_b32 s83, s87, 3
s_or_b32 s85, s85, s83
s_add_u32 s87, s87, 1
s_mul_i32 s81, s85, 458752
s_add_u32 s81, s81, s86
s_lshl_b32 s82, s85, 17
s_add_u32 s82, s82, s89
s_add_u32 m0, s80, 22528
s_add_u32 s83, s81, 344064
buffer_load_dwordx4 v9, s[16:19], s83 offen lds
s_add_u32 m0, m0, 1024
s_add_u32 s83, s81, 344064
buffer_load_dwordx4 v10, s[16:19], s83 offen lds
s_add_u32 m0, m0, 1024
s_add_u32 s83, s81, 344064
buffer_load_dwordx4 v11, s[16:19], s83 offen lds
s_add_u32 m0, m0, 1024
s_add_u32 s83, s81, 344064
buffer_load_dwordx4 v12, s[16:19], s83 offen lds
s_add_u32 m0, m0, 1024
s_add_u32 s83, s81, 344064
buffer_load_dwordx4 v13, s[16:19], s83 offen lds
s_add_u32 m0, m0, 1024
s_add_u32 s83, s81, 344064
buffer_load_dwordx4 v14, s[16:19], s83 offen lds
s_add_u32 m0, m0, 1024
s_add_u32 s83, s82, 0
buffer_load_dwordx4 v16, s[24:27], s83 offen lds
s_add_u32 m0, m0, 1024
s_add_u32 s83, s82, 8192
buffer_load_dwordx4 v17, s[24:27], s83 offen lds
s_add_u32 m0, m0, 1024
s_add_u32 s83, s82, 16384
buffer_load_dwordx4 v16, s[24:27], s83 offen lds
s_add_u32 m0, m0, 1024
s_add_u32 s83, s82, 24576
buffer_load_dwordx4 v17, s[24:27], s83 offen lds
s_add_u32 m0, m0, 1024
s_add_u32 s83, s82, 32768
buffer_load_dwordx4 v16, s[24:27], s83 offen lds
s_add_u32 m0, m0, 1024
s_add_u32 s83, s82, 40960
buffer_load_dwordx4 v17, s[24:27], s83 offen lds
s_add_u32 m0, m0, 1024
s_add_u32 s83, s82, 49152
buffer_load_dwordx4 v16, s[24:27], s83 offen lds
s_add_u32 m0, m0, 1024
s_add_u32 s83, s82, 57344
buffer_load_dwordx4 v17, s[24:27], s83 offen lds
s_add_u32 m0, m0, 1024
s_add_u32 s83, s82, 65536
buffer_load_dwordx4 v16, s[24:27], s83 offen lds
s_add_u32 m0, m0, 1024
s_add_u32 s83, s82, 73728
buffer_load_dwordx4 v17, s[24:27], s83 offen lds
s_add_u32 m0, m0, 1024
s_add_u32 s83, s82, 81920
buffer_load_dwordx4 v16, s[24:27], s83 offen lds
s_add_u32 m0, m0, 1024
s_add_u32 s83, s82, 90112
buffer_load_dwordx4 v17, s[24:27], s83 offen lds
s_add_u32 m0, m0, 1024
s_add_u32 s83, s82, 98304
buffer_load_dwordx4 v16, s[24:27], s83 offen lds
s_add_u32 m0, m0, 1024
s_add_u32 s83, s82, 106496
buffer_load_dwordx4 v17, s[24:27], s83 offen lds
s_add_u32 m0, m0, 1024
s_add_u32 s83, s82, 114688
buffer_load_dwordx4 v16, s[24:27], s83 offen lds
s_add_u32 m0, m0, 1024
s_add_u32 s83, s82, 122880
buffer_load_dwordx4 v17, s[24:27], s83 offen lds
s_add_u32 s80, s80, 45056
s_cmp_eq_u32 s80, 135168
s_cselect_b32 s80, 0, s80
s_waitcnt vmcnt(41)
s_mov_b32 s80, 90112
s_mov_b32 s87, 2
s_add_u32 s85, s87, s88
s_and_b32 s85, s85, 3
s_andn2_b32 s83, s87, 3
s_or_b32 s85, s85, s83
s_add_u32 s87, s87, 1
s_mul_i32 s81, s85, 458752
s_add_u32 s81, s81, s86
s_lshl_b32 s82, s85, 17
s_add_u32 s82, s82, s89
s_add_u32 m0, s80, 22528
s_add_u32 s83, s81, 344064
buffer_load_dwordx4 v9, s[16:19], s83 offen lds
s_add_u32 m0, m0, 1024
s_add_u32 s83, s81, 344064
buffer_load_dwordx4 v10, s[16:19], s83 offen lds
s_add_u32 m0, m0, 1024
s_add_u32 s83, s81, 344064
buffer_load_dwordx4 v11, s[16:19], s83 offen lds
s_add_u32 m0, m0, 1024
s_add_u32 s83, s81, 344064
buffer_load_dwordx4 v12, s[16:19], s83 offen lds
s_add_u32 m0, m0, 1024
s_add_u32 s83, s81, 344064
buffer_load_dwordx4 v13, s[16:19], s83 offen lds
s_add_u32 m0, m0, 1024
s_add_u32 s83, s81, 344064
buffer_load_dwordx4 v14, s[16:19], s83 offen lds
s_add_u32 m0, m0, 1024
s_add_u32 s83, s82, 0
buffer_load_dwordx4 v16, s[24:27], s83 offen lds
s_add_u32 m0, m0, 1024
s_add_u32 s83, s82, 8192
buffer_load_dwordx4 v17, s[24:27], s83 offen lds
s_add_u32 m0, m0, 1024
s_add_u32 s83, s82, 16384
buffer_load_dwordx4 v16, s[24:27], s83 offen lds
s_add_u32 m0, m0, 1024
s_add_u32 s83, s82, 24576
buffer_load_dwordx4 v17, s[24:27], s83 offen lds
s_add_u32 m0, m0, 1024
s_add_u32 s83, s82, 32768
buffer_load_dwordx4 v16, s[24:27], s83 offen lds
s_add_u32 m0, m0, 1024
s_add_u32 s83, s82, 40960
buffer_load_dwordx4 v17, s[24:27], s83 offen lds
s_add_u32 m0, m0, 1024
s_add_u32 s83, s82, 49152
buffer_load_dwordx4 v16, s[24:27], s83 offen lds
s_add_u32 m0, m0, 1024
s_add_u32 s83, s82, 57344
buffer_load_dwordx4 v17, s[24:27], s83 offen lds
s_add_u32 m0, m0, 1024
s_add_u32 s83, s82, 65536
buffer_load_dwordx4 v16, s[24:27], s83 offen lds
s_add_u32 m0, m0, 1024
s_add_u32 s83, s82, 73728
buffer_load_dwordx4 v17, s[24:27], s83 offen lds
s_add_u32 m0, m0, 1024
s_add_u32 s83, s82, 81920
buffer_load_dwordx4 v16, s[24:27], s83 offen lds
s_add_u32 m0, m0, 1024
s_add_u32 s83, s82, 90112
buffer_load_dwordx4 v17, s[24:27], s83 offen lds
s_add_u32 m0, m0, 1024
s_add_u32 s83, s82, 98304
buffer_load_dwordx4 v16, s[24:27], s83 offen lds
s_add_u32 m0, m0, 1024
s_add_u32 s83, s82, 106496
buffer_load_dwordx4 v17, s[24:27], s83 offen lds
s_add_u32 m0, m0, 1024
s_add_u32 s83, s82, 114688
buffer_load_dwordx4 v16, s[24:27], s83 offen lds
s_add_u32 m0, m0, 1024
s_add_u32 s83, s82, 122880
buffer_load_dwordx4 v17, s[24:27], s83 offen lds
s_add_u32 s80, s80, 45056
s_cmp_eq_u32 s80, 135168
s_cselect_b32 s80, 0, s80
s_mov_b32 s80, 0
s_mov_b32 s87, 3
s_waitcnt vmcnt(44)
s_barrier
s_waitcnt vmcnt(22)
s_barrier
s_add_u32 s64, s62, 0
buffer_load_dword v48, v45, s[24:27], s64 offen sc1
s_add_u32 s64, s62, 1024
buffer_load_dword v49, v45, s[24:27], s64 offen sc1
s_add_u32 s64, s62, 2048
buffer_load_dword v50, v45, s[24:27], s64 offen sc1
s_add_u32 s64, s62, 3072
buffer_load_dword v51, v45, s[24:27], s64 offen sc1
s_add_u32 s85, s87, s88
s_and_b32 s85, s85, 3
s_andn2_b32 s83, s87, 3
s_or_b32 s85, s85, s83
s_add_u32 s87, s87, 1
s_mul_i32 s81, s85, 458752
s_add_u32 s81, s81, s86
s_lshl_b32 s82, s85, 17
s_add_u32 s82, s82, s89
s_add_u32 m0, s80, 22528
s_add_u32 s83, s81, 344064
buffer_load_dwordx4 v9, s[16:19], s83 offen lds
s_add_u32 m0, m0, 1024
s_add_u32 s83, s81, 344064
buffer_load_dwordx4 v10, s[16:19], s83 offen lds
s_add_u32 m0, m0, 1024
s_add_u32 s83, s81, 344064
buffer_load_dwordx4 v11, s[16:19], s83 offen lds
s_add_u32 m0, m0, 1024
s_add_u32 s83, s81, 344064
buffer_load_dwordx4 v12, s[16:19], s83 offen lds
s_add_u32 m0, m0, 1024
s_add_u32 s83, s81, 344064
buffer_load_dwordx4 v13, s[16:19], s83 offen lds
s_add_u32 m0, m0, 1024
s_add_u32 s83, s81, 344064
buffer_load_dwordx4 v14, s[16:19], s83 offen lds
s_add_u32 m0, m0, 1024
s_add_u32 s83, s82, 0
buffer_load_dwordx4 v16, s[24:27], s83 offen lds
s_add_u32 m0, m0, 1024
s_add_u32 s83, s82, 8192
buffer_load_dwordx4 v17, s[24:27], s83 offen lds
s_add_u32 m0, m0, 1024
s_add_u32 s83, s82, 16384
buffer_load_dwordx4 v16, s[24:27], s83 offen lds
s_add_u32 m0, m0, 1024
s_add_u32 s83, s82, 24576
buffer_load_dwordx4 v17, s[24:27], s83 offen lds
s_add_u32 m0, m0, 1024
s_add_u32 s83, s82, 32768
buffer_load_dwordx4 v16, s[24:27], s83 offen lds
s_add_u32 m0, m0, 1024
s_add_u32 s83, s82, 40960
buffer_load_dwordx4 v17, s[24:27], s83 offen lds
s_add_u32 m0, m0, 1024
s_add_u32 s83, s82, 49152
buffer_load_dwordx4 v16, s[24:27], s83 offen lds
s_add_u32 m0, m0, 1024
s_add_u32 s83, s82, 57344
buffer_load_dwordx4 v17, s[24:27], s83 offen lds
s_add_u32 m0, m0, 1024
s_add_u32 s83, s82, 65536
buffer_load_dwordx4 v16, s[24:27], s83 offen lds
s_add_u32 m0, m0, 1024
s_add_u32 s83, s82, 73728
buffer_load_dwordx4 v17, s[24:27], s83 offen lds
s_add_u32 m0, m0, 1024
s_add_u32 s83, s82, 81920
buffer_load_dwordx4 v16, s[24:27], s83 offen lds
s_add_u32 m0, m0, 1024
s_add_u32 s83, s82, 90112
buffer_load_dwordx4 v17, s[24:27], s83 offen lds
s_add_u32 m0, m0, 1024
s_add_u32 s83, s82, 98304
buffer_load_dwordx4 v16, s[24:27], s83 offen lds
s_add_u32 m0, m0, 1024
s_add_u32 s83, s82, 106496
buffer_load_dwordx4 v17, s[24:27], s83 offen lds
s_add_u32 m0, m0, 1024
s_add_u32 s83, s82, 114688
buffer_load_dwordx4 v16, s[24:27], s83 offen lds
s_add_u32 m0, m0, 1024
s_add_u32 s83, s82, 122880
buffer_load_dwordx4 v17, s[24:27], s83 offen lds
s_add_u32 s80, s80, 45056
s_cmp_eq_u32 s80, 135168
s_cselect_b32 s80, 0, s80
s_mov_b32 s84, 28
K1_g3p1_loop:
s_waitcnt vmcnt(22)
s_barrier
s_cmp_lg_u32 s84, 28
s_cbranch_scc1 K1_g3p1_pb
s_mov_b32 s73, 0x40000
s_branch K1_g3p1_lnchk
K1_g3p1_lnpoll:
s_add_u32 s64, s62, 0
buffer_load_dword v48, v45, s[24:27], s64 offen sc1
s_add_u32 s64, s62, 1024
buffer_load_dword v49, v45, s[24:27], s64 offen sc1
s_add_u32 s64, s62, 2048
buffer_load_dword v50, v45, s[24:27], s64 offen sc1
s_add_u32 s64, s62, 3072
buffer_load_dword v51, v45, s[24:27], s64 offen sc1
s_waitcnt vmcnt(0)
K1_g3p1_lnchk:
v_xor_b32 v48, v48, v40
v_xor_b32 v49, v49, v41
v_xor_b32 v50, v50, v42
v_xor_b32 v51, v51, v43
v_min_u32 v48, v48, v49
v_min3_u32 v48, v48, v50, v51
v_cmp_eq_u32 vcc, 0, v48
s_cmp_eq_u64 vcc, 0
s_cbranch_scc1 K1_g3p1_lnok
s_sleep 2
s_sub_u32 s73, s73, 1
s_cmp_lg_u32 s73, 0
s_cbranch_scc1 K1_g3p1_lnpoll
K1_g3p1_lnok:
v_xor_b32 v47, 2, v44
s_mov_b64 exec, 255
buffer_store_dword v47, v46, s[24:27], s63 offen sc1
s_mov_b64 exec, -1
K1_g3p1_pb:
s_add_u32 s85, s87, s88
s_and_b32 s85, s85, 3
s_andn2_b32 s83, s87, 3
s_or_b32 s85, s85, s83
s_add_u32 s87, s87, 1
s_mul_i32 s81, s85, 458752
s_add_u32 s81, s81, s86
s_lshl_b32 s82, s85, 17
s_add_u32 s82, s82, s89
s_add_u32 m0, s80, 22528
s_add_u32 s83, s81, 344064
buffer_load_dwordx4 v9, s[16:19], s83 offen lds
s_add_u32 m0, m0, 1024
s_add_u32 s83, s81, 344064
buffer_load_dwordx4 v10, s[16:19], s83 offen lds
s_add_u32 m0, m0, 1024
s_add_u32 s83, s81, 344064
buffer_load_dwordx4 v11, s[16:19], s83 offen lds
s_add_u32 m0, m0, 1024
s_add_u32 s83, s81, 344064
buffer_load_dwordx4 v12, s[16:19], s83 offen lds
s_add_u32 m0, m0, 1024
s_add_u32 s83, s81, 344064
buffer_load_dwordx4 v13, s[16:19], s83 offen lds
s_add_u32 m0, m0, 1024
s_add_u32 s83, s81, 344064
buffer_load_dwordx4 v14, s[16:19], s83 offen lds
s_add_u32 m0, m0, 1024
s_add_u32 s83, s82, 0
buffer_load_dwordx4 v16, s[24:27], s83 offen lds
s_add_u32 m0, m0, 1024
s_add_u32 s83, s82, 8192
buffer_load_dwordx4 v17, s[24:27], s83 offen lds
s_add_u32 m0, m0, 1024
s_add_u32 s83, s82, 16384
buffer_load_dwordx4 v16, s[24:27], s83 offen lds
s_add_u32 m0, m0, 1024
s_add_u32 s83, s82, 24576
buffer_load_dwordx4 v17, s[24:27], s83 offen lds
s_add_u32 m0, m0, 1024
s_add_u32 s83, s82, 32768
buffer_load_dwordx4 v16, s[24:27], s83 offen lds
s_add_u32 m0, m0, 1024
s_add_u32 s83, s82, 40960
buffer_load_dwordx4 v17, s[24:27], s83 offen lds
s_add_u32 m0, m0, 1024
s_add_u32 s83, s82, 49152
buffer_load_dwordx4 v16, s[24:27], s83 offen lds
s_add_u32 m0, m0, 1024
s_add_u32 s83, s82, 57344
buffer_load_dwordx4 v17, s[24:27], s83 offen lds
s_add_u32 m0, m0, 1024
s_add_u32 s83, s82, 65536
buffer_load_dwordx4 v16, s[24:27], s83 offen lds
s_add_u32 m0, m0, 1024
s_add_u32 s83, s82, 73728
buffer_load_dwordx4 v17, s[24:27], s83 offen lds
s_add_u32 m0, m0, 1024
s_add_u32 s83, s82, 81920
buffer_load_dwordx4 v16, s[24:27], s83 offen lds
s_add_u32 m0, m0, 1024
s_add_u32 s83, s82, 90112
buffer_load_dwordx4 v17, s[24:27], s83 offen lds
s_add_u32 m0, m0, 1024
s_add_u32 s83, s82, 98304
buffer_load_dwordx4 v16, s[24:27], s83 offen lds
s_add_u32 m0, m0, 1024
s_add_u32 s83, s82, 106496
buffer_load_dwordx4 v17, s[24:27], s83 offen lds
s_add_u32 m0, m0, 1024
s_add_u32 s83, s82, 114688
buffer_load_dwordx4 v16, s[24:27], s83 offen lds
s_add_u32 m0, m0, 1024
s_add_u32 s83, s82, 122880
buffer_load_dwordx4 v17, s[24:27], s83 offen lds
s_add_u32 s80, s80, 45056
s_cmp_eq_u32 s80, 135168
s_cselect_b32 s80, 0, s80
s_sub_u32 s84, s84, 1
s_cmp_lg_u32 s84, 0
s_cbranch_scc1 K1_g3p1_loop
s_waitcnt vmcnt(22)
s_barrier
s_waitcnt vmcnt(0)
s_barrier
s_branch K1_pb_b
K1_g1:
s_mov_b32 s12, s76
s_mov_b32 s13, s77
s_mov_b32 s14, 2048
s_mov_b32 s15, 0x20000
s_mov_b32 s16, s78
s_mov_b32 s17, s79
s_mov_b32 s18, 2048
s_mov_b32 s19, 0x20000
s_mov_b32 s28, s80
s_mov_b32 s29, s81
s_mov_b32 s30, 2048
s_mov_b32 s31, 0x20000
v_and_b32 v2, 15, v1
v_lshlrev_b32 v2, 1, v2
s_lshl_b32 s63, s62, 1
buffer_load_ushort v32, v2, s[12:15], s63 offen offset:0
buffer_load_ushort v33, v2, s[16:19], s63 offen offset:0
buffer_load_ushort v34, v2, s[28:31], s63 offen offset:0
buffer_load_ushort v36, v2, s[12:15], s63 offen offset:32
buffer_load_ushort v37, v2, s[16:19], s63 offen offset:32
buffer_load_ushort v38, v2, s[28:31], s63 offen offset:32
v_and_b32 v2, 15, v1
v_lshrrev_b32 v3, 4, v1
v_lshrrev_b32 v4, 1, v2
v_xor_b32 v4, v4, v3
v_lshlrev_b32 v4, 4, v4
v_lshlrev_b32 v5, 7, v2
v_add_u32 v4, v4, v5
s_mul_i32 s90, s60, 16384
v_add_u32 v8, s90, v4
v_xor_b32 v9, 64, v8
s_lshl_b32 s90, s61, 13
s_add_u32 s90, s90, 32768
v_add_u32 v12, s90, v4
v_xor_b32 v13, 64, v12
v_lshrrev_b32 v5, 2, v1
v_and_b32 v6, 3, v1
v_lshlrev_b32 v6, 3, v6
v_mov_b32 v128, 0
v_mov_b32 v129, 0
v_mov_b32 v130, 0
v_mov_b32 v131, 0
v_mov_b32 v132, 0
v_mov_b32 v133, 0
v_mov_b32 v134, 0
v_mov_b32 v135, 0
v_mov_b32 v136, 0
v_mov_b32 v137, 0
v_mov_b32 v138, 0
v_mov_b32 v139, 0
v_mov_b32 v140, 0
v_mov_b32 v141, 0
v_mov_b32 v142, 0
v_mov_b32 v143, 0
v_mov_b32 v144, 0
v_mov_b32 v145, 0
v_mov_b32 v146, 0
v_mov_b32 v147, 0
v_mov_b32 v148, 0
v_mov_b32 v149, 0
v_mov_b32 v150, 0
v_mov_b32 v151, 0
v_mov_b32 v152, 0
v_mov_b32 v153, 0
v_mov_b32 v154, 0
v_mov_b32 v155, 0
v_mov_b32 v156, 0
v_mov_b32 v157, 0
v_mov_b32 v158, 0
v_mov_b32 v159, 0
v_mov_b32 v160, 0
v_mov_b32 v161, 0
v_mov_b32 v162, 0
v_mov_b32 v163, 0
v_mov_b32 v164, 0
v_mov_b32 v165, 0
v_mov_b32 v166, 0
v_mov_b32 v167, 0
v_mov_b32 v168, 0
v_mov_b32 v169, 0
v_mov_b32 v170, 0
v_mov_b32 v171, 0
v_mov_b32 v172, 0
v_mov_b32 v173, 0
v_mov_b32 v174, 0
v_mov_b32 v175, 0
v_mov_b32 v176, 0
v_mov_b32 v177, 0
v_mov_b32 v178, 0
v_mov_b32 v179, 0
v_mov_b32 v180, 0
v_mov_b32 v181, 0
v_mov_b32 v182, 0
v_mov_b32 v183, 0
v_mov_b32 v184, 0
v_mov_b32 v185, 0
v_mov_b32 v186, 0
v_mov_b32 v187, 0
v_mov_b32 v188, 0
v_mov_b32 v189, 0
v_mov_b32 v190, 0
v_mov_b32 v191, 0
v_mov_b32 v192, 0
v_mov_b32 v193, 0
v_mov_b32 v194, 0
v_mov_b32 v195, 0
v_mov_b32 v196, 0
v_mov_b32 v197, 0
v_mov_b32 v198, 0
v_mov_b32 v199, 0
v_mov_b32 v200, 0
v_mov_b32 v201, 0
v_mov_b32 v202, 0
v_mov_b32 v203, 0
v_mov_b32 v204, 0
v_mov_b32 v205, 0
v_mov_b32 v206, 0
v_mov_b32 v207, 0
v_mov_b32 v208, 0
v_mov_b32 v209, 0
v_mov_b32 v210, 0
v_mov_b32 v211, 0
v_mov_b32 v212, 0
v_mov_b32 v213, 0
v_mov_b32 v214, 0
v_mov_b32 v215, 0
v_mov_b32 v216, 0
v_mov_b32 v217, 0
v_mov_b32 v218, 0
v_mov_b32 v219, 0
v_mov_b32 v220, 0
v_mov_b32 v221, 0
v_mov_b32 v222, 0
v_mov_b32 v223, 0
v_mov_b32 v224, 0
v_mov_b32 v225, 0
v_mov_b32 v226, 0
v_mov_b32 v227, 0
v_mov_b32 v228, 0
v_mov_b32 v229, 0
v_mov_b32 v230, 0
v_mov_b32 v231, 0
v_mov_b32 v232, 0
v_mov_b32 v233, 0
v_mov_b32 v234, 0
v_mov_b32 v235, 0
v_mov_b32 v236, 0
v_mov_b32 v237, 0
v_mov_b32 v238, 0
v_mov_b32 v239, 0
v_mov_b32 v240, 0
v_mov_b32 v241, 0
v_mov_b32 v242, 0
v_mov_b32 v243, 0
v_mov_b32 v244, 0
v_mov_b32 v245, 0
v_mov_b32 v246, 0
v_mov_b32 v247, 0
v_mov_b32 v248, 0
v_mov_b32 v249, 0
v_mov_b32 v250, 0
v_mov_b32 v251, 0
v_mov_b32 v252, 0
v_mov_b32 v253, 0
v_mov_b32 v254, 0
v_mov_b32 v255, 0
s_mov_b32 s50, 14680064
s_mov_b32 s51, 0x20000
v_lshlrev_b32 v14, 7, v1
s_lshr_b32 s45, s3, 0
s_lshl_b32 s44, s3, 7
s_or_b32 s47, s44, s45
s_and_b32 s47, s47, 127
s_and_b32 s44, s47, 3
s_mul_i32 s46, s44, 1048576
s_lshr_b32 s45, s47, 2
s_lshl_b32 s45, s45, 2
s_add_u32 s45, s45, s32
s_mul_i32 s45, s45, 8192
s_add_u32 s46, s46, s45
s_add_u32 s46, s46, 2097152
s_add_u32 s44, s44, 1
s_mov_b32 s86, 28
s_mov_b32 s87, 0
s_cmp_lg_u32 s32, 3
s_cbranch_scc1 K1_g1c_aok
s_mov_b32 s101, 0x40000
K1_g1c_apoll:
buffer_load_dword v20, v18, s[24:27], s100 offen sc1
s_waitcnt vmcnt(0)
v_cmp_eq_u32 vcc, v20, v19
s_cmp_eq_u64 vcc, 0
s_cbranch_scc1 K1_g1c_aok
s_sleep 1
s_sub_u32 s101, s101, 1
s_cmp_lg_u32 s101, 0
s_cbranch_scc1 K1_g1c_apoll
K1_g1c_aok:
s_barrier
s_waitcnt vmcnt(0)
v_lshlrev_b32 v32, 16, v32
v_lshlrev_b32 v33, 16, v33
v_lshlrev_b32 v34, 16, v34
v_mul_f32 v34, 0x3fb8aa3b, v34
v_exp_f32 v34, v34
s_nop 0
v_cvt_pk_bf16_f32 v34, 0, v34
v_mul_f32 v40, v34, v32
v_mul_f32 v41, v34, v33
v_mul_f32 v42, 0x3fb8aa3b, v40
v_exp_f32 v42, v42
v_mul_f32 v43, 0x3e22f983, v41
v_fract_f32 v43, v43
v_cos_f32 v44, v43
v_sin_f32 v45, v43
s_nop 0
v_mul_f32 v16, v42, v44
v_mul_f32 v17, v42, v45
v_add_f32 v46, -1.0, v16
v_mul_f32 v47, v32, v32
v_fmac_f32 v47, v33, v33
v_rcp_f32 v48, v47
s_nop 0
v_fma_f32 v49, -v47, v48, 1.0
v_fma_f32 v48, v48, v49, v48
v_add_f32 v48, v48, v48
v_mul_f32 v18, v46, v32
v_fmac_f32 v18, v17, v33
v_mul_f32 v18, v18, v48
v_mul_f32 v19, v17, v32
v_fma_f32 v19, -v46, v33, v19
v_mul_f32 v19, v19, v48
v_mov_b32 v20, v16
v_mov_b32 v21, v17
v_mul_f32 v49, v20, v20
v_fma_f32 v49, -v21, v21, v49
v_mul_f32 v50, v20, v21
v_add_f32 v21, v50, v50
v_mov_b32 v20, v49
v_mul_f32 v49, v20, v20
v_fma_f32 v49, -v21, v21, v49
v_mul_f32 v50, v20, v21
v_add_f32 v21, v50, v50
v_mov_b32 v20, v49
v_mul_f32 v49, v20, v20
v_fma_f32 v49, -v21, v21, v49
v_mul_f32 v50, v20, v21
v_add_f32 v21, v50, v50
v_mov_b32 v20, v49
v_mul_f32 v49, v20, v20
v_fma_f32 v49, -v21, v21, v49
v_mul_f32 v50, v20, v21
v_add_f32 v21, v50, v50
v_mov_b32 v20, v49
v_mul_f32 v49, v20, v20
v_fma_f32 v49, -v21, v21, v49
v_mul_f32 v50, v20, v21
v_add_f32 v21, v50, v50
v_mov_b32 v20, v49
v_mov_b32 v22, v20
v_mov_b32 v23, v21
v_mul_f32 v49, v22, v22
v_fma_f32 v49, -v23, v23, v49
v_mul_f32 v50, v22, v23
v_add_f32 v23, v50, v50
v_mov_b32 v22, v49
v_mul_f32 v49, v22, v22
v_fma_f32 v49, -v23, v23, v49
v_mul_f32 v50, v22, v23
v_add_f32 v23, v50, v50
v_mov_b32 v22, v49
v_lshlrev_b32 v36, 16, v36
v_lshlrev_b32 v37, 16, v37
v_lshlrev_b32 v38, 16, v38
v_mul_f32 v38, 0x3fb8aa3b, v38
v_exp_f32 v38, v38
s_nop 0
v_cvt_pk_bf16_f32 v38, 0, v38
v_mul_f32 v40, v38, v36
v_mul_f32 v41, v38, v37
v_mul_f32 v42, 0x3fb8aa3b, v40
v_exp_f32 v42, v42
v_mul_f32 v43, 0x3e22f983, v41
v_fract_f32 v43, v43
v_cos_f32 v44, v43
v_sin_f32 v45, v43
s_nop 0
v_mul_f32 v24, v42, v44
v_mul_f32 v25, v42, v45
v_add_f32 v46, -1.0, v24
v_mul_f32 v47, v36, v36
v_fmac_f32 v47, v37, v37
v_rcp_f32 v48, v47
s_nop 0
v_fma_f32 v49, -v47, v48, 1.0
v_fma_f32 v48, v48, v49, v48
v_add_f32 v48, v48, v48
v_mul_f32 v26, v46, v36
v_fmac_f32 v26, v25, v37
v_mul_f32 v26, v26, v48
v_mul_f32 v27, v25, v36
v_fma_f32 v27, -v46, v37, v27
v_mul_f32 v27, v27, v48
v_mov_b32 v28, v24
v_mov_b32 v29, v25
v_mul_f32 v49, v28, v28
v_fma_f32 v49, -v29, v29, v49
v_mul_f32 v50, v28, v29
v_add_f32 v29, v50, v50
v_mov_b32 v28, v49
v_mul_f32 v49, v28, v28
v_fma_f32 v49, -v29, v29, v49
v_mul_f32 v50, v28, v29
v_add_f32 v29, v50, v50
v_mov_b32 v28, v49
v_mul_f32 v49, v28, v28
v_fma_f32 v49, -v29, v29, v49
v_mul_f32 v50, v28, v29
v_add_f32 v29, v50, v50
v_mov_b32 v28, v49
v_mul_f32 v49, v28, v28
v_fma_f32 v49, -v29, v29, v49
v_mul_f32 v50, v28, v29
v_add_f32 v29, v50, v50
v_mov_b32 v28, v49
v_mul_f32 v49, v28, v28
v_fma_f32 v49, -v29, v29, v49
v_mul_f32 v50, v28, v29
v_add_f32 v29, v50, v50
v_mov_b32 v28, v49
v_mov_b32 v30, v28
v_mov_b32 v31, v29
v_mul_f32 v49, v30, v30
v_fma_f32 v49, -v31, v31, v49
v_mul_f32 v50, v30, v31
v_add_f32 v31, v50, v50
v_mov_b32 v30, v49
v_mul_f32 v49, v30, v30
v_fma_f32 v49, -v31, v31, v49
v_mul_f32 v50, v30, v31
v_add_f32 v31, v50, v50
v_mov_b32 v30, v49
s_mov_b32 s8, s56
s_mov_b32 s9, s57
s_mov_b32 s10, 4194304
s_mov_b32 s11, 0x20000
s_mov_b32 s12, s58
s_mov_b32 s13, s59
s_mov_b32 s14, 2048
s_mov_b32 s15, 0x20000
v_lshrrev_b32 v2, 3, v1
v_and_b32 v3, 7, v1
v_lshrrev_b32 v4, 1, v2
v_xor_b32 v3, v3, v4
s_mov_b32 s90, 2048
v_mul_lo_u32 v2, v2, s90
v_lshlrev_b32 v3, 4, v3
v_add_u32 v10, v2, v3
v_xor_b32 v3, 64, v3
v_add_u32 v11, v2, v3
s_lshl_b32 s82, s43, 7
s_lshl_b32 s83, s61, 6
s_add_u32 s81, s82, s83
s_lshl_b32 s80, s81, 11
s_lshl_b32 s81, s81, 5
s_add_u32 s81, s81, 25690112
s_lshl_b32 s82, s37, 8
s_lshl_b32 s83, s60, 7
s_add_u32 s82, s82, s83
s_add_u32 s80, s80, s82
s_lshl_b32 s84, s32, 13
s_add_u32 s84, s84, 131072
s_mov_b32 s93, 0
s_mov_b32 s95, 49152
s_barrier
ds_read_b128 v[32:35], v8 offset:0
ds_read_b128 v[64:67], v12 offset:0
ds_read_b128 v[68:71], v12 offset:2048
ds_read_b128 v[72:75], v12 offset:4096
ds_read_b128 v[76:79], v12 offset:6144
ds_read_b128 v[36:39], v8 offset:2048
ds_read_b128 v[40:43], v8 offset:4096
ds_read_b128 v[44:47], v8 offset:6144
ds_read_b128 v[48:51], v8 offset:8192
ds_read_b128 v[52:55], v8 offset:10240
ds_read_b128 v[56:59], v8 offset:12288
ds_read_b128 v[60:63], v8 offset:14336
s_mov_b32 s92, 15
K1_g1_loop:
s_waitcnt lgkmcnt(0)
v_mfma_f32_16x16x32_bf16 v[128:131], v[32:35], v[64:67], v[128:131]
ds_read_b128 v[80:83], v9 offset:0
v_mfma_f32_16x16x32_bf16 v[132:135], v[32:35], v[68:71], v[132:135]
v_mfma_f32_16x16x32_bf16 v[136:139], v[32:35], v[72:75], v[136:139]
ds_read_b128 v[112:115], v13 offset:0
v_mfma_f32_16x16x32_bf16 v[140:143], v[32:35], v[76:79], v[140:143]
v_mfma_f32_16x16x32_bf16 v[156:159], v[36:39], v[76:79], v[156:159]
ds_read_b128 v[116:119], v13 offset:2048
v_mfma_f32_16x16x32_bf16 v[152:155], v[36:39], v[72:75], v[152:155]
v_mfma_f32_16x16x32_bf16 v[148:151], v[36:39], v[68:71], v[148:151]
ds_read_b128 v[120:123], v13 offset:4096
v_mfma_f32_16x16x32_bf16 v[144:147], v[36:39], v[64:67], v[144:147]
v_mfma_f32_16x16x32_bf16 v[160:163], v[40:43], v[64:67], v[160:163]
ds_read_b128 v[124:127], v13 offset:6144
v_mfma_f32_16x16x32_bf16 v[164:167], v[40:43], v[68:71], v[164:167]
v_mfma_f32_16x16x32_bf16 v[168:171], v[40:43], v[72:75], v[168:171]
ds_read_b128 v[84:87], v9 offset:2048
v_mfma_f32_16x16x32_bf16 v[172:175], v[40:43], v[76:79], v[172:175]
v_mfma_f32_16x16x32_bf16 v[188:191], v[44:47], v[76:79], v[188:191]
v_mfma_f32_16x16x32_bf16 v[184:187], v[44:47], v[72:75], v[184:187]
ds_read_b128 v[88:91], v9 offset:4096
v_mfma_f32_16x16x32_bf16 v[180:183], v[44:47], v[68:71], v[180:183]
s_sub_u32 s44, s44, 1
s_cmp_lg_u32 s44, 0
s_cbranch_scc1 K1_g1_ah
s_add_u32 s45, s46, 0
buffer_load_dword v15, v14, s[48:51], s45 offen
s_add_u32 s46, s46, 4194304
s_mov_b32 s44, 4
K1_g1_ah:
v_mfma_f32_16x16x32_bf16 v[176:179], v[44:47], v[64:67], v[176:179]
ds_read_b128 v[92:95], v9 offset:6144
v_mfma_f32_16x16x32_bf16 v[192:195], v[48:51], v[64:67], v[192:195]
v_mfma_f32_16x16x32_bf16 v[196:199], v[48:51], v[68:71], v[196:199]
ds_read_b128 v[96:99], v9 offset:8192
v_mfma_f32_16x16x32_bf16 v[200:203], v[48:51], v[72:75], v[200:203]
v_mfma_f32_16x16x32_bf16 v[204:207], v[48:51], v[76:79], v[204:207]
ds_read_b128 v[100:103], v9 offset:10240
v_mfma_f32_16x16x32_bf16 v[220:223], v[52:55], v[76:79], v[220:223]
v_mfma_f32_16x16x32_bf16 v[216:219], v[52:55], v[72:75], v[216:219]
ds_read_b128 v[104:107], v9 offset:12288
v_mfma_f32_16x16x32_bf16 v[212:215], v[52:55], v[68:71], v[212:215]
v_mfma_f32_16x16x32_bf16 v[208:211], v[52:55], v[64:67], v[208:211]
ds_read_b128 v[108:111], v9 offset:14336
v_mfma_f32_16x16x32_bf16 v[224:227], v[56:59], v[64:67], v[224:227]
v_mfma_f32_16x16x32_bf16 v[228:231], v[56:59], v[68:71], v[228:231]
v_mfma_f32_16x16x32_bf16 v[232:235], v[56:59], v[72:75], v[232:235]
v_mfma_f32_16x16x32_bf16 v[236:239], v[56:59], v[76:79], v[236:239]
v_mfma_f32_16x16x32_bf16 v[252:255], v[60:63], v[76:79], v[252:255]
v_mfma_f32_16x16x32_bf16 v[248:251], v[60:63], v[72:75], v[248:251]
v_mfma_f32_16x16x32_bf16 v[244:247], v[60:63], v[68:71], v[244:247]
v_mfma_f32_16x16x32_bf16 v[240:243], v[60:63], v[64:67], v[240:243]
s_waitcnt lgkmcnt(0)
v_mfma_f32_16x16x32_bf16 v[128:131], v[80:83], v[112:115], v[128:131]
s_add_u32 s93, s93, 1
s_cmp_eq_u32 s93, 3
s_cselect_b32 s94, 4294868992, s95
s_cselect_b32 s93, 0, s93
v_mfma_f32_16x16x32_bf16 v[132:135], v[80:83], v[116:119], v[132:135]
v_add_u32 v8, s94, v8
v_add_u32 v9, s94, v9
v_mfma_f32_16x16x32_bf16 v[136:139], v[80:83], v[120:123], v[136:139]
v_add_u32 v12, s94, v12
v_add_u32 v13, s94, v13
v_mfma_f32_16x16x32_bf16 v[140:143], v[80:83], v[124:127], v[140:143]
s_barrier
ds_read_b128 v[32:35], v8 offset:0
v_mfma_f32_16x16x32_bf16 v[156:159], v[84:87], v[124:127], v[156:159]
ds_read_b128 v[64:67], v12 offset:0
v_mfma_f32_16x16x32_bf16 v[152:155], v[84:87], v[120:123], v[152:155]
v_mfma_f32_16x16x32_bf16 v[148:151], v[84:87], v[116:119], v[148:151]
ds_read_b128 v[68:71], v12 offset:2048
v_mfma_f32_16x16x32_bf16 v[144:147], v[84:87], v[112:115], v[144:147]
v_mfma_f32_16x16x32_bf16 v[160:163], v[88:91], v[112:115], v[160:163]
ds_read_b128 v[72:75], v12 offset:4096
v_mfma_f32_16x16x32_bf16 v[164:167], v[88:91], v[116:119], v[164:167]
v_mfma_f32_16x16x32_bf16 v[168:171], v[88:91], v[120:123], v[168:171]
ds_read_b128 v[76:79], v12 offset:6144
v_mfma_f32_16x16x32_bf16 v[172:175], v[88:91], v[124:127], v[172:175]
v_mfma_f32_16x16x32_bf16 v[188:191], v[92:95], v[124:127], v[188:191]
ds_read_b128 v[36:39], v8 offset:2048
v_mfma_f32_16x16x32_bf16 v[184:187], v[92:95], v[120:123], v[184:187]
v_mfma_f32_16x16x32_bf16 v[180:183], v[92:95], v[116:119], v[180:183]
ds_read_b128 v[40:43], v8 offset:4096
v_mfma_f32_16x16x32_bf16 v[176:179], v[92:95], v[112:115], v[176:179]
v_mfma_f32_16x16x32_bf16 v[192:195], v[96:99], v[112:115], v[192:195]
ds_read_b128 v[44:47], v8 offset:6144
v_mfma_f32_16x16x32_bf16 v[196:199], v[96:99], v[116:119], v[196:199]
v_mfma_f32_16x16x32_bf16 v[200:203], v[96:99], v[120:123], v[200:203]
ds_read_b128 v[48:51], v8 offset:8192
v_mfma_f32_16x16x32_bf16 v[204:207], v[96:99], v[124:127], v[204:207]
v_mfma_f32_16x16x32_bf16 v[220:223], v[100:103], v[124:127], v[220:223]
ds_read_b128 v[52:55], v8 offset:10240
v_mfma_f32_16x16x32_bf16 v[216:219], v[100:103], v[120:123], v[216:219]
v_mfma_f32_16x16x32_bf16 v[212:215], v[100:103], v[116:119], v[212:215]
ds_read_b128 v[56:59], v8 offset:12288
v_mfma_f32_16x16x32_bf16 v[208:211], v[100:103], v[112:115], v[208:211]
v_mfma_f32_16x16x32_bf16 v[224:227], v[104:107], v[112:115], v[224:227]
ds_read_b128 v[60:63], v8 offset:14336
v_mfma_f32_16x16x32_bf16 v[228:231], v[104:107], v[116:119], v[228:231]
v_mfma_f32_16x16x32_bf16 v[232:235], v[104:107], v[120:123], v[232:235]
v_mfma_f32_16x16x32_bf16 v[236:239], v[104:107], v[124:127], v[236:239]
v_mfma_f32_16x16x32_bf16 v[252:255], v[108:111], v[124:127], v[252:255]
v_mfma_f32_16x16x32_bf16 v[248:251], v[108:111], v[120:123], v[248:251]
v_mfma_f32_16x16x32_bf16 v[244:247], v[108:111], v[116:119], v[244:247]
v_mfma_f32_16x16x32_bf16 v[240:243], v[108:111], v[112:115], v[240:243]
s_sub_u32 s92, s92, 1
s_cmp_lg_u32 s92, 0
s_cbranch_scc1 K1_g1_loop
s_waitcnt lgkmcnt(0)
v_mfma_f32_16x16x32_bf16 v[128:131], v[32:35], v[64:67], v[128:131]
ds_read_b128 v[80:83], v9 offset:0
v_mfma_f32_16x16x32_bf16 v[132:135], v[32:35], v[68:71], v[132:135]
v_mfma_f32_16x16x32_bf16 v[136:139], v[32:35], v[72:75], v[136:139]
ds_read_b128 v[112:115], v13 offset:0
v_mfma_f32_16x16x32_bf16 v[140:143], v[32:35], v[76:79], v[140:143]
v_mfma_f32_16x16x32_bf16 v[156:159], v[36:39], v[76:79], v[156:159]
ds_read_b128 v[116:119], v13 offset:2048
v_mfma_f32_16x16x32_bf16 v[152:155], v[36:39], v[72:75], v[152:155]
v_mfma_f32_16x16x32_bf16 v[148:151], v[36:39], v[68:71], v[148:151]
ds_read_b128 v[120:123], v13 offset:4096
v_mfma_f32_16x16x32_bf16 v[144:147], v[36:39], v[64:67], v[144:147]
v_mfma_f32_16x16x32_bf16 v[160:163], v[40:43], v[64:67], v[160:163]
ds_read_b128 v[124:127], v13 offset:6144
v_mfma_f32_16x16x32_bf16 v[164:167], v[40:43], v[68:71], v[164:167]
v_mfma_f32_16x16x32_bf16 v[168:171], v[40:43], v[72:75], v[168:171]
ds_read_b128 v[84:87], v9 offset:2048
v_mfma_f32_16x16x32_bf16 v[172:175], v[40:43], v[76:79], v[172:175]
v_mfma_f32_16x16x32_bf16 v[188:191], v[44:47], v[76:79], v[188:191]
v_mfma_f32_16x16x32_bf16 v[184:187], v[44:47], v[72:75], v[184:187]
ds_read_b128 v[88:91], v9 offset:4096
v_mfma_f32_16x16x32_bf16 v[180:183], v[44:47], v[68:71], v[180:183]
v_mfma_f32_16x16x32_bf16 v[176:179], v[44:47], v[64:67], v[176:179]
ds_read_b128 v[92:95], v9 offset:6144
v_mfma_f32_16x16x32_bf16 v[192:195], v[48:51], v[64:67], v[192:195]
v_mfma_f32_16x16x32_bf16 v[196:199], v[48:51], v[68:71], v[196:199]
ds_read_b128 v[96:99], v9 offset:8192
v_mfma_f32_16x16x32_bf16 v[200:203], v[48:51], v[72:75], v[200:203]
v_mfma_f32_16x16x32_bf16 v[204:207], v[48:51], v[76:79], v[204:207]
ds_read_b128 v[100:103], v9 offset:10240
v_mfma_f32_16x16x32_bf16 v[220:223], v[52:55], v[76:79], v[220:223]
v_mfma_f32_16x16x32_bf16 v[216:219], v[52:55], v[72:75], v[216:219]
ds_read_b128 v[104:107], v9 offset:12288
v_mfma_f32_16x16x32_bf16 v[212:215], v[52:55], v[68:71], v[212:215]
v_mfma_f32_16x16x32_bf16 v[208:211], v[52:55], v[64:67], v[208:211]
ds_read_b128 v[108:111], v9 offset:14336
v_mfma_f32_16x16x32_bf16 v[224:227], v[56:59], v[64:67], v[224:227]
v_mfma_f32_16x16x32_bf16 v[228:231], v[56:59], v[68:71], v[228:231]
v_mfma_f32_16x16x32_bf16 v[232:235], v[56:59], v[72:75], v[232:235]
v_mfma_f32_16x16x32_bf16 v[236:239], v[56:59], v[76:79], v[236:239]
v_mfma_f32_16x16x32_bf16 v[252:255], v[60:63], v[76:79], v[252:255]
v_mfma_f32_16x16x32_bf16 v[248:251], v[60:63], v[72:75], v[248:251]
v_mfma_f32_16x16x32_bf16 v[244:247], v[60:63], v[68:71], v[244:247]
v_mfma_f32_16x16x32_bf16 v[240:243], v[60:63], v[64:67], v[240:243]
s_waitcnt lgkmcnt(0)
v_mfma_f32_16x16x32_bf16 v[128:131], v[80:83], v[112:115], v[128:131]
v_mfma_f32_16x16x32_bf16 v[132:135], v[80:83], v[116:119], v[132:135]
v_mfma_f32_16x16x32_bf16 v[136:139], v[80:83], v[120:123], v[136:139]
v_mfma_f32_16x16x32_bf16 v[140:143], v[80:83], v[124:127], v[140:143]
s_barrier
s_add_u32 m0, s84, 0
s_add_u32 s83, s80, 0
buffer_load_dwordx4 v10, s[8:11], s83 offen nt lds
v_mfma_f32_16x16x32_bf16 v[156:159], v[84:87], v[124:127], v[156:159]
v_mfma_f32_16x16x32_bf16 v[152:155], v[84:87], v[120:123], v[152:155]
s_add_u32 m0, s84, 1024
s_add_u32 s83, s80, 16384
buffer_load_dwordx4 v11, s[8:11], s83 offen nt lds
v_mfma_f32_16x16x32_bf16 v[148:151], v[84:87], v[116:119], v[148:151]
v_mfma_f32_16x16x32_bf16 v[144:147], v[84:87], v[112:115], v[144:147]
v_mfma_f32_16x16x32_bf16 v[160:163], v[88:91], v[112:115], v[160:163]
s_add_u32 m0, s84, 2048
s_add_u32 s83, s80, 32768
buffer_load_dwordx4 v10, s[8:11], s83 offen nt lds
v_mfma_f32_16x16x32_bf16 v[164:167], v[88:91], v[116:119], v[164:167]
v_mfma_f32_16x16x32_bf16 v[168:171], v[88:91], v[120:123], v[168:171]
v_mfma_f32_16x16x32_bf16 v[172:175], v[88:91], v[124:127], v[172:175]
s_add_u32 m0, s84, 3072
s_add_u32 s83, s80, 49152
buffer_load_dwordx4 v11, s[8:11], s83 offen nt lds
v_mfma_f32_16x16x32_bf16 v[188:191], v[92:95], v[124:127], v[188:191]
v_mfma_f32_16x16x32_bf16 v[184:187], v[92:95], v[120:123], v[184:187]
v_mfma_f32_16x16x32_bf16 v[180:183], v[92:95], v[116:119], v[180:183]
s_add_u32 m0, s84, 4096
s_add_u32 s83, s80, 65536
buffer_load_dwordx4 v10, s[8:11], s83 offen nt lds
v_mfma_f32_16x16x32_bf16 v[176:179], v[92:95], v[112:115], v[176:179]
v_mfma_f32_16x16x32_bf16 v[192:195], v[96:99], v[112:115], v[192:195]
v_mfma_f32_16x16x32_bf16 v[196:199], v[96:99], v[116:119], v[196:199]
s_add_u32 m0, s84, 5120
s_add_u32 s83, s80, 81920
buffer_load_dwordx4 v11, s[8:11], s83 offen nt lds
v_mfma_f32_16x16x32_bf16 v[200:203], v[96:99], v[120:123], v[200:203]
v_mfma_f32_16x16x32_bf16 v[204:207], v[96:99], v[124:127], v[204:207]
v_mfma_f32_16x16x32_bf16 v[220:223], v[100:103], v[124:127], v[220:223]
s_add_u32 m0, s84, 6144
s_add_u32 s83, s80, 98304
buffer_load_dwordx4 v10, s[8:11], s83 offen nt lds
v_mfma_f32_16x16x32_bf16 v[216:219], v[100:103], v[120:123], v[216:219]
v_mfma_f32_16x16x32_bf16 v[212:215], v[100:103], v[116:119], v[212:215]
v_mfma_f32_16x16x32_bf16 v[208:211], v[100:103], v[112:115], v[208:211]
s_add_u32 m0, s84, 7168
s_add_u32 s83, s80, 114688
buffer_load_dwordx4 v11, s[8:11], s83 offen nt lds
v_mfma_f32_16x16x32_bf16 v[224:227], v[104:107], v[112:115], v[224:227]
v_mfma_f32_16x16x32_bf16 v[228:231], v[104:107], v[116:119], v[228:231]
v_mfma_f32_16x16x32_bf16 v[232:235], v[104:107], v[120:123], v[232:235]
v_mfma_f32_16x16x32_bf16 v[236:239], v[104:107], v[124:127], v[236:239]
v_mfma_f32_16x16x32_bf16 v[252:255], v[108:111], v[124:127], v[252:255]
v_mfma_f32_16x16x32_bf16 v[248:251], v[108:111], v[120:123], v[248:251]
v_mfma_f32_16x16x32_bf16 v[244:247], v[108:111], v[116:119], v[244:247]
v_mfma_f32_16x16x32_bf16 v[240:243], v[108:111], v[112:115], v[240:243]
s_nop 7
v_fma_f32 v129, v16, v128, v129
v_fma_f32 v133, v16, v132, v133
v_fma_f32 v137, v24, v136, v137
v_fma_f32 v141, v24, v140, v141
v_fma_f32 v129, -v17, v132, v129
v_fma_f32 v133, v17, v128, v133
v_fma_f32 v137, -v25, v140, v137
v_fma_f32 v141, v25, v136, v141
v_fma_f32 v130, v16, v129, v130
v_fma_f32 v134, v16, v133, v134
v_fma_f32 v138, v24, v137, v138
v_fma_f32 v142, v24, v141, v142
v_fma_f32 v130, -v17, v133, v130
v_fma_f32 v134, v17, v129, v134
v_fma_f32 v138, -v25, v141, v138
v_fma_f32 v142, v25, v137, v142
v_fma_f32 v131, v16, v130, v131
v_fma_f32 v135, v16, v134, v135
v_fma_f32 v139, v24, v138, v139
v_fma_f32 v143, v24, v142, v143
v_fma_f32 v131, -v17, v134, v131
v_fma_f32 v135, v17, v130, v135
v_fma_f32 v139, -v25, v142, v139
v_fma_f32 v143, v25, v138, v143
v_fma_f32 v144, v16, v131, v144
v_fma_f32 v148, v16, v135, v148
v_fma_f32 v152, v24, v139, v152
v_fma_f32 v156, v24, v143, v156
v_fma_f32 v144, -v17, v135, v144
v_fma_f32 v148, v17, v131, v148
v_fma_f32 v152, -v25, v143, v152
v_fma_f32 v156, v25, v139, v156
v_fma_f32 v145, v16, v144, v145
v_fma_f32 v149, v16, v148, v149
v_fma_f32 v153, v24, v152, v153
v_fma_f32 v157, v24, v156, v157
v_fma_f32 v145, -v17, v148, v145
v_fma_f32 v149, v17, v144, v149
v_fma_f32 v153, -v25, v156, v153
v_fma_f32 v157, v25, v152, v157
v_fma_f32 v146, v16, v145, v146
v_fma_f32 v150, v16, v149, v150
v_fma_f32 v154, v24, v153, v154
v_fma_f32 v158, v24, v157, v158
v_fma_f32 v146, -v17, v149, v146
v_fma_f32 v150, v17, v145, v150
v_fma_f32 v154, -v25, v157, v154
v_fma_f32 v158, v25, v153, v158
v_fma_f32 v147, v16, v146, v147
v_fma_f32 v151, v16, v150, v151
v_fma_f32 v155, v24, v154, v155
v_fma_f32 v159, v24, v158, v159
v_fma_f32 v147, -v17, v150, v147
v_fma_f32 v151, v17, v146, v151
v_fma_f32 v155, -v25, v158, v155
v_fma_f32 v159, v25, v154, v159
v_fma_f32 v160, v16, v147, v160
v_fma_f32 v164, v16, v151, v164
v_fma_f32 v168, v24, v155, v168
v_fma_f32 v172, v24, v159, v172
v_fma_f32 v160, -v17, v151, v160
v_fma_f32 v164, v17, v147, v164
v_fma_f32 v168, -v25, v159, v168
v_fma_f32 v172, v25, v155, v172
v_fma_f32 v161, v16, v160, v161
v_fma_f32 v165, v16, v164, v165
v_fma_f32 v169, v24, v168, v169
v_fma_f32 v173, v24, v172, v173
v_fma_f32 v161, -v17, v164, v161
v_fma_f32 v165, v17, v160, v165
v_fma_f32 v169, -v25, v172, v169
v_fma_f32 v173, v25, v168, v173
v_fma_f32 v162, v16, v161, v162
v_fma_f32 v166, v16, v165, v166
v_fma_f32 v170, v24, v169, v170
v_fma_f32 v174, v24, v173, v174
v_fma_f32 v162, -v17, v165, v162
v_fma_f32 v166, v17, v161, v166
v_fma_f32 v170, -v25, v173, v170
v_fma_f32 v174, v25, v169, v174
v_fma_f32 v163, v16, v162, v163
v_fma_f32 v167, v16, v166, v167
v_fma_f32 v171, v24, v170, v171
v_fma_f32 v175, v24, v174, v175
v_fma_f32 v163, -v17, v166, v163
v_fma_f32 v167, v17, v162, v167
v_fma_f32 v171, -v25, v174, v171
v_fma_f32 v175, v25, v170, v175
v_fma_f32 v176, v16, v163, v176
v_fma_f32 v180, v16, v167, v180
v_fma_f32 v184, v24, v171, v184
v_fma_f32 v188, v24, v175, v188
v_fma_f32 v176, -v17, v167, v176
v_fma_f32 v180, v17, v163, v180
v_fma_f32 v184, -v25, v175, v184
v_fma_f32 v188, v25, v171, v188
v_fma_f32 v177, v16, v176, v177
v_fma_f32 v181, v16, v180, v181
v_fma_f32 v185, v24, v184, v185
v_fma_f32 v189, v24, v188, v189
v_fma_f32 v177, -v17, v180, v177
v_fma_f32 v181, v17, v176, v181
v_fma_f32 v185, -v25, v188, v185
v_fma_f32 v189, v25, v184, v189
v_fma_f32 v178, v16, v177, v178
v_fma_f32 v182, v16, v181, v182
v_fma_f32 v186, v24, v185, v186
v_fma_f32 v190, v24, v189, v190
v_fma_f32 v178, -v17, v181, v178
v_fma_f32 v182, v17, v177, v182
v_fma_f32 v186, -v25, v189, v186
v_fma_f32 v190, v25, v185, v190
v_fma_f32 v179, v16, v178, v179
v_fma_f32 v183, v16, v182, v183
v_fma_f32 v187, v24, v186, v187
v_fma_f32 v191, v24, v190, v191
v_fma_f32 v179, -v17, v182, v179
v_fma_f32 v183, v17, v178, v183
v_fma_f32 v187, -v25, v190, v187
v_fma_f32 v191, v25, v186, v191
v_fma_f32 v192, v16, v179, v192
v_fma_f32 v196, v16, v183, v196
v_fma_f32 v200, v24, v187, v200
v_fma_f32 v204, v24, v191, v204
v_fma_f32 v192, -v17, v183, v192
v_fma_f32 v196, v17, v179, v196
v_fma_f32 v200, -v25, v191, v200
v_fma_f32 v204, v25, v187, v204
v_fma_f32 v193, v16, v192, v193
v_fma_f32 v197, v16, v196, v197
v_fma_f32 v201, v24, v200, v201
v_fma_f32 v205, v24, v204, v205
v_fma_f32 v193, -v17, v196, v193
v_fma_f32 v197, v17, v192, v197
v_fma_f32 v201, -v25, v204, v201
v_fma_f32 v205, v25, v200, v205
v_fma_f32 v194, v16, v193, v194
v_fma_f32 v198, v16, v197, v198
v_fma_f32 v202, v24, v201, v202
v_fma_f32 v206, v24, v205, v206
v_fma_f32 v194, -v17, v197, v194
v_fma_f32 v198, v17, v193, v198
v_fma_f32 v202, -v25, v205, v202
v_fma_f32 v206, v25, v201, v206
v_fma_f32 v195, v16, v194, v195
v_fma_f32 v199, v16, v198, v199
v_fma_f32 v203, v24, v202, v203
v_fma_f32 v207, v24, v206, v207
v_fma_f32 v195, -v17, v198, v195
v_fma_f32 v199, v17, v194, v199
v_fma_f32 v203, -v25, v206, v203
v_fma_f32 v207, v25, v202, v207
v_fma_f32 v208, v16, v195, v208
v_fma_f32 v212, v16, v199, v212
v_fma_f32 v216, v24, v203, v216
v_fma_f32 v220, v24, v207, v220
v_fma_f32 v208, -v17, v199, v208
v_fma_f32 v212, v17, v195, v212
v_fma_f32 v216, -v25, v207, v216
v_fma_f32 v220, v25, v203, v220
v_fma_f32 v209, v16, v208, v209
v_fma_f32 v213, v16, v212, v213
v_fma_f32 v217, v24, v216, v217
v_fma_f32 v221, v24, v220, v221
v_fma_f32 v209, -v17, v212, v209
v_fma_f32 v213, v17, v208, v213
v_fma_f32 v217, -v25, v220, v217
v_fma_f32 v221, v25, v216, v221
v_fma_f32 v210, v16, v209, v210
v_fma_f32 v214, v16, v213, v214
v_fma_f32 v218, v24, v217, v218
v_fma_f32 v222, v24, v221, v222
v_fma_f32 v210, -v17, v213, v210
v_fma_f32 v214, v17, v209, v214
v_fma_f32 v218, -v25, v221, v218
v_fma_f32 v222, v25, v217, v222
v_fma_f32 v211, v16, v210, v211
v_fma_f32 v215, v16, v214, v215
v_fma_f32 v219, v24, v218, v219
v_fma_f32 v223, v24, v222, v223
v_fma_f32 v211, -v17, v214, v211
v_fma_f32 v215, v17, v210, v215
v_fma_f32 v219, -v25, v222, v219
v_fma_f32 v223, v25, v218, v223
v_fma_f32 v224, v16, v211, v224
v_fma_f32 v228, v16, v215, v228
v_fma_f32 v232, v24, v219, v232
v_fma_f32 v236, v24, v223, v236
v_fma_f32 v224, -v17, v215, v224
v_fma_f32 v228, v17, v211, v228
v_fma_f32 v232, -v25, v223, v232
v_fma_f32 v236, v25, v219, v236
v_fma_f32 v225, v16, v224, v225
v_fma_f32 v229, v16, v228, v229
v_fma_f32 v233, v24, v232, v233
v_fma_f32 v237, v24, v236, v237
v_fma_f32 v225, -v17, v228, v225
v_fma_f32 v229, v17, v224, v229
v_fma_f32 v233, -v25, v236, v233
v_fma_f32 v237, v25, v232, v237
v_fma_f32 v226, v16, v225, v226
v_fma_f32 v230, v16, v229, v230
v_fma_f32 v234, v24, v233, v234
v_fma_f32 v238, v24, v237, v238
v_fma_f32 v226, -v17, v229, v226
v_fma_f32 v230, v17, v225, v230
v_fma_f32 v234, -v25, v237, v234
v_fma_f32 v238, v25, v233, v238
v_fma_f32 v227, v16, v226, v227
v_fma_f32 v231, v16, v230, v231
v_fma_f32 v235, v24, v234, v235
v_fma_f32 v239, v24, v238, v239
v_fma_f32 v227, -v17, v230, v227
v_fma_f32 v231, v17, v226, v231
v_fma_f32 v235, -v25, v238, v235
v_fma_f32 v239, v25, v234, v239
v_fma_f32 v240, v16, v227, v240
v_fma_f32 v244, v16, v231, v244
v_fma_f32 v248, v24, v235, v248
v_fma_f32 v252, v24, v239, v252
v_fma_f32 v240, -v17, v231, v240
v_fma_f32 v244, v17, v227, v244
v_fma_f32 v248, -v25, v239, v248
v_fma_f32 v252, v25, v235, v252
v_fma_f32 v241, v16, v240, v241
v_fma_f32 v245, v16, v244, v245
v_fma_f32 v249, v24, v248, v249
v_fma_f32 v253, v24, v252, v253
v_fma_f32 v241, -v17, v244, v241
v_fma_f32 v245, v17, v240, v245
v_fma_f32 v249, -v25, v252, v249
v_fma_f32 v253, v25, v248, v253
v_fma_f32 v242, v16, v241, v242
v_fma_f32 v246, v16, v245, v246
v_fma_f32 v250, v24, v249, v250
v_fma_f32 v254, v24, v253, v254
v_fma_f32 v242, -v17, v245, v242
v_fma_f32 v246, v17, v241, v246
v_fma_f32 v250, -v25, v253, v250
v_fma_f32 v254, v25, v249, v254
v_fma_f32 v243, v16, v242, v243
v_fma_f32 v247, v16, v246, v247
v_fma_f32 v251, v24, v250, v251
v_fma_f32 v255, v24, v254, v255
v_fma_f32 v243, -v17, v246, v243
v_fma_f32 v247, v17, v242, v247
v_fma_f32 v251, -v25, v254, v251
v_fma_f32 v255, v25, v250, v255
v_and_b32 v2, 15, v1
v_lshlrev_b32 v2, 2, v2
v_lshrrev_b32 v3, 4, v1
ds_bpermute_b32 v40, v2, v243 offset:0
ds_bpermute_b32 v41, v2, v247 offset:0
ds_bpermute_b32 v42, v2, v243 offset:64
ds_bpermute_b32 v43, v2, v247 offset:64
ds_bpermute_b32 v44, v2, v243 offset:128
ds_bpermute_b32 v45, v2, v247 offset:128
ds_bpermute_b32 v46, v2, v243 offset:192
ds_bpermute_b32 v47, v2, v247 offset:192
ds_bpermute_b32 v48, v2, v251 offset:0
ds_bpermute_b32 v49, v2, v255 offset:0
ds_bpermute_b32 v50, v2, v251 offset:64
ds_bpermute_b32 v51, v2, v255 offset:64
ds_bpermute_b32 v52, v2, v251 offset:128
ds_bpermute_b32 v53, v2, v255 offset:128
ds_bpermute_b32 v54, v2, v251 offset:192
ds_bpermute_b32 v55, v2, v255 offset:192
v_mul_f32 v56, v20, v20
v_mul_f32 v57, v20, v21
v_fma_f32 v56, -v21, v21, v56
v_fma_f32 v57, v21, v20, v57
v_mul_f32 v58, v56, v20
v_mul_f32 v59, v56, v21
v_fma_f32 v58, -v57, v21, v58
v_fma_f32 v59, v57, v20, v59
v_mul_f32 v60, v28, v28
v_mul_f32 v61, v28, v29
v_fma_f32 v60, -v29, v29, v60
v_fma_f32 v61, v29, v28, v61
v_mul_f32 v62, v60, v28
v_mul_f32 v63, v60, v29
v_fma_f32 v62, -v61, v29, v62
v_fma_f32 v63, v61, v28, v63
v_lshlrev_b32 v8, 2, v2
s_lshl_b32 s70, s39, 1
s_add_u32 s70, s70, s60
s_lshl_b32 s71, s62, 3
s_add_u32 s71, s71, 25231360
s_lshl_b32 s72, s70, 13
s_add_u32 s72, s72, s71
v_mov_b32 v4, 0x7fc00000
s_waitcnt lgkmcnt(0)
v_fma_f32 v42, v20, v40, v42
v_fma_f32 v43, v20, v41, v43
v_fma_f32 v42, -v21, v41, v42
v_fma_f32 v43, v21, v40, v43
v_fma_f32 v44, v20, v42, v44
v_fma_f32 v45, v20, v43, v45
v_fma_f32 v44, -v21, v43, v44
v_fma_f32 v45, v21, v42, v45
v_fma_f32 v46, v20, v44, v46
v_fma_f32 v47, v20, v45, v47
v_fma_f32 v46, -v21, v45, v46
v_fma_f32 v47, v21, v44, v47
v_fma_f32 v50, v28, v48, v50
v_fma_f32 v51, v28, v49, v51
v_fma_f32 v50, -v29, v49, v50
v_fma_f32 v51, v29, v48, v51
v_fma_f32 v52, v28, v50, v52
v_fma_f32 v53, v28, v51, v53
v_fma_f32 v52, -v29, v51, v52
v_fma_f32 v53, v29, v50, v53
v_fma_f32 v54, v28, v52, v54
v_fma_f32 v55, v28, v53, v55
v_fma_f32 v54, -v29, v53, v54
v_fma_f32 v55, v29, v52, v55
v_cmp_eq_u32 vcc, -1, v46
s_nop 1
v_cndmask_b32 v76, v46, v4, vcc
v_cmp_eq_u32 vcc, -1, v47
s_nop 1
v_cndmask_b32 v77, v47, v4, vcc
v_cmp_eq_u32 vcc, -1, v54
s_nop 1
v_cndmask_b32 v78, v54, v4, vcc
v_cmp_eq_u32 vcc, -1, v55
s_nop 1
v_cndmask_b32 v79, v55, v4, vcc
s_mov_b64 s[74:75], exec
s_mov_b64 exec, 0xffff
buffer_store_dwordx4 v[76:79], v8, s[24:27], s72 offen sc1
s_mov_b64 exec, s[74:75]
s_sub_u32 s72, s70, 1
v_sub_u32 v4, s72, v3
v_lshlrev_b32 v4, 13, v4
v_add_u32 v4, v4, v8
v_mov_b32 v5, 0x40000000
v_subrev_u32 v6, 0, v4
v_cmp_gt_i32 vcc, 0, v6
s_nop 1
v_cndmask_b32 v10, v6, v5, vcc
v_subrev_u32 v6, 32768, v4
v_cmp_gt_i32 vcc, 0, v6
s_nop 1
v_cndmask_b32 v11, v6, v5, vcc
v_subrev_u32 v6, 65536, v4
v_cmp_gt_i32 vcc, 0, v6
s_nop 1
v_cndmask_b32 v12, v6, v5, vcc
v_subrev_u32 v6, 98304, v4
v_cmp_gt_i32 vcc, 0, v6
s_nop 1
v_cndmask_b32 v13, v6, v5, vcc
buffer_load_dwordx4 v[96:99], v10, s[24:27], s71 offen sc1
buffer_load_dwordx4 v[100:103], v11, s[24:27], s71 offen sc1
buffer_load_dwordx4 v[104:107], v12, s[24:27], s71 offen sc1
buffer_load_dwordx4 v[108:111], v13, s[24:27], s71 offen sc1
v_mov_b32 v32, 0
v_mov_b32 v33, 0
v_mov_b32 v34, 0
v_mov_b32 v35, 0
v_mov_b32 v36, 1.0
v_mov_b32 v37, 0
v_mov_b32 v38, 1.0
v_mov_b32 v39, 0
v_mul_f32 v64, v22, v22
v_mul_f32 v65, v22, v23
v_fma_f32 v64, -v23, v23, v64
v_fma_f32 v65, v23, v22, v65
v_mul_f32 v68, v64, v22
v_mul_f32 v69, v64, v23
v_fma_f32 v68, -v65, v23, v68
v_fma_f32 v69, v65, v22, v69
v_mul_f32 v72, v64, v64
v_mul_f32 v73, v64, v65
v_fma_f32 v72, -v65, v65, v72
v_fma_f32 v73, v65, v64, v73
v_mul_f32 v66, v30, v30
v_mul_f32 v67, v30, v31
v_fma_f32 v66, -v31, v31, v66
v_fma_f32 v67, v31, v30, v67
v_mul_f32 v70, v66, v30
v_mul_f32 v71, v66, v31
v_fma_f32 v70, -v67, v31, v70
v_fma_f32 v71, v67, v30, v71
v_mul_f32 v74, v66, v66
v_mul_f32 v75, v66, v67
v_fma_f32 v74, -v67, v67, v74
v_fma_f32 v75, v67, v66, v75
v_mov_b32 v88, 1.0
v_mov_b32 v89, 0
v_mov_b32 v90, 1.0
v_mov_b32 v91, 0
v_cmp_eq_u32 vcc, 1, v3
s_nop 1
v_cndmask_b32 v32, v32, v40, vcc
v_cndmask_b32 v33, v33, v41, vcc
v_cndmask_b32 v36, v36, v20, vcc
v_cndmask_b32 v37, v37, v21, vcc
v_cndmask_b32 v88, v88, v22, vcc
v_cndmask_b32 v89, v89, v23, vcc
v_cndmask_b32 v34, v34, v48, vcc
v_cndmask_b32 v35, v35, v49, vcc
v_cndmask_b32 v38, v38, v28, vcc
v_cndmask_b32 v39, v39, v29, vcc
v_cndmask_b32 v90, v90, v30, vcc
v_cndmask_b32 v91, v91, v31, vcc
v_cmp_eq_u32 vcc, 2, v3
s_nop 1
v_cndmask_b32 v32, v32, v42, vcc
v_cndmask_b32 v33, v33, v43, vcc
v_cndmask_b32 v36, v36, v56, vcc
v_cndmask_b32 v37, v37, v57, vcc
v_cndmask_b32 v88, v88, v64, vcc
v_cndmask_b32 v89, v89, v65, vcc
v_cndmask_b32 v34, v34, v50, vcc
v_cndmask_b32 v35, v35, v51, vcc
v_cndmask_b32 v38, v38, v60, vcc
v_cndmask_b32 v39, v39, v61, vcc
v_cndmask_b32 v90, v90, v66, vcc
v_cndmask_b32 v91, v91, v67, vcc
v_cmp_eq_u32 vcc, 3, v3
s_nop 1
v_cndmask_b32 v32, v32, v44, vcc
v_cndmask_b32 v33, v33, v45, vcc
v_cndmask_b32 v36, v36, v58, vcc
v_cndmask_b32 v37, v37, v59, vcc
v_cndmask_b32 v88, v88, v68, vcc
v_cndmask_b32 v89, v89, v69, vcc
v_cndmask_b32 v34, v34, v52, vcc
v_cndmask_b32 v35, v35, v53, vcc
v_cndmask_b32 v38, v38, v62, vcc
v_cndmask_b32 v39, v39, v63, vcc
v_cndmask_b32 v90, v90, v70, vcc
v_cndmask_b32 v91, v91, v71, vcc
v_lshlrev_b32 v9, 4, v1
v_xor_b32 v14, 64, v9
s_lshl_b32 s76, s70, 19
s_lshl_b32 s73, s40, 14
s_add_u32 s76, s76, s73
s_lshl_b32 s73, s61, 13
s_add_u32 s76, s76, s73
s_add_u32 s76, s76, 8388608
s_add_u32 s77, s76, 262144
s_add_u32 s78, s76, 4096
s_add_u32 s79, s77, 4096
v_mul_f32 v60, v18, v16
v_mul_f32 v61, v18, v17
v_fma_f32 v60, -v19, v17, v60
v_fma_f32 v61, v19, v16, v61
v_mul_f32 v62, v60, v16
v_mul_f32 v63, v60, v17
v_fma_f32 v62, -v61, v17, v62
v_fma_f32 v63, v61, v16, v63
v_mul_f32 v20, v16, v16
v_mul_f32 v21, v16, v17
v_fma_f32 v20, -v17, v17, v20
v_fma_f32 v21, v17, v16, v21
v_mul_f32 v44, v60, v32
v_mul_f32 v46, v60, v33
v_fma_f32 v44, -v61, v33, v44
v_fma_f32 v46, v61, v32, v46
v_mul_f32 v48, v60, v36
v_mul_f32 v50, v60, v37
v_fma_f32 v48, -v61, v37, v48
v_fma_f32 v50, v61, v36, v50
v_mul_f32 v45, v62, v32
v_mul_f32 v47, v62, v33
v_fma_f32 v45, -v63, v33, v45
v_fma_f32 v47, v63, v32, v47
v_mul_f32 v49, v62, v36
v_mul_f32 v51, v62, v37
v_fma_f32 v49, -v63, v37, v49
v_fma_f32 v51, v63, v36, v51
v_mul_f32 v60, v26, v24
v_mul_f32 v61, v26, v25
v_fma_f32 v60, -v27, v25, v60
v_fma_f32 v61, v27, v24, v61
v_mul_f32 v62, v60, v24
v_mul_f32 v63, v60, v25
v_fma_f32 v62, -v61, v25, v62
v_fma_f32 v63, v61, v24, v63
v_mul_f32 v28, v24, v24
v_mul_f32 v29, v24, v25
v_fma_f32 v28, -v25, v25, v28
v_fma_f32 v29, v25, v24, v29
v_mul_f32 v52, v60, v34
v_mul_f32 v54, v60, v35
v_fma_f32 v52, -v61, v35, v52
v_fma_f32 v54, v61, v34, v54
v_mul_f32 v56, v60, v38
v_mul_f32 v58, v60, v39
v_fma_f32 v56, -v61, v39, v56
v_fma_f32 v58, v61, v38, v58
v_mul_f32 v53, v62, v34
v_mul_f32 v55, v62, v35
v_fma_f32 v53, -v63, v35, v53
v_fma_f32 v55, v63, v34, v55
v_mul_f32 v57, v62, v38
v_mul_f32 v59, v62, v39
v_fma_f32 v57, -v63, v39, v57
v_fma_f32 v59, v63, v38, v59
v_pk_mul_f32 v[92:93], v[128:129], v[18:19] op_sel:[0,0] op_sel_hi:[1,0]
v_pk_mul_f32 v[94:95], v[136:137], v[26:27] op_sel:[0,0] op_sel_hi:[1,0]
v_pk_fma_f32 v[92:93], v[132:133], v[18:19], v[92:93] op_sel:[0,1,0] op_sel_hi:[1,1,1] neg_lo:[0,1,0] neg_hi:[0,1,0]
v_pk_mul_f32 v[132:133], v[132:133], v[18:19] op_sel:[0,0] op_sel_hi:[1,0] neg_lo:[0,1] neg_hi:[0,1]
v_pk_fma_f32 v[94:95], v[140:141], v[26:27], v[94:95] op_sel:[0,1,0] op_sel_hi:[1,1,1] neg_lo:[0,1,0] neg_hi:[0,1,0]
v_pk_mul_f32 v[140:141], v[140:141], v[26:27] op_sel:[0,0] op_sel_hi:[1,0] neg_lo:[0,1] neg_hi:[0,1]
v_pk_fma_f32 v[132:133], v[128:129], v[18:19], v[132:133] op_sel:[0,1,0] op_sel_hi:[1,1,1] neg_lo:[0,1,0] neg_hi:[0,1,0]
v_pk_fma_f32 v[140:141], v[136:137], v[26:27], v[140:141] op_sel:[0,1,0] op_sel_hi:[1,1,1] neg_lo:[0,1,0] neg_hi:[0,1,0]
v_pk_mul_f32 v[128:129], v[130:131], v[18:19] op_sel:[0,0] op_sel_hi:[1,0]
v_pk_mul_f32 v[136:137], v[138:139], v[26:27] op_sel:[0,0] op_sel_hi:[1,0]
v_pk_fma_f32 v[128:129], v[134:135], v[18:19], v[128:129] op_sel:[0,1,0] op_sel_hi:[1,1,1] neg_lo:[0,1,0] neg_hi:[0,1,0]
v_pk_mul_f32 v[134:135], v[134:135], v[18:19] op_sel:[0,0] op_sel_hi:[1,0] neg_lo:[0,1] neg_hi:[0,1]
v_pk_fma_f32 v[136:137], v[142:143], v[26:27], v[136:137] op_sel:[0,1,0] op_sel_hi:[1,1,1] neg_lo:[0,1,0] neg_hi:[0,1,0]
v_pk_mul_f32 v[142:143], v[142:143], v[26:27] op_sel:[0,0] op_sel_hi:[1,0] neg_lo:[0,1] neg_hi:[0,1]
v_pk_fma_f32 v[134:135], v[130:131], v[18:19], v[134:135] op_sel:[0,1,0] op_sel_hi:[1,1,1] neg_lo:[0,1,0] neg_hi:[0,1,0]
v_pk_fma_f32 v[142:143], v[138:139], v[26:27], v[142:143] op_sel:[0,1,0] op_sel_hi:[1,1,1] neg_lo:[0,1,0] neg_hi:[0,1,0]
v_pk_mul_f32 v[130:131], v[144:145], v[18:19] op_sel:[0,0] op_sel_hi:[1,0]
v_pk_mul_f32 v[138:139], v[152:153], v[26:27] op_sel:[0,0] op_sel_hi:[1,0]
v_pk_fma_f32 v[130:131], v[148:149], v[18:19], v[130:131] op_sel:[0,1,0] op_sel_hi:[1,1,1] neg_lo:[0,1,0] neg_hi:[0,1,0]
v_pk_mul_f32 v[148:149], v[148:149], v[18:19] op_sel:[0,0] op_sel_hi:[1,0] neg_lo:[0,1] neg_hi:[0,1]
v_pk_fma_f32 v[138:139], v[156:157], v[26:27], v[138:139] op_sel:[0,1,0] op_sel_hi:[1,1,1] neg_lo:[0,1,0] neg_hi:[0,1,0]
v_pk_mul_f32 v[156:157], v[156:157], v[26:27] op_sel:[0,0] op_sel_hi:[1,0] neg_lo:[0,1] neg_hi:[0,1]
v_pk_fma_f32 v[148:149], v[144:145], v[18:19], v[148:149] op_sel:[0,1,0] op_sel_hi:[1,1,1] neg_lo:[0,1,0] neg_hi:[0,1,0]
v_pk_fma_f32 v[156:157], v[152:153], v[26:27], v[156:157] op_sel:[0,1,0] op_sel_hi:[1,1,1] neg_lo:[0,1,0] neg_hi:[0,1,0]
v_pk_mul_f32 v[144:145], v[146:147], v[18:19] op_sel:[0,0] op_sel_hi:[1,0]
v_pk_mul_f32 v[152:153], v[154:155], v[26:27] op_sel:[0,0] op_sel_hi:[1,0]
v_pk_fma_f32 v[144:145], v[150:151], v[18:19], v[144:145] op_sel:[0,1,0] op_sel_hi:[1,1,1] neg_lo:[0,1,0] neg_hi:[0,1,0]
v_pk_mul_f32 v[150:151], v[150:151], v[18:19] op_sel:[0,0] op_sel_hi:[1,0] neg_lo:[0,1] neg_hi:[0,1]
v_pk_fma_f32 v[152:153], v[158:159], v[26:27], v[152:153] op_sel:[0,1,0] op_sel_hi:[1,1,1] neg_lo:[0,1,0] neg_hi:[0,1,0]
v_pk_mul_f32 v[158:159], v[158:159], v[26:27] op_sel:[0,0] op_sel_hi:[1,0] neg_lo:[0,1] neg_hi:[0,1]
v_pk_fma_f32 v[150:151], v[146:147], v[18:19], v[150:151] op_sel:[0,1,0] op_sel_hi:[1,1,1] neg_lo:[0,1,0] neg_hi:[0,1,0]
v_pk_fma_f32 v[158:159], v[154:155], v[26:27], v[158:159] op_sel:[0,1,0] op_sel_hi:[1,1,1] neg_lo:[0,1,0] neg_hi:[0,1,0]
v_pk_mul_f32 v[146:147], v[160:161], v[18:19] op_sel:[0,0] op_sel_hi:[1,0]
v_pk_mul_f32 v[154:155], v[168:169], v[26:27] op_sel:[0,0] op_sel_hi:[1,0]
v_pk_fma_f32 v[146:147], v[164:165], v[18:19], v[146:147] op_sel:[0,1,0] op_sel_hi:[1,1,1] neg_lo:[0,1,0] neg_hi:[0,1,0]
v_pk_mul_f32 v[164:165], v[164:165], v[18:19] op_sel:[0,0] op_sel_hi:[1,0] neg_lo:[0,1] neg_hi:[0,1]
v_pk_fma_f32 v[154:155], v[172:173], v[26:27], v[154:155] op_sel:[0,1,0] op_sel_hi:[1,1,1] neg_lo:[0,1,0] neg_hi:[0,1,0]
v_pk_mul_f32 v[172:173], v[172:173], v[26:27] op_sel:[0,0] op_sel_hi:[1,0] neg_lo:[0,1] neg_hi:[0,1]
v_pk_fma_f32 v[164:165], v[160:161], v[18:19], v[164:165] op_sel:[0,1,0] op_sel_hi:[1,1,1] neg_lo:[0,1,0] neg_hi:[0,1,0]
v_pk_fma_f32 v[172:173], v[168:169], v[26:27], v[172:173] op_sel:[0,1,0] op_sel_hi:[1,1,1] neg_lo:[0,1,0] neg_hi:[0,1,0]
v_pk_mul_f32 v[160:161], v[162:163], v[18:19] op_sel:[0,0] op_sel_hi:[1,0]
v_pk_mul_f32 v[168:169], v[170:171], v[26:27] op_sel:[0,0] op_sel_hi:[1,0]
v_pk_fma_f32 v[160:161], v[166:167], v[18:19], v[160:161] op_sel:[0,1,0] op_sel_hi:[1,1,1] neg_lo:[0,1,0] neg_hi:[0,1,0]
v_pk_mul_f32 v[166:167], v[166:167], v[18:19] op_sel:[0,0] op_sel_hi:[1,0] neg_lo:[0,1] neg_hi:[0,1]
v_pk_fma_f32 v[168:169], v[174:175], v[26:27], v[168:169] op_sel:[0,1,0] op_sel_hi:[1,1,1] neg_lo:[0,1,0] neg_hi:[0,1,0]
v_pk_mul_f32 v[174:175], v[174:175], v[26:27] op_sel:[0,0] op_sel_hi:[1,0] neg_lo:[0,1] neg_hi:[0,1]
v_pk_fma_f32 v[166:167], v[162:163], v[18:19], v[166:167] op_sel:[0,1,0] op_sel_hi:[1,1,1] neg_lo:[0,1,0] neg_hi:[0,1,0]
v_pk_fma_f32 v[174:175], v[170:171], v[26:27], v[174:175] op_sel:[0,1,0] op_sel_hi:[1,1,1] neg_lo:[0,1,0] neg_hi:[0,1,0]
v_pk_mul_f32 v[162:163], v[176:177], v[18:19] op_sel:[0,0] op_sel_hi:[1,0]
v_pk_mul_f32 v[170:171], v[184:185], v[26:27] op_sel:[0,0] op_sel_hi:[1,0]
v_pk_fma_f32 v[162:163], v[180:181], v[18:19], v[162:163] op_sel:[0,1,0] op_sel_hi:[1,1,1] neg_lo:[0,1,0] neg_hi:[0,1,0]
v_pk_mul_f32 v[180:181], v[180:181], v[18:19] op_sel:[0,0] op_sel_hi:[1,0] neg_lo:[0,1] neg_hi:[0,1]
v_pk_fma_f32 v[170:171], v[188:189], v[26:27], v[170:171] op_sel:[0,1,0] op_sel_hi:[1,1,1] neg_lo:[0,1,0] neg_hi:[0,1,0]
v_pk_mul_f32 v[188:189], v[188:189], v[26:27] op_sel:[0,0] op_sel_hi:[1,0] neg_lo:[0,1] neg_hi:[0,1]
v_pk_fma_f32 v[180:181], v[176:177], v[18:19], v[180:181] op_sel:[0,1,0] op_sel_hi:[1,1,1] neg_lo:[0,1,0] neg_hi:[0,1,0]
v_pk_fma_f32 v[188:189], v[184:185], v[26:27], v[188:189] op_sel:[0,1,0] op_sel_hi:[1,1,1] neg_lo:[0,1,0] neg_hi:[0,1,0]
v_pk_mul_f32 v[176:177], v[178:179], v[18:19] op_sel:[0,0] op_sel_hi:[1,0]
v_pk_mul_f32 v[184:185], v[186:187], v[26:27] op_sel:[0,0] op_sel_hi:[1,0]
v_pk_fma_f32 v[176:177], v[182:183], v[18:19], v[176:177] op_sel:[0,1,0] op_sel_hi:[1,1,1] neg_lo:[0,1,0] neg_hi:[0,1,0]
v_pk_mul_f32 v[182:183], v[182:183], v[18:19] op_sel:[0,0] op_sel_hi:[1,0] neg_lo:[0,1] neg_hi:[0,1]
v_pk_fma_f32 v[184:185], v[190:191], v[26:27], v[184:185] op_sel:[0,1,0] op_sel_hi:[1,1,1] neg_lo:[0,1,0] neg_hi:[0,1,0]
v_pk_mul_f32 v[190:191], v[190:191], v[26:27] op_sel:[0,0] op_sel_hi:[1,0] neg_lo:[0,1] neg_hi:[0,1]
v_pk_fma_f32 v[182:183], v[178:179], v[18:19], v[182:183] op_sel:[0,1,0] op_sel_hi:[1,1,1] neg_lo:[0,1,0] neg_hi:[0,1,0]
v_pk_fma_f32 v[190:191], v[186:187], v[26:27], v[190:191] op_sel:[0,1,0] op_sel_hi:[1,1,1] neg_lo:[0,1,0] neg_hi:[0,1,0]
buffer_load_dwordx4 v[112:115], v10, s[24:27], s71 offen sc1
buffer_load_dwordx4 v[116:119], v11, s[24:27], s71 offen sc1
buffer_load_dwordx4 v[120:123], v12, s[24:27], s71 offen sc1
buffer_load_dwordx4 v[124:127], v13, s[24:27], s71 offen sc1
v_pk_mul_f32 v[178:179], v[192:193], v[18:19] op_sel:[0,0] op_sel_hi:[1,0]
v_pk_mul_f32 v[186:187], v[200:201], v[26:27] op_sel:[0,0] op_sel_hi:[1,0]
v_pk_fma_f32 v[178:179], v[196:197], v[18:19], v[178:179] op_sel:[0,1,0] op_sel_hi:[1,1,1] neg_lo:[0,1,0] neg_hi:[0,1,0]
v_pk_mul_f32 v[196:197], v[196:197], v[18:19] op_sel:[0,0] op_sel_hi:[1,0] neg_lo:[0,1] neg_hi:[0,1]
v_pk_fma_f32 v[186:187], v[204:205], v[26:27], v[186:187] op_sel:[0,1,0] op_sel_hi:[1,1,1] neg_lo:[0,1,0] neg_hi:[0,1,0]
v_pk_mul_f32 v[204:205], v[204:205], v[26:27] op_sel:[0,0] op_sel_hi:[1,0] neg_lo:[0,1] neg_hi:[0,1]
v_pk_fma_f32 v[196:197], v[192:193], v[18:19], v[196:197] op_sel:[0,1,0] op_sel_hi:[1,1,1] neg_lo:[0,1,0] neg_hi:[0,1,0]
v_pk_fma_f32 v[204:205], v[200:201], v[26:27], v[204:205] op_sel:[0,1,0] op_sel_hi:[1,1,1] neg_lo:[0,1,0] neg_hi:[0,1,0]
v_pk_mul_f32 v[192:193], v[194:195], v[18:19] op_sel:[0,0] op_sel_hi:[1,0]
v_pk_mul_f32 v[200:201], v[202:203], v[26:27] op_sel:[0,0] op_sel_hi:[1,0]
v_pk_fma_f32 v[192:193], v[198:199], v[18:19], v[192:193] op_sel:[0,1,0] op_sel_hi:[1,1,1] neg_lo:[0,1,0] neg_hi:[0,1,0]
v_pk_mul_f32 v[198:199], v[198:199], v[18:19] op_sel:[0,0] op_sel_hi:[1,0] neg_lo:[0,1] neg_hi:[0,1]
v_pk_fma_f32 v[200:201], v[206:207], v[26:27], v[200:201] op_sel:[0,1,0] op_sel_hi:[1,1,1] neg_lo:[0,1,0] neg_hi:[0,1,0]
v_pk_mul_f32 v[206:207], v[206:207], v[26:27] op_sel:[0,0] op_sel_hi:[1,0] neg_lo:[0,1] neg_hi:[0,1]
v_pk_fma_f32 v[198:199], v[194:195], v[18:19], v[198:199] op_sel:[0,1,0] op_sel_hi:[1,1,1] neg_lo:[0,1,0] neg_hi:[0,1,0]
v_pk_fma_f32 v[206:207], v[202:203], v[26:27], v[206:207] op_sel:[0,1,0] op_sel_hi:[1,1,1] neg_lo:[0,1,0] neg_hi:[0,1,0]
v_pk_mul_f32 v[194:195], v[208:209], v[18:19] op_sel:[0,0] op_sel_hi:[1,0]
v_pk_mul_f32 v[202:203], v[216:217], v[26:27] op_sel:[0,0] op_sel_hi:[1,0]
v_pk_fma_f32 v[194:195], v[212:213], v[18:19], v[194:195] op_sel:[0,1,0] op_sel_hi:[1,1,1] neg_lo:[0,1,0] neg_hi:[0,1,0]
v_pk_mul_f32 v[212:213], v[212:213], v[18:19] op_sel:[0,0] op_sel_hi:[1,0] neg_lo:[0,1] neg_hi:[0,1]
v_pk_fma_f32 v[202:203], v[220:221], v[26:27], v[202:203] op_sel:[0,1,0] op_sel_hi:[1,1,1] neg_lo:[0,1,0] neg_hi:[0,1,0]
v_pk_mul_f32 v[220:221], v[220:221], v[26:27] op_sel:[0,0] op_sel_hi:[1,0] neg_lo:[0,1] neg_hi:[0,1]
v_pk_fma_f32 v[212:213], v[208:209], v[18:19], v[212:213] op_sel:[0,1,0] op_sel_hi:[1,1,1] neg_lo:[0,1,0] neg_hi:[0,1,0]
v_pk_fma_f32 v[220:221], v[216:217], v[26:27], v[220:221] op_sel:[0,1,0] op_sel_hi:[1,1,1] neg_lo:[0,1,0] neg_hi:[0,1,0]
v_pk_mul_f32 v[208:209], v[210:211], v[18:19] op_sel:[0,0] op_sel_hi:[1,0]
v_pk_mul_f32 v[216:217], v[218:219], v[26:27] op_sel:[0,0] op_sel_hi:[1,0]
v_pk_fma_f32 v[208:209], v[214:215], v[18:19], v[208:209] op_sel:[0,1,0] op_sel_hi:[1,1,1] neg_lo:[0,1,0] neg_hi:[0,1,0]
v_pk_mul_f32 v[214:215], v[214:215], v[18:19] op_sel:[0,0] op_sel_hi:[1,0] neg_lo:[0,1] neg_hi:[0,1]
v_pk_fma_f32 v[216:217], v[222:223], v[26:27], v[216:217] op_sel:[0,1,0] op_sel_hi:[1,1,1] neg_lo:[0,1,0] neg_hi:[0,1,0]
v_pk_mul_f32 v[222:223], v[222:223], v[26:27] op_sel:[0,0] op_sel_hi:[1,0] neg_lo:[0,1] neg_hi:[0,1]
v_pk_fma_f32 v[214:215], v[210:211], v[18:19], v[214:215] op_sel:[0,1,0] op_sel_hi:[1,1,1] neg_lo:[0,1,0] neg_hi:[0,1,0]
v_pk_fma_f32 v[222:223], v[218:219], v[26:27], v[222:223] op_sel:[0,1,0] op_sel_hi:[1,1,1] neg_lo:[0,1,0] neg_hi:[0,1,0]
v_pk_mul_f32 v[210:211], v[224:225], v[18:19] op_sel:[0,0] op_sel_hi:[1,0]
v_pk_mul_f32 v[218:219], v[232:233], v[26:27] op_sel:[0,0] op_sel_hi:[1,0]
v_pk_fma_f32 v[210:211], v[228:229], v[18:19], v[210:211] op_sel:[0,1,0] op_sel_hi:[1,1,1] neg_lo:[0,1,0] neg_hi:[0,1,0]
v_pk_mul_f32 v[228:229], v[228:229], v[18:19] op_sel:[0,0] op_sel_hi:[1,0] neg_lo:[0,1] neg_hi:[0,1]
v_pk_fma_f32 v[218:219], v[236:237], v[26:27], v[218:219] op_sel:[0,1,0] op_sel_hi:[1,1,1] neg_lo:[0,1,0] neg_hi:[0,1,0]
v_pk_mul_f32 v[236:237], v[236:237], v[26:27] op_sel:[0,0] op_sel_hi:[1,0] neg_lo:[0,1] neg_hi:[0,1]
v_pk_fma_f32 v[228:229], v[224:225], v[18:19], v[228:229] op_sel:[0,1,0] op_sel_hi:[1,1,1] neg_lo:[0,1,0] neg_hi:[0,1,0]
v_pk_fma_f32 v[236:237], v[232:233], v[26:27], v[236:237] op_sel:[0,1,0] op_sel_hi:[1,1,1] neg_lo:[0,1,0] neg_hi:[0,1,0]
v_pk_mul_f32 v[224:225], v[226:227], v[18:19] op_sel:[0,0] op_sel_hi:[1,0]
v_pk_mul_f32 v[232:233], v[234:235], v[26:27] op_sel:[0,0] op_sel_hi:[1,0]
v_pk_fma_f32 v[224:225], v[230:231], v[18:19], v[224:225] op_sel:[0,1,0] op_sel_hi:[1,1,1] neg_lo:[0,1,0] neg_hi:[0,1,0]
v_pk_mul_f32 v[230:231], v[230:231], v[18:19] op_sel:[0,0] op_sel_hi:[1,0] neg_lo:[0,1] neg_hi:[0,1]
v_pk_fma_f32 v[232:233], v[238:239], v[26:27], v[232:233] op_sel:[0,1,0] op_sel_hi:[1,1,1] neg_lo:[0,1,0] neg_hi:[0,1,0]
v_pk_mul_f32 v[238:239], v[238:239], v[26:27] op_sel:[0,0] op_sel_hi:[1,0] neg_lo:[0,1] neg_hi:[0,1]
v_pk_fma_f32 v[230:231], v[226:227], v[18:19], v[230:231] op_sel:[0,1,0] op_sel_hi:[1,1,1] neg_lo:[0,1,0] neg_hi:[0,1,0]
v_pk_fma_f32 v[238:239], v[234:235], v[26:27], v[238:239] op_sel:[0,1,0] op_sel_hi:[1,1,1] neg_lo:[0,1,0] neg_hi:[0,1,0]
v_pk_mul_f32 v[226:227], v[240:241], v[18:19] op_sel:[0,0] op_sel_hi:[1,0]
v_pk_mul_f32 v[234:235], v[248:249], v[26:27] op_sel:[0,0] op_sel_hi:[1,0]
v_pk_fma_f32 v[226:227], v[244:245], v[18:19], v[226:227] op_sel:[0,1,0] op_sel_hi:[1,1,1] neg_lo:[0,1,0] neg_hi:[0,1,0]
v_pk_mul_f32 v[244:245], v[244:245], v[18:19] op_sel:[0,0] op_sel_hi:[1,0] neg_lo:[0,1] neg_hi:[0,1]
v_pk_fma_f32 v[234:235], v[252:253], v[26:27], v[234:235] op_sel:[0,1,0] op_sel_hi:[1,1,1] neg_lo:[0,1,0] neg_hi:[0,1,0]
v_pk_mul_f32 v[252:253], v[252:253], v[26:27] op_sel:[0,0] op_sel_hi:[1,0] neg_lo:[0,1] neg_hi:[0,1]
v_pk_fma_f32 v[244:245], v[240:241], v[18:19], v[244:245] op_sel:[0,1,0] op_sel_hi:[1,1,1] neg_lo:[0,1,0] neg_hi:[0,1,0]
v_pk_fma_f32 v[252:253], v[248:249], v[26:27], v[252:253] op_sel:[0,1,0] op_sel_hi:[1,1,1] neg_lo:[0,1,0] neg_hi:[0,1,0]
v_pk_mul_f32 v[240:241], v[242:243], v[18:19] op_sel:[0,0] op_sel_hi:[1,0]
v_pk_mul_f32 v[248:249], v[250:251], v[26:27] op_sel:[0,0] op_sel_hi:[1,0]
v_pk_fma_f32 v[240:241], v[246:247], v[18:19], v[240:241] op_sel:[0,1,0] op_sel_hi:[1,1,1] neg_lo:[0,1,0] neg_hi:[0,1,0]
v_pk_mul_f32 v[246:247], v[246:247], v[18:19] op_sel:[0,0] op_sel_hi:[1,0] neg_lo:[0,1] neg_hi:[0,1]
v_pk_fma_f32 v[248:249], v[254:255], v[26:27], v[248:249] op_sel:[0,1,0] op_sel_hi:[1,1,1] neg_lo:[0,1,0] neg_hi:[0,1,0]
v_pk_mul_f32 v[254:255], v[254:255], v[26:27] op_sel:[0,0] op_sel_hi:[1,0] neg_lo:[0,1] neg_hi:[0,1]
v_pk_fma_f32 v[246:247], v[242:243], v[18:19], v[246:247] op_sel:[0,1,0] op_sel_hi:[1,1,1] neg_lo:[0,1,0] neg_hi:[0,1,0]
v_pk_fma_f32 v[254:255], v[250:251], v[26:27], v[254:255] op_sel:[0,1,0] op_sel_hi:[1,1,1] neg_lo:[0,1,0] neg_hi:[0,1,0]
s_mov_b32 s73, 0x40000
K1_retry:
s_waitcnt vmcnt(4)
v_max3_u32 v4, v96, v97, v98
v_max3_u32 v4, v4, v99, v100
v_max3_u32 v4, v4, v101, v102
v_max3_u32 v4, v4, v103, v104
v_max3_u32 v4, v4, v105, v106
v_max3_u32 v4, v4, v107, v108
v_max3_u32 v4, v4, v109, v110
v_max_u32 v4, v4, v111
v_cmp_eq_u32 vcc, -1, v4
s_cmp_eq_u64 vcc, 0
s_cbranch_scc1 K1_use0
buffer_load_dwordx4 v[96:99], v10, s[24:27], s71 offen sc1
buffer_load_dwordx4 v[100:103], v11, s[24:27], s71 offen sc1
buffer_load_dwordx4 v[104:107], v12, s[24:27], s71 offen sc1
buffer_load_dwordx4 v[108:111], v13, s[24:27], s71 offen sc1
s_waitcnt vmcnt(4)
v_max3_u32 v4, v112, v113, v114
v_max3_u32 v4, v4, v115, v116
v_max3_u32 v4, v4, v117, v118
v_max3_u32 v4, v4, v119, v120
v_max3_u32 v4, v4, v121, v122
v_max3_u32 v4, v4, v123, v124
v_max3_u32 v4, v4, v125, v126
v_max_u32 v4, v4, v127
v_cmp_eq_u32 vcc, -1, v4
s_cmp_eq_u64 vcc, 0
s_cbranch_scc1 K1_use1
buffer_load_dwordx4 v[112:115], v10, s[24:27], s71 offen sc1
buffer_load_dwordx4 v[116:119], v11, s[24:27], s71 offen sc1
buffer_load_dwordx4 v[120:123], v12, s[24:27], s71 offen sc1
buffer_load_dwordx4 v[124:127], v13, s[24:27], s71 offen sc1
s_sub_u32 s73, s73, 1
s_cmp_lg_u32 s73, 0
s_cbranch_scc1 K1_retry
s_waitcnt vmcnt(0)
K1_use0:
v_fma_f32 v84, v72, v108, v104
v_fma_f32 v85, v72, v109, v105
v_fma_f32 v84, -v73, v109, v84
v_fma_f32 v85, v73, v108, v85
v_fma_f32 v80, v72, v84, v100
v_fma_f32 v81, v72, v85, v101
v_fma_f32 v80, -v73, v85, v80
v_fma_f32 v81, v73, v84, v81
v_fma_f32 v84, v72, v80, v96
v_fma_f32 v85, v72, v81, v97
v_fma_f32 v84, -v73, v81, v84
v_fma_f32 v85, v73, v80, v85
v_fma_f32 v86, v74, v110, v106
v_fma_f32 v87, v74, v111, v107
v_fma_f32 v86, -v75, v111, v86
v_fma_f32 v87, v75, v110, v87
v_fma_f32 v82, v74, v86, v102
v_fma_f32 v83, v74, v87, v103
v_fma_f32 v82, -v75, v87, v82
v_fma_f32 v83, v75, v86, v83
v_fma_f32 v86, v74, v82, v98
v_fma_f32 v87, v74, v83, v99
v_fma_f32 v86, -v75, v83, v86
v_fma_f32 v87, v75, v82, v87
s_branch K1_gotall
K1_use1:
v_fma_f32 v84, v72, v124, v120
v_fma_f32 v85, v72, v125, v121
v_fma_f32 v84, -v73, v125, v84
v_fma_f32 v85, v73, v124, v85
v_fma_f32 v80, v72, v84, v116
v_fma_f32 v81, v72, v85, v117
v_fma_f32 v80, -v73, v85, v80
v_fma_f32 v81, v73, v84, v81
v_fma_f32 v84, v72, v80, v112
v_fma_f32 v85, v72, v81, v113
v_fma_f32 v84, -v73, v81, v84
v_fma_f32 v85, v73, v80, v85
v_fma_f32 v86, v74, v126, v122
v_fma_f32 v87, v74, v127, v123
v_fma_f32 v86, -v75, v127, v86
v_fma_f32 v87, v75, v126, v87
v_fma_f32 v82, v74, v86, v118
v_fma_f32 v83, v74, v87, v119
v_fma_f32 v82, -v75, v87, v82
v_fma_f32 v83, v75, v86, v83
v_fma_f32 v86, v74, v82, v114
v_fma_f32 v87, v74, v83, v115
v_fma_f32 v86, -v75, v83, v86
v_fma_f32 v87, v75, v82, v87
K1_gotall:
v_mul_f32 v40, v88, v84
v_mul_f32 v41, v88, v85
v_fma_f32 v40, -v89, v85, v40
v_fma_f32 v41, v89, v84, v41
v_mul_f32 v42, v90, v86
v_mul_f32 v43, v90, v87
v_fma_f32 v42, -v91, v87, v42
v_fma_f32 v43, v91, v86, v43
v_mov_b32 v80, v40
v_mov_b32 v81, v41
v_mov_b32 v82, v42
v_mov_b32 v83, v43
s_nop 1
v_permlane32_swap_b32 v40, v80
v_permlane32_swap_b32 v41, v81
v_permlane32_swap_b32 v42, v82
v_permlane32_swap_b32 v43, v83
s_nop 1
v_add_f32 v40, v40, v80
v_add_f32 v41, v41, v81
v_add_f32 v42, v42, v82
v_add_f32 v43, v43, v83
v_mov_b32 v80, v40
v_mov_b32 v81, v41
v_mov_b32 v82, v42
v_mov_b32 v83, v43
s_nop 1
v_permlane16_swap_b32 v40, v80
v_permlane16_swap_b32 v41, v81
v_permlane16_swap_b32 v42, v82
v_permlane16_swap_b32 v43, v83
s_nop 1
v_add_f32 v40, v40, v80
v_add_f32 v41, v41, v81
v_add_f32 v42, v42, v82
v_add_f32 v43, v43, v83
v_bfe_u32 v4, v1, 1, 3
v_lshlrev_b32 v4, 6, v4
v_and_b32 v5, 1, v1
v_lshl_add_u32 v4, v5, 3, v4
v_lshrrev_b32 v5, 4, v1
v_lshlrev_b32 v5, 3, v5
buffer_load_dwordx2 v[96:97], v4, s[24:27], s81 offen offset:0 sc1
buffer_load_dwordx2 v[98:99], v4, s[24:27], s81 offen offset:512 sc1
buffer_load_dwordx2 v[100:101], v4, s[24:27], s81 offen offset:1024 sc1
buffer_load_dwordx2 v[102:103], v4, s[24:27], s81 offen offset:1536 sc1
buffer_load_dwordx2 v[104:105], v5, s[12:15], s82 offen offset:0
buffer_load_dwordx2 v[106:107], v5, s[12:15], s82 offen offset:32
buffer_load_dwordx2 v[108:109], v5, s[12:15], s82 offen offset:64
buffer_load_dwordx2 v[110:111], v5, s[12:15], s82 offen offset:96
v_pk_fma_f32 v[44:45], v[48:49], v[40:41], v[44:45] op_sel:[0,0,0] op_sel_hi:[1,0,1]
v_pk_fma_f32 v[46:47], v[48:49], v[40:41], v[46:47] op_sel:[0,1,0] op_sel_hi:[1,1,1]
v_pk_fma_f32 v[52:53], v[56:57], v[42:43], v[52:53] op_sel:[0,0,0] op_sel_hi:[1,0,1]
v_pk_fma_f32 v[54:55], v[56:57], v[42:43], v[54:55] op_sel:[0,1,0] op_sel_hi:[1,1,1]
v_pk_fma_f32 v[44:45], v[50:51], v[40:41], v[44:45] op_sel:[0,1,0] op_sel_hi:[1,1,1] neg_lo:[0,1,0] neg_hi:[0,1,0]
v_pk_fma_f32 v[46:47], v[50:51], v[40:41], v[46:47] op_sel:[0,0,0] op_sel_hi:[1,0,1]
v_pk_fma_f32 v[52:53], v[58:59], v[42:43], v[52:53] op_sel:[0,1,0] op_sel_hi:[1,1,1] neg_lo:[0,1,0] neg_hi:[0,1,0]
v_pk_fma_f32 v[54:55], v[58:59], v[42:43], v[54:55] op_sel:[0,0,0] op_sel_hi:[1,0,1]
v_pk_mul_f32 v[48:49], v[44:45], v[20:21] op_sel:[0,0] op_sel_hi:[1,0]
v_pk_mul_f32 v[50:51], v[46:47], v[20:21] op_sel:[0,0] op_sel_hi:[1,0]
v_pk_mul_f32 v[56:57], v[52:53], v[28:29] op_sel:[0,0] op_sel_hi:[1,0]
v_pk_mul_f32 v[58:59], v[54:55], v[28:29] op_sel:[0,0] op_sel_hi:[1,0]
v_pk_add_f32 v[92:93], v[92:93], v[44:45]
v_pk_add_f32 v[132:133], v[132:133], v[46:47] neg_lo:[0,1] neg_hi:[0,1]
v_pk_add_f32 v[94:95], v[94:95], v[52:53]
v_pk_add_f32 v[140:141], v[140:141], v[54:55] neg_lo:[0,1] neg_hi:[0,1]
v_pk_fma_f32 v[48:49], v[46:47], v[20:21], v[48:49] op_sel:[0,1,0] op_sel_hi:[1,1,1] neg_lo:[0,1,0] neg_hi:[0,1,0]
v_pk_fma_f32 v[50:51], v[44:45], v[20:21], v[50:51] op_sel:[0,1,0] op_sel_hi:[1,1,1]
v_pk_fma_f32 v[56:57], v[54:55], v[28:29], v[56:57] op_sel:[0,1,0] op_sel_hi:[1,1,1] neg_lo:[0,1,0] neg_hi:[0,1,0]
v_pk_fma_f32 v[58:59], v[52:53], v[28:29], v[58:59] op_sel:[0,1,0] op_sel_hi:[1,1,1]
v_cvt_pk_bf16_f32 v64, v92, v93
v_cvt_pk_bf16_f32 v68, v132, v133
v_cvt_pk_bf16_f32 v72, v94, v95
v_cvt_pk_bf16_f32 v76, v140, v141
v_pk_mul_f32 v[44:45], v[48:49], v[20:21] op_sel:[0,0] op_sel_hi:[1,0]
v_pk_mul_f32 v[46:47], v[50:51], v[20:21] op_sel:[0,0] op_sel_hi:[1,0]
v_pk_mul_f32 v[52:53], v[56:57], v[28:29] op_sel:[0,0] op_sel_hi:[1,0]
v_pk_mul_f32 v[54:55], v[58:59], v[28:29] op_sel:[0,0] op_sel_hi:[1,0]
v_pk_add_f32 v[128:129], v[128:129], v[48:49]
v_pk_add_f32 v[134:135], v[134:135], v[50:51] neg_lo:[0,1] neg_hi:[0,1]
v_pk_add_f32 v[136:137], v[136:137], v[56:57]
v_pk_add_f32 v[142:143], v[142:143], v[58:59] neg_lo:[0,1] neg_hi:[0,1]
v_pk_fma_f32 v[44:45], v[50:51], v[20:21], v[44:45] op_sel:[0,1,0] op_sel_hi:[1,1,1] neg_lo:[0,1,0] neg_hi:[0,1,0]
v_pk_fma_f32 v[46:47], v[48:49], v[20:21], v[46:47] op_sel:[0,1,0] op_sel_hi:[1,1,1]
v_pk_fma_f32 v[52:53], v[58:59], v[28:29], v[52:53] op_sel:[0,1,0] op_sel_hi:[1,1,1] neg_lo:[0,1,0] neg_hi:[0,1,0]
v_pk_fma_f32 v[54:55], v[56:57], v[28:29], v[54:55] op_sel:[0,1,0] op_sel_hi:[1,1,1]
v_cvt_pk_bf16_f32 v65, v128, v129
v_cvt_pk_bf16_f32 v69, v134, v135
v_cvt_pk_bf16_f32 v73, v136, v137
v_cvt_pk_bf16_f32 v77, v142, v143
v_pk_mul_f32 v[48:49], v[44:45], v[20:21] op_sel:[0,0] op_sel_hi:[1,0]
v_pk_mul_f32 v[50:51], v[46:47], v[20:21] op_sel:[0,0] op_sel_hi:[1,0]
v_pk_mul_f32 v[56:57], v[52:53], v[28:29] op_sel:[0,0] op_sel_hi:[1,0]
v_pk_mul_f32 v[58:59], v[54:55], v[28:29] op_sel:[0,0] op_sel_hi:[1,0]
v_pk_add_f32 v[130:131], v[130:131], v[44:45]
v_pk_add_f32 v[148:149], v[148:149], v[46:47] neg_lo:[0,1] neg_hi:[0,1]
v_pk_add_f32 v[138:139], v[138:139], v[52:53]
v_pk_add_f32 v[156:157], v[156:157], v[54:55] neg_lo:[0,1] neg_hi:[0,1]
v_pk_fma_f32 v[48:49], v[46:47], v[20:21], v[48:49] op_sel:[0,1,0] op_sel_hi:[1,1,1] neg_lo:[0,1,0] neg_hi:[0,1,0]
v_pk_fma_f32 v[50:51], v[44:45], v[20:21], v[50:51] op_sel:[0,1,0] op_sel_hi:[1,1,1]
v_pk_fma_f32 v[56:57], v[54:55], v[28:29], v[56:57] op_sel:[0,1,0] op_sel_hi:[1,1,1] neg_lo:[0,1,0] neg_hi:[0,1,0]
v_pk_fma_f32 v[58:59], v[52:53], v[28:29], v[58:59] op_sel:[0,1,0] op_sel_hi:[1,1,1]
v_cvt_pk_bf16_f32 v66, v130, v131
v_cvt_pk_bf16_f32 v70, v148, v149
v_cvt_pk_bf16_f32 v74, v138, v139
v_cvt_pk_bf16_f32 v78, v156, v157
v_pk_mul_f32 v[44:45], v[48:49], v[20:21] op_sel:[0,0] op_sel_hi:[1,0]
v_pk_mul_f32 v[46:47], v[50:51], v[20:21] op_sel:[0,0] op_sel_hi:[1,0]
v_pk_mul_f32 v[52:53], v[56:57], v[28:29] op_sel:[0,0] op_sel_hi:[1,0]
v_pk_mul_f32 v[54:55], v[58:59], v[28:29] op_sel:[0,0] op_sel_hi:[1,0]
v_pk_add_f32 v[144:145], v[144:145], v[48:49]
v_pk_add_f32 v[150:151], v[150:151], v[50:51] neg_lo:[0,1] neg_hi:[0,1]
v_pk_add_f32 v[152:153], v[152:153], v[56:57]
v_pk_add_f32 v[158:159], v[158:159], v[58:59] neg_lo:[0,1] neg_hi:[0,1]
v_pk_fma_f32 v[44:45], v[50:51], v[20:21], v[44:45] op_sel:[0,1,0] op_sel_hi:[1,1,1] neg_lo:[0,1,0] neg_hi:[0,1,0]
v_pk_fma_f32 v[46:47], v[48:49], v[20:21], v[46:47] op_sel:[0,1,0] op_sel_hi:[1,1,1]
v_pk_fma_f32 v[52:53], v[58:59], v[28:29], v[52:53] op_sel:[0,1,0] op_sel_hi:[1,1,1] neg_lo:[0,1,0] neg_hi:[0,1,0]
v_pk_fma_f32 v[54:55], v[56:57], v[28:29], v[54:55] op_sel:[0,1,0] op_sel_hi:[1,1,1]
v_cvt_pk_bf16_f32 v67, v144, v145
v_cvt_pk_bf16_f32 v71, v150, v151
v_cvt_pk_bf16_f32 v75, v152, v153
v_cvt_pk_bf16_f32 v79, v158, v159
buffer_store_dwordx4 v[64:67], v9, s[24:27], s76 offen offset:0 sc1
buffer_store_dwordx4 v[68:71], v9, s[24:27], s77 offen offset:0 sc1
buffer_store_dwordx4 v[72:75], v9, s[24:27], s78 offen offset:0 sc1
buffer_store_dwordx4 v[76:79], v9, s[24:27], s79 offen offset:0 sc1
v_pk_mul_f32 v[48:49], v[44:45], v[20:21] op_sel:[0,0] op_sel_hi:[1,0]
v_pk_mul_f32 v[50:51], v[46:47], v[20:21] op_sel:[0,0] op_sel_hi:[1,0]
v_pk_mul_f32 v[56:57], v[52:53], v[28:29] op_sel:[0,0] op_sel_hi:[1,0]
v_pk_mul_f32 v[58:59], v[54:55], v[28:29] op_sel:[0,0] op_sel_hi:[1,0]
v_pk_add_f32 v[146:147], v[146:147], v[44:45]
v_pk_add_f32 v[164:165], v[164:165], v[46:47] neg_lo:[0,1] neg_hi:[0,1]
v_pk_add_f32 v[154:155], v[154:155], v[52:53]
v_pk_add_f32 v[172:173], v[172:173], v[54:55] neg_lo:[0,1] neg_hi:[0,1]
v_pk_fma_f32 v[48:49], v[46:47], v[20:21], v[48:49] op_sel:[0,1,0] op_sel_hi:[1,1,1] neg_lo:[0,1,0] neg_hi:[0,1,0]
v_pk_fma_f32 v[50:51], v[44:45], v[20:21], v[50:51] op_sel:[0,1,0] op_sel_hi:[1,1,1]
v_pk_fma_f32 v[56:57], v[54:55], v[28:29], v[56:57] op_sel:[0,1,0] op_sel_hi:[1,1,1] neg_lo:[0,1,0] neg_hi:[0,1,0]
v_pk_fma_f32 v[58:59], v[52:53], v[28:29], v[58:59] op_sel:[0,1,0] op_sel_hi:[1,1,1]
v_cvt_pk_bf16_f32 v80, v146, v147
v_cvt_pk_bf16_f32 v84, v164, v165
v_cvt_pk_bf16_f32 v88, v154, v155
v_cvt_pk_bf16_f32 v92, v172, v173
v_pk_mul_f32 v[44:45], v[48:49], v[20:21] op_sel:[0,0] op_sel_hi:[1,0]
v_pk_mul_f32 v[46:47], v[50:51], v[20:21] op_sel:[0,0] op_sel_hi:[1,0]
v_pk_mul_f32 v[52:53], v[56:57], v[28:29] op_sel:[0,0] op_sel_hi:[1,0]
v_pk_mul_f32 v[54:55], v[58:59], v[28:29] op_sel:[0,0] op_sel_hi:[1,0]
v_pk_add_f32 v[160:161], v[160:161], v[48:49]
v_pk_add_f32 v[166:167], v[166:167], v[50:51] neg_lo:[0,1] neg_hi:[0,1]
v_pk_add_f32 v[168:169], v[168:169], v[56:57]
v_pk_add_f32 v[174:175], v[174:175], v[58:59] neg_lo:[0,1] neg_hi:[0,1]
v_pk_fma_f32 v[44:45], v[50:51], v[20:21], v[44:45] op_sel:[0,1,0] op_sel_hi:[1,1,1] neg_lo:[0,1,0] neg_hi:[0,1,0]
v_pk_fma_f32 v[46:47], v[48:49], v[20:21], v[46:47] op_sel:[0,1,0] op_sel_hi:[1,1,1]
v_pk_fma_f32 v[52:53], v[58:59], v[28:29], v[52:53] op_sel:[0,1,0] op_sel_hi:[1,1,1] neg_lo:[0,1,0] neg_hi:[0,1,0]
v_pk_fma_f32 v[54:55], v[56:57], v[28:29], v[54:55] op_sel:[0,1,0] op_sel_hi:[1,1,1]
v_cvt_pk_bf16_f32 v81, v160, v161
v_cvt_pk_bf16_f32 v85, v166, v167
v_cvt_pk_bf16_f32 v89, v168, v169
v_cvt_pk_bf16_f32 v93, v174, v175
v_pk_mul_f32 v[48:49], v[44:45], v[20:21] op_sel:[0,0] op_sel_hi:[1,0]
v_pk_mul_f32 v[50:51], v[46:47], v[20:21] op_sel:[0,0] op_sel_hi:[1,0]
v_pk_mul_f32 v[56:57], v[52:53], v[28:29] op_sel:[0,0] op_sel_hi:[1,0]
v_pk_mul_f32 v[58:59], v[54:55], v[28:29] op_sel:[0,0] op_sel_hi:[1,0]
v_pk_add_f32 v[162:163], v[162:163], v[44:45]
v_pk_add_f32 v[180:181], v[180:181], v[46:47] neg_lo:[0,1] neg_hi:[0,1]
v_pk_add_f32 v[170:171], v[170:171], v[52:53]
v_pk_add_f32 v[188:189], v[188:189], v[54:55] neg_lo:[0,1] neg_hi:[0,1]
v_pk_fma_f32 v[48:49], v[46:47], v[20:21], v[48:49] op_sel:[0,1,0] op_sel_hi:[1,1,1] neg_lo:[0,1,0] neg_hi:[0,1,0]
v_pk_fma_f32 v[50:51], v[44:45], v[20:21], v[50:51] op_sel:[0,1,0] op_sel_hi:[1,1,1]
v_pk_fma_f32 v[56:57], v[54:55], v[28:29], v[56:57] op_sel:[0,1,0] op_sel_hi:[1,1,1] neg_lo:[0,1,0] neg_hi:[0,1,0]
v_pk_fma_f32 v[58:59], v[52:53], v[28:29], v[58:59] op_sel:[0,1,0] op_sel_hi:[1,1,1]
v_cvt_pk_bf16_f32 v82, v162, v163
v_cvt_pk_bf16_f32 v86, v180, v181
v_cvt_pk_bf16_f32 v90, v170, v171
v_cvt_pk_bf16_f32 v94, v188, v189
v_pk_mul_f32 v[44:45], v[48:49], v[20:21] op_sel:[0,0] op_sel_hi:[1,0]
v_pk_mul_f32 v[46:47], v[50:51], v[20:21] op_sel:[0,0] op_sel_hi:[1,0]
v_pk_mul_f32 v[52:53], v[56:57], v[28:29] op_sel:[0,0] op_sel_hi:[1,0]
v_pk_mul_f32 v[54:55], v[58:59], v[28:29] op_sel:[0,0] op_sel_hi:[1,0]
v_pk_add_f32 v[176:177], v[176:177], v[48:49]
v_pk_add_f32 v[182:183], v[182:183], v[50:51] neg_lo:[0,1] neg_hi:[0,1]
v_pk_add_f32 v[184:185], v[184:185], v[56:57]
v_pk_add_f32 v[190:191], v[190:191], v[58:59] neg_lo:[0,1] neg_hi:[0,1]
v_pk_fma_f32 v[44:45], v[50:51], v[20:21], v[44:45] op_sel:[0,1,0] op_sel_hi:[1,1,1] neg_lo:[0,1,0] neg_hi:[0,1,0]
v_pk_fma_f32 v[46:47], v[48:49], v[20:21], v[46:47] op_sel:[0,1,0] op_sel_hi:[1,1,1]
v_pk_fma_f32 v[52:53], v[58:59], v[28:29], v[52:53] op_sel:[0,1,0] op_sel_hi:[1,1,1] neg_lo:[0,1,0] neg_hi:[0,1,0]
v_pk_fma_f32 v[54:55], v[56:57], v[28:29], v[54:55] op_sel:[0,1,0] op_sel_hi:[1,1,1]
v_cvt_pk_bf16_f32 v83, v176, v177
v_cvt_pk_bf16_f32 v87, v182, v183
v_cvt_pk_bf16_f32 v91, v184, v185
v_cvt_pk_bf16_f32 v95, v190, v191
buffer_store_dwordx4 v[80:83], v14, s[24:27], s76 offen offset:1024 sc1
buffer_store_dwordx4 v[84:87], v14, s[24:27], s77 offen offset:1024 sc1
buffer_store_dwordx4 v[88:91], v14, s[24:27], s78 offen offset:1024 sc1
buffer_store_dwordx4 v[92:95], v14, s[24:27], s79 offen offset:1024 sc1
v_pk_mul_f32 v[48:49], v[44:45], v[20:21] op_sel:[0,0] op_sel_hi:[1,0]
v_pk_mul_f32 v[50:51], v[46:47], v[20:21] op_sel:[0,0] op_sel_hi:[1,0]
v_pk_mul_f32 v[56:57], v[52:53], v[28:29] op_sel:[0,0] op_sel_hi:[1,0]
v_pk_mul_f32 v[58:59], v[54:55], v[28:29] op_sel:[0,0] op_sel_hi:[1,0]
v_pk_add_f32 v[178:179], v[178:179], v[44:45]
v_pk_add_f32 v[196:197], v[196:197], v[46:47] neg_lo:[0,1] neg_hi:[0,1]
v_pk_add_f32 v[186:187], v[186:187], v[52:53]
v_pk_add_f32 v[204:205], v[204:205], v[54:55] neg_lo:[0,1] neg_hi:[0,1]
v_pk_fma_f32 v[48:49], v[46:47], v[20:21], v[48:49] op_sel:[0,1,0] op_sel_hi:[1,1,1] neg_lo:[0,1,0] neg_hi:[0,1,0]
v_pk_fma_f32 v[50:51], v[44:45], v[20:21], v[50:51] op_sel:[0,1,0] op_sel_hi:[1,1,1]
v_pk_fma_f32 v[56:57], v[54:55], v[28:29], v[56:57] op_sel:[0,1,0] op_sel_hi:[1,1,1] neg_lo:[0,1,0] neg_hi:[0,1,0]
v_pk_fma_f32 v[58:59], v[52:53], v[28:29], v[58:59] op_sel:[0,1,0] op_sel_hi:[1,1,1]
v_cvt_pk_bf16_f32 v64, v178, v179
v_cvt_pk_bf16_f32 v68, v196, v197
v_cvt_pk_bf16_f32 v72, v186, v187
v_cvt_pk_bf16_f32 v76, v204, v205
v_pk_mul_f32 v[44:45], v[48:49], v[20:21] op_sel:[0,0] op_sel_hi:[1,0]
v_pk_mul_f32 v[46:47], v[50:51], v[20:21] op_sel:[0,0] op_sel_hi:[1,0]
v_pk_mul_f32 v[52:53], v[56:57], v[28:29] op_sel:[0,0] op_sel_hi:[1,0]
v_pk_mul_f32 v[54:55], v[58:59], v[28:29] op_sel:[0,0] op_sel_hi:[1,0]
v_pk_add_f32 v[192:193], v[192:193], v[48:49]
v_pk_add_f32 v[198:199], v[198:199], v[50:51] neg_lo:[0,1] neg_hi:[0,1]
v_pk_add_f32 v[200:201], v[200:201], v[56:57]
v_pk_add_f32 v[206:207], v[206:207], v[58:59] neg_lo:[0,1] neg_hi:[0,1]
v_pk_fma_f32 v[44:45], v[50:51], v[20:21], v[44:45] op_sel:[0,1,0] op_sel_hi:[1,1,1] neg_lo:[0,1,0] neg_hi:[0,1,0]
v_pk_fma_f32 v[46:47], v[48:49], v[20:21], v[46:47] op_sel:[0,1,0] op_sel_hi:[1,1,1]
v_pk_fma_f32 v[52:53], v[58:59], v[28:29], v[52:53] op_sel:[0,1,0] op_sel_hi:[1,1,1] neg_lo:[0,1,0] neg_hi:[0,1,0]
v_pk_fma_f32 v[54:55], v[56:57], v[28:29], v[54:55] op_sel:[0,1,0] op_sel_hi:[1,1,1]
v_cvt_pk_bf16_f32 v65, v192, v193
v_cvt_pk_bf16_f32 v69, v198, v199
v_cvt_pk_bf16_f32 v73, v200, v201
v_cvt_pk_bf16_f32 v77, v206, v207
v_pk_mul_f32 v[48:49], v[44:45], v[20:21] op_sel:[0,0] op_sel_hi:[1,0]
v_pk_mul_f32 v[50:51], v[46:47], v[20:21] op_sel:[0,0] op_sel_hi:[1,0]
v_pk_mul_f32 v[56:57], v[52:53], v[28:29] op_sel:[0,0] op_sel_hi:[1,0]
v_pk_mul_f32 v[58:59], v[54:55], v[28:29] op_sel:[0,0] op_sel_hi:[1,0]
v_pk_add_f32 v[194:195], v[194:195], v[44:45]
v_pk_add_f32 v[212:213], v[212:213], v[46:47] neg_lo:[0,1] neg_hi:[0,1]
v_pk_add_f32 v[202:203], v[202:203], v[52:53]
v_pk_add_f32 v[220:221], v[220:221], v[54:55] neg_lo:[0,1] neg_hi:[0,1]
v_pk_fma_f32 v[48:49], v[46:47], v[20:21], v[48:49] op_sel:[0,1,0] op_sel_hi:[1,1,1] neg_lo:[0,1,0] neg_hi:[0,1,0]
v_pk_fma_f32 v[50:51], v[44:45], v[20:21], v[50:51] op_sel:[0,1,0] op_sel_hi:[1,1,1]
v_pk_fma_f32 v[56:57], v[54:55], v[28:29], v[56:57] op_sel:[0,1,0] op_sel_hi:[1,1,1] neg_lo:[0,1,0] neg_hi:[0,1,0]
v_pk_fma_f32 v[58:59], v[52:53], v[28:29], v[58:59] op_sel:[0,1,0] op_sel_hi:[1,1,1]
v_cvt_pk_bf16_f32 v66, v194, v195
v_cvt_pk_bf16_f32 v70, v212, v213
v_cvt_pk_bf16_f32 v74, v202, v203
v_cvt_pk_bf16_f32 v78, v220, v221
v_pk_mul_f32 v[44:45], v[48:49], v[20:21] op_sel:[0,0] op_sel_hi:[1,0]
v_pk_mul_f32 v[46:47], v[50:51], v[20:21] op_sel:[0,0] op_sel_hi:[1,0]
v_pk_mul_f32 v[52:53], v[56:57], v[28:29] op_sel:[0,0] op_sel_hi:[1,0]
v_pk_mul_f32 v[54:55], v[58:59], v[28:29] op_sel:[0,0] op_sel_hi:[1,0]
v_pk_add_f32 v[208:209], v[208:209], v[48:49]
v_pk_add_f32 v[214:215], v[214:215], v[50:51] neg_lo:[0,1] neg_hi:[0,1]
v_pk_add_f32 v[216:217], v[216:217], v[56:57]
v_pk_add_f32 v[222:223], v[222:223], v[58:59] neg_lo:[0,1] neg_hi:[0,1]
v_pk_fma_f32 v[44:45], v[50:51], v[20:21], v[44:45] op_sel:[0,1,0] op_sel_hi:[1,1,1] neg_lo:[0,1,0] neg_hi:[0,1,0]
v_pk_fma_f32 v[46:47], v[48:49], v[20:21], v[46:47] op_sel:[0,1,0] op_sel_hi:[1,1,1]
v_pk_fma_f32 v[52:53], v[58:59], v[28:29], v[52:53] op_sel:[0,1,0] op_sel_hi:[1,1,1] neg_lo:[0,1,0] neg_hi:[0,1,0]
v_pk_fma_f32 v[54:55], v[56:57], v[28:29], v[54:55] op_sel:[0,1,0] op_sel_hi:[1,1,1]
v_cvt_pk_bf16_f32 v67, v208, v209
v_cvt_pk_bf16_f32 v71, v214, v215
v_cvt_pk_bf16_f32 v75, v216, v217
v_cvt_pk_bf16_f32 v79, v222, v223
buffer_store_dwordx4 v[64:67], v9, s[24:27], s76 offen offset:2048 sc1
buffer_store_dwordx4 v[68:71], v9, s[24:27], s77 offen offset:2048 sc1
buffer_store_dwordx4 v[72:75], v9, s[24:27], s78 offen offset:2048 sc1
buffer_store_dwordx4 v[76:79], v9, s[24:27], s79 offen offset:2048 sc1
v_pk_mul_f32 v[48:49], v[44:45], v[20:21] op_sel:[0,0] op_sel_hi:[1,0]
v_pk_mul_f32 v[50:51], v[46:47], v[20:21] op_sel:[0,0] op_sel_hi:[1,0]
v_pk_mul_f32 v[56:57], v[52:53], v[28:29] op_sel:[0,0] op_sel_hi:[1,0]
v_pk_mul_f32 v[58:59], v[54:55], v[28:29] op_sel:[0,0] op_sel_hi:[1,0]
v_pk_add_f32 v[210:211], v[210:211], v[44:45]
v_pk_add_f32 v[228:229], v[228:229], v[46:47] neg_lo:[0,1] neg_hi:[0,1]
v_pk_add_f32 v[218:219], v[218:219], v[52:53]
v_pk_add_f32 v[236:237], v[236:237], v[54:55] neg_lo:[0,1] neg_hi:[0,1]
v_pk_fma_f32 v[48:49], v[46:47], v[20:21], v[48:49] op_sel:[0,1,0] op_sel_hi:[1,1,1] neg_lo:[0,1,0] neg_hi:[0,1,0]
v_pk_fma_f32 v[50:51], v[44:45], v[20:21], v[50:51] op_sel:[0,1,0] op_sel_hi:[1,1,1]
v_pk_fma_f32 v[56:57], v[54:55], v[28:29], v[56:57] op_sel:[0,1,0] op_sel_hi:[1,1,1] neg_lo:[0,1,0] neg_hi:[0,1,0]
v_pk_fma_f32 v[58:59], v[52:53], v[28:29], v[58:59] op_sel:[0,1,0] op_sel_hi:[1,1,1]
v_cvt_pk_bf16_f32 v80, v210, v211
v_cvt_pk_bf16_f32 v84, v228, v229
v_cvt_pk_bf16_f32 v88, v218, v219
v_cvt_pk_bf16_f32 v92, v236, v237
v_pk_mul_f32 v[44:45], v[48:49], v[20:21] op_sel:[0,0] op_sel_hi:[1,0]
v_pk_mul_f32 v[46:47], v[50:51], v[20:21] op_sel:[0,0] op_sel_hi:[1,0]
v_pk_mul_f32 v[52:53], v[56:57], v[28:29] op_sel:[0,0] op_sel_hi:[1,0]
v_pk_mul_f32 v[54:55], v[58:59], v[28:29] op_sel:[0,0] op_sel_hi:[1,0]
v_pk_add_f32 v[224:225], v[224:225], v[48:49]
v_pk_add_f32 v[230:231], v[230:231], v[50:51] neg_lo:[0,1] neg_hi:[0,1]
v_pk_add_f32 v[232:233], v[232:233], v[56:57]
v_pk_add_f32 v[238:239], v[238:239], v[58:59] neg_lo:[0,1] neg_hi:[0,1]
v_pk_fma_f32 v[44:45], v[50:51], v[20:21], v[44:45] op_sel:[0,1,0] op_sel_hi:[1,1,1] neg_lo:[0,1,0] neg_hi:[0,1,0]
v_pk_fma_f32 v[46:47], v[48:49], v[20:21], v[46:47] op_sel:[0,1,0] op_sel_hi:[1,1,1]
v_pk_fma_f32 v[52:53], v[58:59], v[28:29], v[52:53] op_sel:[0,1,0] op_sel_hi:[1,1,1] neg_lo:[0,1,0] neg_hi:[0,1,0]
v_pk_fma_f32 v[54:55], v[56:57], v[28:29], v[54:55] op_sel:[0,1,0] op_sel_hi:[1,1,1]
v_cvt_pk_bf16_f32 v81, v224, v225
v_cvt_pk_bf16_f32 v85, v230, v231
v_cvt_pk_bf16_f32 v89, v232, v233
v_cvt_pk_bf16_f32 v93, v238, v239
v_pk_mul_f32 v[48:49], v[44:45], v[20:21] op_sel:[0,0] op_sel_hi:[1,0]
v_pk_mul_f32 v[50:51], v[46:47], v[20:21] op_sel:[0,0] op_sel_hi:[1,0]
v_pk_mul_f32 v[56:57], v[52:53], v[28:29] op_sel:[0,0] op_sel_hi:[1,0]
v_pk_mul_f32 v[58:59], v[54:55], v[28:29] op_sel:[0,0] op_sel_hi:[1,0]
v_pk_add_f32 v[226:227], v[226:227], v[44:45]
v_pk_add_f32 v[244:245], v[244:245], v[46:47] neg_lo:[0,1] neg_hi:[0,1]
v_pk_add_f32 v[234:235], v[234:235], v[52:53]
v_pk_add_f32 v[252:253], v[252:253], v[54:55] neg_lo:[0,1] neg_hi:[0,1]
v_pk_fma_f32 v[48:49], v[46:47], v[20:21], v[48:49] op_sel:[0,1,0] op_sel_hi:[1,1,1] neg_lo:[0,1,0] neg_hi:[0,1,0]
v_pk_fma_f32 v[50:51], v[44:45], v[20:21], v[50:51] op_sel:[0,1,0] op_sel_hi:[1,1,1]
v_pk_fma_f32 v[56:57], v[54:55], v[28:29], v[56:57] op_sel:[0,1,0] op_sel_hi:[1,1,1] neg_lo:[0,1,0] neg_hi:[0,1,0]
v_pk_fma_f32 v[58:59], v[52:53], v[28:29], v[58:59] op_sel:[0,1,0] op_sel_hi:[1,1,1]
v_cvt_pk_bf16_f32 v82, v226, v227
v_cvt_pk_bf16_f32 v86, v244, v245
v_cvt_pk_bf16_f32 v90, v234, v235
v_cvt_pk_bf16_f32 v94, v252, v253
v_pk_add_f32 v[240:241], v[240:241], v[48:49]
v_pk_add_f32 v[246:247], v[246:247], v[50:51] neg_lo:[0,1] neg_hi:[0,1]
v_pk_add_f32 v[248:249], v[248:249], v[56:57]
v_pk_add_f32 v[254:255], v[254:255], v[58:59] neg_lo:[0,1] neg_hi:[0,1]
v_cvt_pk_bf16_f32 v83, v240, v241
v_cvt_pk_bf16_f32 v87, v246, v247
v_cvt_pk_bf16_f32 v91, v248, v249
v_cvt_pk_bf16_f32 v95, v254, v255
buffer_store_dwordx4 v[80:83], v14, s[24:27], s76 offen offset:3072 sc1
buffer_store_dwordx4 v[84:87], v14, s[24:27], s77 offen offset:3072 sc1
buffer_store_dwordx4 v[88:91], v14, s[24:27], s78 offen offset:3072 sc1
buffer_store_dwordx4 v[92:95], v14, s[24:27], s79 offen offset:3072 sc1
v_and_b32 v2, 15, v1
v_lshrrev_b32 v3, 5, v1
v_lshrrev_b32 v4, 1, v2
v_xor_b32 v4, v4, v3
v_lshlrev_b32 v4, 4, v4
v_lshlrev_b32 v2, 7, v2
v_bfe_u32 v3, v1, 4, 1
v_lshlrev_b32 v3, 3, v3
v_add3_u32 v2, v2, v3, s84
v_mov_b32 v22, 0
v_mov_b32 v23, 1
s_waitcnt vmcnt(16)
v_xor_b32 v3, 0, v4
v_add_u32 v120, v2, v3
v_xor_b32 v3, 32, v4
v_add_u32 v121, v2, v3
v_xor_b32 v3, 64, v4
v_add_u32 v122, v2, v3
v_xor_b32 v3, 96, v4
v_add_u32 v123, v2, v3
ds_read_b64 v[192:193], v120 offset:0
ds_read_b64 v[194:195], v121 offset:0
ds_read_b64 v[196:197], v122 offset:0
ds_read_b64 v[198:199], v123 offset:0
ds_read_b64 v[200:201], v120 offset:2048
ds_read_b64 v[202:203], v121 offset:2048
ds_read_b64 v[204:205], v122 offset:2048
ds_read_b64 v[206:207], v123 offset:2048
ds_read_b64 v[208:209], v120 offset:4096
ds_read_b64 v[210:211], v121 offset:4096
ds_read_b64 v[212:213], v122 offset:4096
ds_read_b64 v[214:215], v123 offset:4096
ds_read_b64 v[216:217], v120 offset:6144
ds_read_b64 v[218:219], v121 offset:6144
ds_read_b64 v[220:221], v122 offset:6144
ds_read_b64 v[222:223], v123 offset:6144
v_lshlrev_b32 v224, 16, v104
v_and_b32 v225, 0xffff0000, v104
v_lshlrev_b32 v226, 16, v105
v_and_b32 v227, 0xffff0000, v105
v_lshlrev_b32 v228, 16, v106
v_and_b32 v229, 0xffff0000, v106
v_lshlrev_b32 v230, 16, v107
v_and_b32 v231, 0xffff0000, v107
v_lshlrev_b32 v232, 16, v108
v_and_b32 v233, 0xffff0000, v108
v_lshlrev_b32 v234, 16, v109
v_and_b32 v235, 0xffff0000, v109
v_lshlrev_b32 v236, 16, v110
v_and_b32 v237, 0xffff0000, v110
v_lshlrev_b32 v238, 16, v111
v_and_b32 v239, 0xffff0000, v111
s_waitcnt lgkmcnt(12)
v_lshlrev_b32 v128, 16, v192
v_and_b32 v129, 0xffff0000, v192
v_lshlrev_b32 v130, 16, v193
v_and_b32 v131, 0xffff0000, v193
v_lshlrev_b32 v144, 16, v194
v_and_b32 v145, 0xffff0000, v194
v_lshlrev_b32 v146, 16, v195
v_and_b32 v147, 0xffff0000, v195
v_lshlrev_b32 v160, 16, v196
v_and_b32 v161, 0xffff0000, v196
v_lshlrev_b32 v162, 16, v197
v_and_b32 v163, 0xffff0000, v197
v_lshlrev_b32 v176, 16, v198
v_and_b32 v177, 0xffff0000, v198
v_lshlrev_b32 v178, 16, v199
v_and_b32 v179, 0xffff0000, v199
v_pk_add_f32 v[32:33], v[128:129], v[96:97] op_sel_hi:[1,0]
v_pk_add_f32 v[34:35], v[130:131], v[96:97] op_sel_hi:[1,0]
v_pk_add_f32 v[36:37], v[144:145], v[96:97] op_sel_hi:[1,0]
v_pk_add_f32 v[38:39], v[146:147], v[96:97] op_sel_hi:[1,0]
v_pk_add_f32 v[40:41], v[160:161], v[96:97] op_sel_hi:[1,0]
v_pk_add_f32 v[42:43], v[162:163], v[96:97] op_sel_hi:[1,0]
v_pk_add_f32 v[44:45], v[176:177], v[96:97] op_sel_hi:[1,0]
v_pk_add_f32 v[46:47], v[178:179], v[96:97] op_sel_hi:[1,0]
v_cvt_pk_bf16_f32 v32, 0, v32
v_cvt_pk_bf16_f32 v33, 0, v33
v_cvt_pk_bf16_f32 v34, 0, v34
v_cvt_pk_bf16_f32 v35, 0, v35
v_cvt_pk_bf16_f32 v36, 0, v36
v_cvt_pk_bf16_f32 v37, 0, v37
v_cvt_pk_bf16_f32 v38, 0, v38
v_cvt_pk_bf16_f32 v39, 0, v39
v_cvt_pk_bf16_f32 v40, 0, v40
v_cvt_pk_bf16_f32 v41, 0, v41
v_cvt_pk_bf16_f32 v42, 0, v42
v_cvt_pk_bf16_f32 v43, 0, v43
v_cvt_pk_bf16_f32 v44, 0, v44
v_cvt_pk_bf16_f32 v45, 0, v45
v_cvt_pk_bf16_f32 v46, 0, v46
v_cvt_pk_bf16_f32 v47, 0, v47
v_pk_mul_f32 v[32:33], v[32:33], v[96:97] op_sel:[0,1] op_sel_hi:[1,1]
v_pk_mul_f32 v[34:35], v[34:35], v[96:97] op_sel:[0,1] op_sel_hi:[1,1]
v_pk_mul_f32 v[36:37], v[36:37], v[96:97] op_sel:[0,1] op_sel_hi:[1,1]
v_pk_mul_f32 v[38:39], v[38:39], v[96:97] op_sel:[0,1] op_sel_hi:[1,1]
v_pk_mul_f32 v[40:41], v[40:41], v[96:97] op_sel:[0,1] op_sel_hi:[1,1]
v_pk_mul_f32 v[42:43], v[42:43], v[96:97] op_sel:[0,1] op_sel_hi:[1,1]
v_pk_mul_f32 v[44:45], v[44:45], v[96:97] op_sel:[0,1] op_sel_hi:[1,1]
v_pk_mul_f32 v[46:47], v[46:47], v[96:97] op_sel:[0,1] op_sel_hi:[1,1]
v_cvt_pk_bf16_f32 v32, 0, v32
v_cvt_pk_bf16_f32 v33, 0, v33
v_cvt_pk_bf16_f32 v34, 0, v34
v_cvt_pk_bf16_f32 v35, 0, v35
v_cvt_pk_bf16_f32 v36, 0, v36
v_cvt_pk_bf16_f32 v37, 0, v37
v_cvt_pk_bf16_f32 v38, 0, v38
v_cvt_pk_bf16_f32 v39, 0, v39
v_cvt_pk_bf16_f32 v40, 0, v40
v_cvt_pk_bf16_f32 v41, 0, v41
v_cvt_pk_bf16_f32 v42, 0, v42
v_cvt_pk_bf16_f32 v43, 0, v43
v_cvt_pk_bf16_f32 v44, 0, v44
v_cvt_pk_bf16_f32 v45, 0, v45
v_cvt_pk_bf16_f32 v46, 0, v46
v_cvt_pk_bf16_f32 v47, 0, v47
v_pk_mul_f32 v[32:33], v[32:33], v[224:225]
v_pk_mul_f32 v[34:35], v[34:35], v[226:227]
v_pk_mul_f32 v[36:37], v[36:37], v[228:229]
v_pk_mul_f32 v[38:39], v[38:39], v[230:231]
v_pk_mul_f32 v[40:41], v[40:41], v[232:233]
v_pk_mul_f32 v[42:43], v[42:43], v[234:235]
v_pk_mul_f32 v[44:45], v[44:45], v[236:237]
v_pk_mul_f32 v[46:47], v[46:47], v[238:239]
v_cvt_pk_bf16_f32 v32, 0, v32
v_cvt_pk_bf16_f32 v33, 0, v33
v_cvt_pk_bf16_f32 v34, 0, v34
v_cvt_pk_bf16_f32 v35, 0, v35
v_cvt_pk_bf16_f32 v36, 0, v36
v_cvt_pk_bf16_f32 v37, 0, v37
v_cvt_pk_bf16_f32 v38, 0, v38
v_cvt_pk_bf16_f32 v39, 0, v39
v_cvt_pk_bf16_f32 v40, 0, v40
v_cvt_pk_bf16_f32 v41, 0, v41
v_cvt_pk_bf16_f32 v42, 0, v42
v_cvt_pk_bf16_f32 v43, 0, v43
v_cvt_pk_bf16_f32 v44, 0, v44
v_cvt_pk_bf16_f32 v45, 0, v45
v_cvt_pk_bf16_f32 v46, 0, v46
v_cvt_pk_bf16_f32 v47, 0, v47
v_pk_add_f32 v[128:129], v[128:129], v[32:33]
v_pk_add_f32 v[130:131], v[130:131], v[34:35]
v_pk_add_f32 v[144:145], v[144:145], v[36:37]
v_pk_add_f32 v[146:147], v[146:147], v[38:39]
v_pk_add_f32 v[160:161], v[160:161], v[40:41]
v_pk_add_f32 v[162:163], v[162:163], v[42:43]
v_pk_add_f32 v[176:177], v[176:177], v[44:45]
v_pk_add_f32 v[178:179], v[178:179], v[46:47]
s_waitcnt vmcnt(0)
s_mov_b64 s[74:75], exec
s_mov_b64 exec, 1
buffer_store_dword v23, v22, s[24:27], s85 offen sc1
s_mov_b64 exec, s[74:75]
s_waitcnt lgkmcnt(8)
v_lshlrev_b32 v132, 16, v200
v_and_b32 v133, 0xffff0000, v200
v_lshlrev_b32 v134, 16, v201
v_and_b32 v135, 0xffff0000, v201
v_lshlrev_b32 v148, 16, v202
v_and_b32 v149, 0xffff0000, v202
v_lshlrev_b32 v150, 16, v203
v_and_b32 v151, 0xffff0000, v203
v_lshlrev_b32 v164, 16, v204
v_and_b32 v165, 0xffff0000, v204
v_lshlrev_b32 v166, 16, v205
v_and_b32 v167, 0xffff0000, v205
v_lshlrev_b32 v180, 16, v206
v_and_b32 v181, 0xffff0000, v206
v_lshlrev_b32 v182, 16, v207
v_and_b32 v183, 0xffff0000, v207
v_pk_add_f32 v[32:33], v[132:133], v[98:99] op_sel_hi:[1,0]
v_pk_add_f32 v[34:35], v[134:135], v[98:99] op_sel_hi:[1,0]
v_pk_add_f32 v[36:37], v[148:149], v[98:99] op_sel_hi:[1,0]
v_pk_add_f32 v[38:39], v[150:151], v[98:99] op_sel_hi:[1,0]
v_pk_add_f32 v[40:41], v[164:165], v[98:99] op_sel_hi:[1,0]
v_pk_add_f32 v[42:43], v[166:167], v[98:99] op_sel_hi:[1,0]
v_pk_add_f32 v[44:45], v[180:181], v[98:99] op_sel_hi:[1,0]
v_pk_add_f32 v[46:47], v[182:183], v[98:99] op_sel_hi:[1,0]
v_cvt_pk_bf16_f32 v32, 0, v32
v_cvt_pk_bf16_f32 v33, 0, v33
v_cvt_pk_bf16_f32 v34, 0, v34
v_cvt_pk_bf16_f32 v35, 0, v35
v_cvt_pk_bf16_f32 v36, 0, v36
v_cvt_pk_bf16_f32 v37, 0, v37
v_cvt_pk_bf16_f32 v38, 0, v38
v_cvt_pk_bf16_f32 v39, 0, v39
v_cvt_pk_bf16_f32 v40, 0, v40
v_cvt_pk_bf16_f32 v41, 0, v41
v_cvt_pk_bf16_f32 v42, 0, v42
v_cvt_pk_bf16_f32 v43, 0, v43
v_cvt_pk_bf16_f32 v44, 0, v44
v_cvt_pk_bf16_f32 v45, 0, v45
v_cvt_pk_bf16_f32 v46, 0, v46
v_cvt_pk_bf16_f32 v47, 0, v47
v_pk_mul_f32 v[32:33], v[32:33], v[98:99] op_sel:[0,1] op_sel_hi:[1,1]
v_pk_mul_f32 v[34:35], v[34:35], v[98:99] op_sel:[0,1] op_sel_hi:[1,1]
v_pk_mul_f32 v[36:37], v[36:37], v[98:99] op_sel:[0,1] op_sel_hi:[1,1]
v_pk_mul_f32 v[38:39], v[38:39], v[98:99] op_sel:[0,1] op_sel_hi:[1,1]
v_pk_mul_f32 v[40:41], v[40:41], v[98:99] op_sel:[0,1] op_sel_hi:[1,1]
v_pk_mul_f32 v[42:43], v[42:43], v[98:99] op_sel:[0,1] op_sel_hi:[1,1]
v_pk_mul_f32 v[44:45], v[44:45], v[98:99] op_sel:[0,1] op_sel_hi:[1,1]
v_pk_mul_f32 v[46:47], v[46:47], v[98:99] op_sel:[0,1] op_sel_hi:[1,1]
v_cvt_pk_bf16_f32 v32, 0, v32
v_cvt_pk_bf16_f32 v33, 0, v33
v_cvt_pk_bf16_f32 v34, 0, v34
v_cvt_pk_bf16_f32 v35, 0, v35
v_cvt_pk_bf16_f32 v36, 0, v36
v_cvt_pk_bf16_f32 v37, 0, v37
v_cvt_pk_bf16_f32 v38, 0, v38
v_cvt_pk_bf16_f32 v39, 0, v39
v_cvt_pk_bf16_f32 v40, 0, v40
v_cvt_pk_bf16_f32 v41, 0, v41
v_cvt_pk_bf16_f32 v42, 0, v42
v_cvt_pk_bf16_f32 v43, 0, v43
v_cvt_pk_bf16_f32 v44, 0, v44
v_cvt_pk_bf16_f32 v45, 0, v45
v_cvt_pk_bf16_f32 v46, 0, v46
v_cvt_pk_bf16_f32 v47, 0, v47
v_pk_mul_f32 v[32:33], v[32:33], v[224:225]
v_pk_mul_f32 v[34:35], v[34:35], v[226:227]
v_pk_mul_f32 v[36:37], v[36:37], v[228:229]
v_pk_mul_f32 v[38:39], v[38:39], v[230:231]
v_pk_mul_f32 v[40:41], v[40:41], v[232:233]
v_pk_mul_f32 v[42:43], v[42:43], v[234:235]
v_pk_mul_f32 v[44:45], v[44:45], v[236:237]
v_pk_mul_f32 v[46:47], v[46:47], v[238:239]
v_cvt_pk_bf16_f32 v32, 0, v32
v_cvt_pk_bf16_f32 v33, 0, v33
v_cvt_pk_bf16_f32 v34, 0, v34
v_cvt_pk_bf16_f32 v35, 0, v35
v_cvt_pk_bf16_f32 v36, 0, v36
v_cvt_pk_bf16_f32 v37, 0, v37
v_cvt_pk_bf16_f32 v38, 0, v38
v_cvt_pk_bf16_f32 v39, 0, v39
v_cvt_pk_bf16_f32 v40, 0, v40
v_cvt_pk_bf16_f32 v41, 0, v41
v_cvt_pk_bf16_f32 v42, 0, v42
v_cvt_pk_bf16_f32 v43, 0, v43
v_cvt_pk_bf16_f32 v44, 0, v44
v_cvt_pk_bf16_f32 v45, 0, v45
v_cvt_pk_bf16_f32 v46, 0, v46
v_cvt_pk_bf16_f32 v47, 0, v47
v_pk_add_f32 v[132:133], v[132:133], v[32:33]
v_pk_add_f32 v[134:135], v[134:135], v[34:35]
v_pk_add_f32 v[148:149], v[148:149], v[36:37]
v_pk_add_f32 v[150:151], v[150:151], v[38:39]
v_pk_add_f32 v[164:165], v[164:165], v[40:41]
v_pk_add_f32 v[166:167], v[166:167], v[42:43]
v_pk_add_f32 v[180:181], v[180:181], v[44:45]
v_pk_add_f32 v[182:183], v[182:183], v[46:47]
s_waitcnt lgkmcnt(4)
v_lshlrev_b32 v136, 16, v208
v_and_b32 v137, 0xffff0000, v208
v_lshlrev_b32 v138, 16, v209
v_and_b32 v139, 0xffff0000, v209
v_lshlrev_b32 v152, 16, v210
v_and_b32 v153, 0xffff0000, v210
v_lshlrev_b32 v154, 16, v211
v_and_b32 v155, 0xffff0000, v211
v_lshlrev_b32 v168, 16, v212
v_and_b32 v169, 0xffff0000, v212
v_lshlrev_b32 v170, 16, v213
v_and_b32 v171, 0xffff0000, v213
v_lshlrev_b32 v184, 16, v214
v_and_b32 v185, 0xffff0000, v214
v_lshlrev_b32 v186, 16, v215
v_and_b32 v187, 0xffff0000, v215
v_pk_add_f32 v[32:33], v[136:137], v[100:101] op_sel_hi:[1,0]
v_pk_add_f32 v[34:35], v[138:139], v[100:101] op_sel_hi:[1,0]
v_pk_add_f32 v[36:37], v[152:153], v[100:101] op_sel_hi:[1,0]
v_pk_add_f32 v[38:39], v[154:155], v[100:101] op_sel_hi:[1,0]
v_pk_add_f32 v[40:41], v[168:169], v[100:101] op_sel_hi:[1,0]
v_pk_add_f32 v[42:43], v[170:171], v[100:101] op_sel_hi:[1,0]
v_pk_add_f32 v[44:45], v[184:185], v[100:101] op_sel_hi:[1,0]
v_pk_add_f32 v[46:47], v[186:187], v[100:101] op_sel_hi:[1,0]
v_cvt_pk_bf16_f32 v32, 0, v32
v_cvt_pk_bf16_f32 v33, 0, v33
v_cvt_pk_bf16_f32 v34, 0, v34
v_cvt_pk_bf16_f32 v35, 0, v35
v_cvt_pk_bf16_f32 v36, 0, v36
v_cvt_pk_bf16_f32 v37, 0, v37
v_cvt_pk_bf16_f32 v38, 0, v38
v_cvt_pk_bf16_f32 v39, 0, v39
v_cvt_pk_bf16_f32 v40, 0, v40
v_cvt_pk_bf16_f32 v41, 0, v41
v_cvt_pk_bf16_f32 v42, 0, v42
v_cvt_pk_bf16_f32 v43, 0, v43
v_cvt_pk_bf16_f32 v44, 0, v44
v_cvt_pk_bf16_f32 v45, 0, v45
v_cvt_pk_bf16_f32 v46, 0, v46
v_cvt_pk_bf16_f32 v47, 0, v47
v_pk_mul_f32 v[32:33], v[32:33], v[100:101] op_sel:[0,1] op_sel_hi:[1,1]
v_pk_mul_f32 v[34:35], v[34:35], v[100:101] op_sel:[0,1] op_sel_hi:[1,1]
v_pk_mul_f32 v[36:37], v[36:37], v[100:101] op_sel:[0,1] op_sel_hi:[1,1]
v_pk_mul_f32 v[38:39], v[38:39], v[100:101] op_sel:[0,1] op_sel_hi:[1,1]
v_pk_mul_f32 v[40:41], v[40:41], v[100:101] op_sel:[0,1] op_sel_hi:[1,1]
v_pk_mul_f32 v[42:43], v[42:43], v[100:101] op_sel:[0,1] op_sel_hi:[1,1]
v_pk_mul_f32 v[44:45], v[44:45], v[100:101] op_sel:[0,1] op_sel_hi:[1,1]
v_pk_mul_f32 v[46:47], v[46:47], v[100:101] op_sel:[0,1] op_sel_hi:[1,1]
v_cvt_pk_bf16_f32 v32, 0, v32
v_cvt_pk_bf16_f32 v33, 0, v33
v_cvt_pk_bf16_f32 v34, 0, v34
v_cvt_pk_bf16_f32 v35, 0, v35
v_cvt_pk_bf16_f32 v36, 0, v36
v_cvt_pk_bf16_f32 v37, 0, v37
v_cvt_pk_bf16_f32 v38, 0, v38
v_cvt_pk_bf16_f32 v39, 0, v39
v_cvt_pk_bf16_f32 v40, 0, v40
v_cvt_pk_bf16_f32 v41, 0, v41
v_cvt_pk_bf16_f32 v42, 0, v42
v_cvt_pk_bf16_f32 v43, 0, v43
v_cvt_pk_bf16_f32 v44, 0, v44
v_cvt_pk_bf16_f32 v45, 0, v45
v_cvt_pk_bf16_f32 v46, 0, v46
v_cvt_pk_bf16_f32 v47, 0, v47
v_pk_mul_f32 v[32:33], v[32:33], v[224:225]
v_pk_mul_f32 v[34:35], v[34:35], v[226:227]
v_pk_mul_f32 v[36:37], v[36:37], v[228:229]
v_pk_mul_f32 v[38:39], v[38:39], v[230:231]
v_pk_mul_f32 v[40:41], v[40:41], v[232:233]
v_pk_mul_f32 v[42:43], v[42:43], v[234:235]
v_pk_mul_f32 v[44:45], v[44:45], v[236:237]
v_pk_mul_f32 v[46:47], v[46:47], v[238:239]
v_cvt_pk_bf16_f32 v32, 0, v32
v_cvt_pk_bf16_f32 v33, 0, v33
v_cvt_pk_bf16_f32 v34, 0, v34
v_cvt_pk_bf16_f32 v35, 0, v35
v_cvt_pk_bf16_f32 v36, 0, v36
v_cvt_pk_bf16_f32 v37, 0, v37
v_cvt_pk_bf16_f32 v38, 0, v38
v_cvt_pk_bf16_f32 v39, 0, v39
v_cvt_pk_bf16_f32 v40, 0, v40
v_cvt_pk_bf16_f32 v41, 0, v41
v_cvt_pk_bf16_f32 v42, 0, v42
v_cvt_pk_bf16_f32 v43, 0, v43
v_cvt_pk_bf16_f32 v44, 0, v44
v_cvt_pk_bf16_f32 v45, 0, v45
v_cvt_pk_bf16_f32 v46, 0, v46
v_cvt_pk_bf16_f32 v47, 0, v47
v_pk_add_f32 v[136:137], v[136:137], v[32:33]
v_pk_add_f32 v[138:139], v[138:139], v[34:35]
v_pk_add_f32 v[152:153], v[152:153], v[36:37]
v_pk_add_f32 v[154:155], v[154:155], v[38:39]
v_pk_add_f32 v[168:169], v[168:169], v[40:41]
v_pk_add_f32 v[170:171], v[170:171], v[42:43]
v_pk_add_f32 v[184:185], v[184:185], v[44:45]
v_pk_add_f32 v[186:187], v[186:187], v[46:47]
s_waitcnt lgkmcnt(0)
v_lshlrev_b32 v140, 16, v216
v_and_b32 v141, 0xffff0000, v216
v_lshlrev_b32 v142, 16, v217
v_and_b32 v143, 0xffff0000, v217
v_lshlrev_b32 v156, 16, v218
v_and_b32 v157, 0xffff0000, v218
v_lshlrev_b32 v158, 16, v219
v_and_b32 v159, 0xffff0000, v219
v_lshlrev_b32 v172, 16, v220
v_and_b32 v173, 0xffff0000, v220
v_lshlrev_b32 v174, 16, v221
v_and_b32 v175, 0xffff0000, v221
v_lshlrev_b32 v188, 16, v222
v_and_b32 v189, 0xffff0000, v222
v_lshlrev_b32 v190, 16, v223
v_and_b32 v191, 0xffff0000, v223
v_pk_add_f32 v[32:33], v[140:141], v[102:103] op_sel_hi:[1,0]
v_pk_add_f32 v[34:35], v[142:143], v[102:103] op_sel_hi:[1,0]
v_pk_add_f32 v[36:37], v[156:157], v[102:103] op_sel_hi:[1,0]
v_pk_add_f32 v[38:39], v[158:159], v[102:103] op_sel_hi:[1,0]
v_pk_add_f32 v[40:41], v[172:173], v[102:103] op_sel_hi:[1,0]
v_pk_add_f32 v[42:43], v[174:175], v[102:103] op_sel_hi:[1,0]
v_pk_add_f32 v[44:45], v[188:189], v[102:103] op_sel_hi:[1,0]
v_pk_add_f32 v[46:47], v[190:191], v[102:103] op_sel_hi:[1,0]
v_cvt_pk_bf16_f32 v32, 0, v32
v_cvt_pk_bf16_f32 v33, 0, v33
v_cvt_pk_bf16_f32 v34, 0, v34
v_cvt_pk_bf16_f32 v35, 0, v35
v_cvt_pk_bf16_f32 v36, 0, v36
v_cvt_pk_bf16_f32 v37, 0, v37
v_cvt_pk_bf16_f32 v38, 0, v38
v_cvt_pk_bf16_f32 v39, 0, v39
v_cvt_pk_bf16_f32 v40, 0, v40
v_cvt_pk_bf16_f32 v41, 0, v41
v_cvt_pk_bf16_f32 v42, 0, v42
v_cvt_pk_bf16_f32 v43, 0, v43
v_cvt_pk_bf16_f32 v44, 0, v44
v_cvt_pk_bf16_f32 v45, 0, v45
v_cvt_pk_bf16_f32 v46, 0, v46
v_cvt_pk_bf16_f32 v47, 0, v47
v_pk_mul_f32 v[32:33], v[32:33], v[102:103] op_sel:[0,1] op_sel_hi:[1,1]
v_pk_mul_f32 v[34:35], v[34:35], v[102:103] op_sel:[0,1] op_sel_hi:[1,1]
v_pk_mul_f32 v[36:37], v[36:37], v[102:103] op_sel:[0,1] op_sel_hi:[1,1]
v_pk_mul_f32 v[38:39], v[38:39], v[102:103] op_sel:[0,1] op_sel_hi:[1,1]
v_pk_mul_f32 v[40:41], v[40:41], v[102:103] op_sel:[0,1] op_sel_hi:[1,1]
v_pk_mul_f32 v[42:43], v[42:43], v[102:103] op_sel:[0,1] op_sel_hi:[1,1]
v_pk_mul_f32 v[44:45], v[44:45], v[102:103] op_sel:[0,1] op_sel_hi:[1,1]
v_pk_mul_f32 v[46:47], v[46:47], v[102:103] op_sel:[0,1] op_sel_hi:[1,1]
v_cvt_pk_bf16_f32 v32, 0, v32
v_cvt_pk_bf16_f32 v33, 0, v33
v_cvt_pk_bf16_f32 v34, 0, v34
v_cvt_pk_bf16_f32 v35, 0, v35
v_cvt_pk_bf16_f32 v36, 0, v36
v_cvt_pk_bf16_f32 v37, 0, v37
v_cvt_pk_bf16_f32 v38, 0, v38
v_cvt_pk_bf16_f32 v39, 0, v39
v_cvt_pk_bf16_f32 v40, 0, v40
v_cvt_pk_bf16_f32 v41, 0, v41
v_cvt_pk_bf16_f32 v42, 0, v42
v_cvt_pk_bf16_f32 v43, 0, v43
v_cvt_pk_bf16_f32 v44, 0, v44
v_cvt_pk_bf16_f32 v45, 0, v45
v_cvt_pk_bf16_f32 v46, 0, v46
v_cvt_pk_bf16_f32 v47, 0, v47
v_pk_mul_f32 v[32:33], v[32:33], v[224:225]
v_pk_mul_f32 v[34:35], v[34:35], v[226:227]
v_pk_mul_f32 v[36:37], v[36:37], v[228:229]
v_pk_mul_f32 v[38:39], v[38:39], v[230:231]
v_pk_mul_f32 v[40:41], v[40:41], v[232:233]
v_pk_mul_f32 v[42:43], v[42:43], v[234:235]
v_pk_mul_f32 v[44:45], v[44:45], v[236:237]
v_pk_mul_f32 v[46:47], v[46:47], v[238:239]
v_cvt_pk_bf16_f32 v32, 0, v32
v_cvt_pk_bf16_f32 v33, 0, v33
v_cvt_pk_bf16_f32 v34, 0, v34
v_cvt_pk_bf16_f32 v35, 0, v35
v_cvt_pk_bf16_f32 v36, 0, v36
v_cvt_pk_bf16_f32 v37, 0, v37
v_cvt_pk_bf16_f32 v38, 0, v38
v_cvt_pk_bf16_f32 v39, 0, v39
v_cvt_pk_bf16_f32 v40, 0, v40
v_cvt_pk_bf16_f32 v41, 0, v41
v_cvt_pk_bf16_f32 v42, 0, v42
v_cvt_pk_bf16_f32 v43, 0, v43
v_cvt_pk_bf16_f32 v44, 0, v44
v_cvt_pk_bf16_f32 v45, 0, v45
v_cvt_pk_bf16_f32 v46, 0, v46
v_cvt_pk_bf16_f32 v47, 0, v47
v_pk_add_f32 v[140:141], v[140:141], v[32:33]
v_pk_add_f32 v[142:143], v[142:143], v[34:35]
v_pk_add_f32 v[156:157], v[156:157], v[36:37]
v_pk_add_f32 v[158:159], v[158:159], v[38:39]
v_pk_add_f32 v[172:173], v[172:173], v[40:41]
v_pk_add_f32 v[174:175], v[174:175], v[42:43]
v_pk_add_f32 v[188:189], v[188:189], v[44:45]
v_pk_add_f32 v[190:191], v[190:191], v[46:47]
v_mov_b32 v22, 0
v_mov_b32 v23, 1
v_lshlrev_b32 v21, 4, v1
s_lshl_b32 s69, s38, 2
s_add_u32 s69, s69, s32
s_lshl_b32 s70, s69, 6
s_add_u32 s70, s70, 25436160
s_lshl_b32 s69, s69, 14
s_add_u32 s69, s69, 33554432
s_mov_b32 s63, 0
s_cmp_eq_u32 s32, 1
s_cselect_b32 s63, 17408, s63
s_cmp_eq_u32 s32, 2
s_cselect_b32 s63, 34816, s63
s_cmp_eq_u32 s32, 3
s_cselect_b32 s63, 52224, s63
s_mul_i32 s65, s32, 4352
s_add_u32 s65, s65, 131072
v_and_b32 v2, 15, v1
v_lshrrev_b32 v3, 4, v1
v_mul_u32_u24 v5, 272, v2
v_lshlrev_b32 v4, 4, v3
v_add3_u32 v25, v5, v4, s63
v_add3_u32 v28, v5, v4, s65
v_mul_u32_u24 v5, 272, v3
v_lshlrev_b32 v4, 4, v2
v_add3_u32 v26, v5, v4, s63
v_add3_u32 v27, v5, v4, s65
v_lshlrev_b32 v20, 12, v3
v_add_u32 v20, v20, v4
s_lshl_b32 s62, s43, 7
s_lshl_b32 s63, s61, 6
s_add_u32 s62, s62, s63
s_lshl_b32 s64, s37, 7
s_lshl_b32 s63, s60, 6
s_add_u32 s64, s64, s63
s_mov_b32 s28, s54
s_mov_b32 s29, s55
s_mov_b32 s30, 8388608
s_mov_b32 s31, 0x20000
v_and_b32 v2, 15, v1
v_lshrrev_b32 v3, 4, v1
s_mul_i32 s90, s60, 8192
v_lshlrev_b32 v4, 4, v1
v_add_u32 v10, s90, v4
v_lshrrev_b32 v5, 2, v1
v_and_b32 v6, 3, v1
v_lshlrev_b32 v6, 3, v6
v_and_b32 v4, 7, v5
s_lshl_b32 s90, s61, 2
v_xor_b32 v4, s90, v4
v_lshlrev_b32 v4, 5, v4
v_lshlrev_b32 v7, 8, v5
v_add_u32 v7, v7, v6
v_add_u32 v7, 16384, v7
v_xor_b32 v2, 0, v4
v_add_u32 v12, v7, v2
v_xor_b32 v2, 32, v4
v_add_u32 v13, v7, v2
v_xor_b32 v2, 64, v4
v_add_u32 v14, v7, v2
v_xor_b32 v2, 96, v4
v_add_u32 v15, v7, v2
v_and_b32 v2, 15, v1
v_lshrrev_b32 v3, 4, v1
v_lshrrev_b32 v4, 1, v2
v_xor_b32 v4, v4, v3
v_lshlrev_b32 v4, 4, v4
v_lshlrev_b32 v5, 7, v2
v_add_u32 v4, v4, v5
s_mul_i32 s90, s60, 8192
v_add_u32 v8, s90, v4
v_xor_b32 v9, 64, v8
v_lshrrev_b32 v5, 2, v1
v_and_b32 v6, 3, v1
v_lshlrev_b32 v6, 3, v6
v_lshrrev_b32 v4, 1, v3
v_lshlrev_b32 v4, 12, v4
v_bfe_u32 v7, v1, 1, 1
v_mul_u32_u24 v7, 1088, v7
v_add_u32 v4, v4, v7
v_and_b32 v7, 1, v3
v_lshlrev_b32 v7, 7, v7
v_add_u32 v4, v4, v7
v_and_b32 v7, 3, v5
v_lshlrev_b32 v7, 4, v7
v_add_u32 v4, v4, v7
v_and_b32 v7, 1, v1
v_lshlrev_b32 v7, 3, v7
v_add_u32 v4, v4, v7
s_lshl_b32 s90, s61, 9
s_add_u32 s90, s90, 16384
v_add_u32 v16, s90, v4
v_xor_b32 v17, 64, v16
s_waitcnt lgkmcnt(0)
s_mov_b32 s93, 0
s_mov_b32 s95, 32768
s_barrier
ds_read_b128 v[32:35], v8 offset:0
ds_read_b64_tr_b16 v[48:49], v16 offset:0
ds_read_b64_tr_b16 v[50:51], v17 offset:0
ds_read_b64_tr_b16 v[52:53], v16 offset:2048
ds_read_b64_tr_b16 v[54:55], v17 offset:2048
ds_read_b64_tr_b16 v[56:57], v16 offset:256
ds_read_b64_tr_b16 v[58:59], v17 offset:256
ds_read_b64_tr_b16 v[60:61], v16 offset:2304
ds_read_b64_tr_b16 v[62:63], v17 offset:2304
ds_read_b128 v[36:39], v8 offset:2048
ds_read_b128 v[40:43], v8 offset:4096
ds_read_b128 v[44:47], v8 offset:6144
s_mov_b32 s92, 19
K1_yA_loop:
s_waitcnt lgkmcnt(0)
v_mfma_f32_16x16x32_bf16 v[128:131], v[32:35], v[48:51], v[128:131]
ds_read_b128 v[64:67], v9 offset:0
ds_read_b64_tr_b16 v[80:81], v16 offset:8192
v_mfma_f32_16x16x32_bf16 v[132:135], v[32:35], v[52:55], v[132:135]
ds_read_b64_tr_b16 v[82:83], v17 offset:8192
v_mfma_f32_16x16x32_bf16 v[136:139], v[32:35], v[56:59], v[136:139]
ds_read_b64_tr_b16 v[84:85], v16 offset:10240
v_mfma_f32_16x16x32_bf16 v[140:143], v[32:35], v[60:63], v[140:143]
ds_read_b64_tr_b16 v[86:87], v17 offset:10240
v_mfma_f32_16x16x32_bf16 v[156:159], v[36:39], v[60:63], v[156:159]
ds_read_b64_tr_b16 v[88:89], v16 offset:8448
v_mfma_f32_16x16x32_bf16 v[152:155], v[36:39], v[56:59], v[152:155]
ds_read_b64_tr_b16 v[90:91], v17 offset:8448
ds_read_b64_tr_b16 v[92:93], v16 offset:10496
v_mfma_f32_16x16x32_bf16 v[148:151], v[36:39], v[52:55], v[148:151]
ds_read_b64_tr_b16 v[94:95], v17 offset:10496
v_mfma_f32_16x16x32_bf16 v[144:147], v[36:39], v[48:51], v[144:147]
ds_read_b128 v[68:71], v9 offset:2048
v_mfma_f32_16x16x32_bf16 v[160:163], v[40:43], v[48:51], v[160:163]
ds_read_b128 v[72:75], v9 offset:4096
v_mfma_f32_16x16x32_bf16 v[164:167], v[40:43], v[52:55], v[164:167]
ds_read_b128 v[76:79], v9 offset:6144
v_mfma_f32_16x16x32_bf16 v[168:171], v[40:43], v[56:59], v[168:171]
v_mfma_f32_16x16x32_bf16 v[172:175], v[40:43], v[60:63], v[172:175]
v_mfma_f32_16x16x32_bf16 v[188:191], v[44:47], v[60:63], v[188:191]
v_mfma_f32_16x16x32_bf16 v[184:187], v[44:47], v[56:59], v[184:187]
v_mfma_f32_16x16x32_bf16 v[180:183], v[44:47], v[52:55], v[180:183]
v_mfma_f32_16x16x32_bf16 v[176:179], v[44:47], v[48:51], v[176:179]
s_waitcnt lgkmcnt(0)
v_mfma_f32_16x16x32_bf16 v[128:131], v[64:67], v[80:83], v[128:131]
s_add_u32 s93, s93, 1
s_cmp_eq_u32 s93, 4
s_cselect_b32 s94, 4294868992, s95
s_cselect_b32 s93, 0, s93
v_mfma_f32_16x16x32_bf16 v[132:135], v[64:67], v[84:87], v[132:135]
v_add_u32 v8, s94, v8
v_add_u32 v9, s94, v9
v_mfma_f32_16x16x32_bf16 v[136:139], v[64:67], v[88:91], v[136:139]
v_add_u32 v16, s94, v16
v_add_u32 v17, s94, v17
v_mfma_f32_16x16x32_bf16 v[140:143], v[64:67], v[92:95], v[140:143]
s_barrier
ds_read_b128 v[32:35], v8 offset:0
ds_read_b64_tr_b16 v[48:49], v16 offset:0
v_mfma_f32_16x16x32_bf16 v[156:159], v[68:71], v[92:95], v[156:159]
ds_read_b64_tr_b16 v[50:51], v17 offset:0
ds_read_b64_tr_b16 v[52:53], v16 offset:2048
v_mfma_f32_16x16x32_bf16 v[152:155], v[68:71], v[88:91], v[152:155]
ds_read_b64_tr_b16 v[54:55], v17 offset:2048
ds_read_b64_tr_b16 v[56:57], v16 offset:256
v_mfma_f32_16x16x32_bf16 v[148:151], v[68:71], v[84:87], v[148:151]
ds_read_b64_tr_b16 v[58:59], v17 offset:256
v_mfma_f32_16x16x32_bf16 v[144:147], v[68:71], v[80:83], v[144:147]
ds_read_b64_tr_b16 v[60:61], v16 offset:2304
ds_read_b64_tr_b16 v[62:63], v17 offset:2304
v_mfma_f32_16x16x32_bf16 v[160:163], v[72:75], v[80:83], v[160:163]
ds_read_b128 v[36:39], v8 offset:2048
ds_read_b128 v[40:43], v8 offset:4096
v_mfma_f32_16x16x32_bf16 v[164:167], v[72:75], v[84:87], v[164:167]
ds_read_b128 v[44:47], v8 offset:6144
v_mfma_f32_16x16x32_bf16 v[168:171], v[72:75], v[88:91], v[168:171]
v_mfma_f32_16x16x32_bf16 v[172:175], v[72:75], v[92:95], v[172:175]
v_mfma_f32_16x16x32_bf16 v[188:191], v[76:79], v[92:95], v[188:191]
v_mfma_f32_16x16x32_bf16 v[184:187], v[76:79], v[88:91], v[184:187]
v_mfma_f32_16x16x32_bf16 v[180:183], v[76:79], v[84:87], v[180:183]
v_mfma_f32_16x16x32_bf16 v[176:179], v[76:79], v[80:83], v[176:179]
s_sub_u32 s92, s92, 1
s_cmp_lg_u32 s92, 0
s_cbranch_scc1 K1_yA_loop
s_waitcnt lgkmcnt(0)
v_mfma_f32_16x16x32_bf16 v[128:131], v[32:35], v[48:51], v[128:131]
ds_read_b128 v[64:67], v9 offset:0
ds_read_b64_tr_b16 v[80:81], v16 offset:8192
v_mfma_f32_16x16x32_bf16 v[132:135], v[32:35], v[52:55], v[132:135]
ds_read_b64_tr_b16 v[82:83], v17 offset:8192
v_mfma_f32_16x16x32_bf16 v[136:139], v[32:35], v[56:59], v[136:139]
ds_read_b64_tr_b16 v[84:85], v16 offset:10240
v_mfma_f32_16x16x32_bf16 v[140:143], v[32:35], v[60:63], v[140:143]
ds_read_b64_tr_b16 v[86:87], v17 offset:10240
v_mfma_f32_16x16x32_bf16 v[156:159], v[36:39], v[60:63], v[156:159]
ds_read_b64_tr_b16 v[88:89], v16 offset:8448
v_mfma_f32_16x16x32_bf16 v[152:155], v[36:39], v[56:59], v[152:155]
ds_read_b64_tr_b16 v[90:91], v17 offset:8448
ds_read_b64_tr_b16 v[92:93], v16 offset:10496
v_mfma_f32_16x16x32_bf16 v[148:151], v[36:39], v[52:55], v[148:151]
ds_read_b64_tr_b16 v[94:95], v17 offset:10496
v_mfma_f32_16x16x32_bf16 v[144:147], v[36:39], v[48:51], v[144:147]
ds_read_b128 v[68:71], v9 offset:2048
v_mfma_f32_16x16x32_bf16 v[160:163], v[40:43], v[48:51], v[160:163]
ds_read_b128 v[72:75], v9 offset:4096
v_mfma_f32_16x16x32_bf16 v[164:167], v[40:43], v[52:55], v[164:167]
ds_read_b128 v[76:79], v9 offset:6144
v_mfma_f32_16x16x32_bf16 v[168:171], v[40:43], v[56:59], v[168:171]
v_mfma_f32_16x16x32_bf16 v[172:175], v[40:43], v[60:63], v[172:175]
v_mfma_f32_16x16x32_bf16 v[188:191], v[44:47], v[60:63], v[188:191]
v_mfma_f32_16x16x32_bf16 v[184:187], v[44:47], v[56:59], v[184:187]
v_mfma_f32_16x16x32_bf16 v[180:183], v[44:47], v[52:55], v[180:183]
v_mfma_f32_16x16x32_bf16 v[176:179], v[44:47], v[48:51], v[176:179]
s_waitcnt lgkmcnt(0)
v_mfma_f32_16x16x32_bf16 v[128:131], v[64:67], v[80:83], v[128:131]
s_add_u32 s93, s93, 1
s_cmp_eq_u32 s93, 4
s_cselect_b32 s94, 4294868992, s95
s_cselect_b32 s93, 0, s93
v_mfma_f32_16x16x32_bf16 v[132:135], v[64:67], v[84:87], v[132:135]
v_mfma_f32_16x16x32_bf16 v[136:139], v[64:67], v[88:91], v[136:139]
v_mfma_f32_16x16x32_bf16 v[140:143], v[64:67], v[92:95], v[140:143]
s_barrier
ds_read_b128 v[32:35], v10 offset:0
ds_read_b64_tr_b16 v[48:49], v12 offset:0
v_mfma_f32_16x16x32_bf16 v[156:159], v[68:71], v[92:95], v[156:159]
ds_read_b64_tr_b16 v[50:51], v12 offset:4096
ds_read_b64_tr_b16 v[52:53], v13 offset:0
v_mfma_f32_16x16x32_bf16 v[152:155], v[68:71], v[88:91], v[152:155]
ds_read_b64_tr_b16 v[54:55], v13 offset:4096
ds_read_b64_tr_b16 v[56:57], v14 offset:0
v_mfma_f32_16x16x32_bf16 v[148:151], v[68:71], v[84:87], v[148:151]
ds_read_b64_tr_b16 v[58:59], v14 offset:4096
v_mfma_f32_16x16x32_bf16 v[144:147], v[68:71], v[80:83], v[144:147]
ds_read_b64_tr_b16 v[60:61], v15 offset:0
ds_read_b64_tr_b16 v[62:63], v15 offset:4096
v_mfma_f32_16x16x32_bf16 v[160:163], v[72:75], v[80:83], v[160:163]
ds_read_b128 v[36:39], v10 offset:2048
ds_read_b128 v[40:43], v10 offset:4096
v_mfma_f32_16x16x32_bf16 v[164:167], v[72:75], v[84:87], v[164:167]
ds_read_b128 v[44:47], v10 offset:6144
v_mfma_f32_16x16x32_bf16 v[168:171], v[72:75], v[88:91], v[168:171]
v_mfma_f32_16x16x32_bf16 v[172:175], v[72:75], v[92:95], v[172:175]
v_mfma_f32_16x16x32_bf16 v[188:191], v[76:79], v[92:95], v[188:191]
v_mfma_f32_16x16x32_bf16 v[184:187], v[76:79], v[88:91], v[184:187]
v_mfma_f32_16x16x32_bf16 v[180:183], v[76:79], v[84:87], v[180:183]
v_mfma_f32_16x16x32_bf16 v[176:179], v[76:79], v[80:83], v[176:179]
s_mov_b32 s92, s86
s_mov_b32 s91, s87
K1_yB_loop:
s_waitcnt lgkmcnt(0)
v_mfma_f32_16x16x32_bf16 v[128:131], v[32:35], v[48:51], v[128:131]
ds_read_b128 v[64:67], v10 offset:1024
ds_read_b64_tr_b16 v[80:81], v12 offset:8192
v_mfma_f32_16x16x32_bf16 v[132:135], v[32:35], v[52:55], v[132:135]
ds_read_b64_tr_b16 v[82:83], v12 offset:12288
v_mfma_f32_16x16x32_bf16 v[136:139], v[32:35], v[56:59], v[136:139]
ds_read_b64_tr_b16 v[84:85], v13 offset:8192
v_mfma_f32_16x16x32_bf16 v[140:143], v[32:35], v[60:63], v[140:143]
ds_read_b64_tr_b16 v[86:87], v13 offset:12288
v_mfma_f32_16x16x32_bf16 v[156:159], v[36:39], v[60:63], v[156:159]
ds_read_b64_tr_b16 v[88:89], v14 offset:8192
v_mfma_f32_16x16x32_bf16 v[152:155], v[36:39], v[56:59], v[152:155]
ds_read_b64_tr_b16 v[90:91], v14 offset:12288
ds_read_b64_tr_b16 v[92:93], v15 offset:8192
v_mfma_f32_16x16x32_bf16 v[148:151], v[36:39], v[52:55], v[148:151]
ds_read_b64_tr_b16 v[94:95], v15 offset:12288
v_mfma_f32_16x16x32_bf16 v[144:147], v[36:39], v[48:51], v[144:147]
ds_read_b128 v[68:71], v10 offset:3072
v_mfma_f32_16x16x32_bf16 v[160:163], v[40:43], v[48:51], v[160:163]
ds_read_b128 v[72:75], v10 offset:5120
v_mfma_f32_16x16x32_bf16 v[164:167], v[40:43], v[52:55], v[164:167]
ds_read_b128 v[76:79], v10 offset:7168
v_mfma_f32_16x16x32_bf16 v[168:171], v[40:43], v[56:59], v[168:171]
v_mfma_f32_16x16x32_bf16 v[172:175], v[40:43], v[60:63], v[172:175]
v_mfma_f32_16x16x32_bf16 v[188:191], v[44:47], v[60:63], v[188:191]
v_mfma_f32_16x16x32_bf16 v[184:187], v[44:47], v[56:59], v[184:187]
v_mfma_f32_16x16x32_bf16 v[180:183], v[44:47], v[52:55], v[180:183]
v_mfma_f32_16x16x32_bf16 v[176:179], v[44:47], v[48:51], v[176:179]
s_waitcnt lgkmcnt(0)
v_mfma_f32_16x16x32_bf16 v[128:131], v[64:67], v[80:83], v[128:131]
s_add_u32 s93, s93, 1
s_cmp_eq_u32 s93, 4
s_cselect_b32 s94, 4294868992, s95
s_cselect_b32 s93, 0, s93
v_mfma_f32_16x16x32_bf16 v[132:135], v[64:67], v[84:87], v[132:135]
v_add_u32 v10, s94, v10
v_add_u32 v12, s94, v12
v_add_u32 v13, s94, v13
v_mfma_f32_16x16x32_bf16 v[136:139], v[64:67], v[88:91], v[136:139]
v_add_u32 v14, s94, v14
v_add_u32 v15, s94, v15
v_mfma_f32_16x16x32_bf16 v[140:143], v[64:67], v[92:95], v[140:143]
s_barrier
ds_read_b128 v[32:35], v10 offset:0
ds_read_b64_tr_b16 v[48:49], v12 offset:0
v_mfma_f32_16x16x32_bf16 v[156:159], v[68:71], v[92:95], v[156:159]
ds_read_b64_tr_b16 v[50:51], v12 offset:4096
ds_read_b64_tr_b16 v[52:53], v13 offset:0
v_mfma_f32_16x16x32_bf16 v[152:155], v[68:71], v[88:91], v[152:155]
ds_read_b64_tr_b16 v[54:55], v13 offset:4096
ds_read_b64_tr_b16 v[56:57], v14 offset:0
v_mfma_f32_16x16x32_bf16 v[148:151], v[68:71], v[84:87], v[148:151]
ds_read_b64_tr_b16 v[58:59], v14 offset:4096
v_mfma_f32_16x16x32_bf16 v[144:147], v[68:71], v[80:83], v[144:147]
ds_read_b64_tr_b16 v[60:61], v15 offset:0
ds_read_b64_tr_b16 v[62:63], v15 offset:4096
v_mfma_f32_16x16x32_bf16 v[160:163], v[72:75], v[80:83], v[160:163]
ds_read_b128 v[36:39], v10 offset:2048
ds_read_b128 v[40:43], v10 offset:4096
v_mfma_f32_16x16x32_bf16 v[164:167], v[72:75], v[84:87], v[164:167]
ds_read_b128 v[44:47], v10 offset:6144
v_mfma_f32_16x16x32_bf16 v[168:171], v[72:75], v[88:91], v[168:171]
v_mfma_f32_16x16x32_bf16 v[172:175], v[72:75], v[92:95], v[172:175]
v_mfma_f32_16x16x32_bf16 v[188:191], v[76:79], v[92:95], v[188:191]
v_mfma_f32_16x16x32_bf16 v[184:187], v[76:79], v[88:91], v[184:187]
v_mfma_f32_16x16x32_bf16 v[180:183], v[76:79], v[84:87], v[180:183]
v_mfma_f32_16x16x32_bf16 v[176:179], v[76:79], v[80:83], v[176:179]
s_sub_u32 s92, s92, 1
s_cmp_lg_u32 s92, 0
s_cbranch_scc1 K1_yB_loop
s_cmp_ge_u32 s91, 2
s_cbranch_scc1 K1_yB_tail
s_cmp_eq_u32 s91, 1
s_cbranch_scc1 K1_yB_ph1
buffer_load_dword v24, v22, s[24:27], s70 offen sc1
s_mov_b32 s92, 2
s_mov_b32 s91, 1
s_branch K1_yB_loop
K1_yB_ph1:
s_waitcnt vmcnt(0)
v_readfirstlane_b32 s71, v24
s_mov_b32 s92, 1
s_mov_b32 s91, 2
s_cmp_lg_u32 s71, 1
s_cbranch_scc1 K1_yB_again
s_add_u32 s72, s69, 0
buffer_load_dwordx4 v[192:195], v21, s[24:27], s72 offen offset:0 sc1
buffer_load_dwordx4 v[196:199], v21, s[24:27], s72 offen offset:1024 sc1
buffer_load_dwordx4 v[200:203], v21, s[24:27], s72 offen offset:2048 sc1
buffer_load_dwordx4 v[204:207], v21, s[24:27], s72 offen offset:3072 sc1
s_add_u32 s72, s69, 4096
buffer_load_dwordx4 v[208:211], v21, s[24:27], s72 offen offset:0 sc1
buffer_load_dwordx4 v[212:215], v21, s[24:27], s72 offen offset:1024 sc1
buffer_load_dwordx4 v[216:219], v21, s[24:27], s72 offen offset:2048 sc1
buffer_load_dwordx4 v[220:223], v21, s[24:27], s72 offen offset:3072 sc1
s_add_u32 s72, s69, 8192
buffer_load_dwordx4 v[224:227], v21, s[24:27], s72 offen offset:0 sc1
buffer_load_dwordx4 v[228:231], v21, s[24:27], s72 offen offset:1024 sc1
buffer_load_dwordx4 v[232:235], v21, s[24:27], s72 offen offset:2048 sc1
buffer_load_dwordx4 v[236:239], v21, s[24:27], s72 offen offset:3072 sc1
s_add_u32 s72, s69, 12288
buffer_load_dwordx4 v[240:243], v21, s[24:27], s72 offen offset:0 sc1
buffer_load_dwordx4 v[244:247], v21, s[24:27], s72 offen offset:1024 sc1
buffer_load_dwordx4 v[248:251], v21, s[24:27], s72 offen offset:2048 sc1
buffer_load_dwordx4 v[252:255], v21, s[24:27], s72 offen offset:3072 sc1
s_branch K1_yB_loop
K1_yB_again:
buffer_load_dword v24, v22, s[24:27], s70 offen sc1
s_mov_b32 s91, 4
s_branch K1_yB_loop
K1_yB_tail:
s_cmp_lg_u32 s91, 4
s_cbranch_scc1 K1_yB_tail2
s_waitcnt vmcnt(0)
v_readfirstlane_b32 s71, v24
s_cmp_lg_u32 s71, 1
s_cbranch_scc1 K1_yB_tail2
s_add_u32 s72, s69, 0
buffer_load_dwordx4 v[192:195], v21, s[24:27], s72 offen offset:0 sc1
buffer_load_dwordx4 v[196:199], v21, s[24:27], s72 offen offset:1024 sc1
buffer_load_dwordx4 v[200:203], v21, s[24:27], s72 offen offset:2048 sc1
buffer_load_dwordx4 v[204:207], v21, s[24:27], s72 offen offset:3072 sc1
s_add_u32 s72, s69, 4096
buffer_load_dwordx4 v[208:211], v21, s[24:27], s72 offen offset:0 sc1
buffer_load_dwordx4 v[212:215], v21, s[24:27], s72 offen offset:1024 sc1
buffer_load_dwordx4 v[216:219], v21, s[24:27], s72 offen offset:2048 sc1
buffer_load_dwordx4 v[220:223], v21, s[24:27], s72 offen offset:3072 sc1
s_add_u32 s72, s69, 8192
buffer_load_dwordx4 v[224:227], v21, s[24:27], s72 offen offset:0 sc1
buffer_load_dwordx4 v[228:231], v21, s[24:27], s72 offen offset:1024 sc1
buffer_load_dwordx4 v[232:235], v21, s[24:27], s72 offen offset:2048 sc1
buffer_load_dwordx4 v[236:239], v21, s[24:27], s72 offen offset:3072 sc1
s_add_u32 s72, s69, 12288
buffer_load_dwordx4 v[240:243], v21, s[24:27], s72 offen offset:0 sc1
buffer_load_dwordx4 v[244:247], v21, s[24:27], s72 offen offset:1024 sc1
buffer_load_dwordx4 v[248:251], v21, s[24:27], s72 offen offset:2048 sc1
buffer_load_dwordx4 v[252:255], v21, s[24:27], s72 offen offset:3072 sc1
K1_yB_tail2:
s_waitcnt lgkmcnt(0)
v_mfma_f32_16x16x32_bf16 v[128:131], v[32:35], v[48:51], v[128:131]
ds_read_b128 v[64:67], v10 offset:1024
ds_read_b64_tr_b16 v[80:81], v12 offset:8192
v_mfma_f32_16x16x32_bf16 v[132:135], v[32:35], v[52:55], v[132:135]
ds_read_b64_tr_b16 v[82:83], v12 offset:12288
v_mfma_f32_16x16x32_bf16 v[136:139], v[32:35], v[56:59], v[136:139]
ds_read_b64_tr_b16 v[84:85], v13 offset:8192
v_mfma_f32_16x16x32_bf16 v[140:143], v[32:35], v[60:63], v[140:143]
ds_read_b64_tr_b16 v[86:87], v13 offset:12288
v_mfma_f32_16x16x32_bf16 v[156:159], v[36:39], v[60:63], v[156:159]
ds_read_b64_tr_b16 v[88:89], v14 offset:8192
v_mfma_f32_16x16x32_bf16 v[152:155], v[36:39], v[56:59], v[152:155]
ds_read_b64_tr_b16 v[90:91], v14 offset:12288
ds_read_b64_tr_b16 v[92:93], v15 offset:8192
v_mfma_f32_16x16x32_bf16 v[148:151], v[36:39], v[52:55], v[148:151]
ds_read_b64_tr_b16 v[94:95], v15 offset:12288
v_mfma_f32_16x16x32_bf16 v[144:147], v[36:39], v[48:51], v[144:147]
ds_read_b128 v[68:71], v10 offset:3072
v_mfma_f32_16x16x32_bf16 v[160:163], v[40:43], v[48:51], v[160:163]
ds_read_b128 v[72:75], v10 offset:5120
v_mfma_f32_16x16x32_bf16 v[164:167], v[40:43], v[52:55], v[164:167]
ds_read_b128 v[76:79], v10 offset:7168
v_mfma_f32_16x16x32_bf16 v[168:171], v[40:43], v[56:59], v[168:171]
v_mfma_f32_16x16x32_bf16 v[172:175], v[40:43], v[60:63], v[172:175]
v_mfma_f32_16x16x32_bf16 v[188:191], v[44:47], v[60:63], v[188:191]
v_mfma_f32_16x16x32_bf16 v[184:187], v[44:47], v[56:59], v[184:187]
v_mfma_f32_16x16x32_bf16 v[180:183], v[44:47], v[52:55], v[180:183]
v_mfma_f32_16x16x32_bf16 v[176:179], v[44:47], v[48:51], v[176:179]
s_waitcnt lgkmcnt(0)
v_mfma_f32_16x16x32_bf16 v[128:131], v[64:67], v[80:83], v[128:131]
v_mfma_f32_16x16x32_bf16 v[132:135], v[64:67], v[84:87], v[132:135]
v_mfma_f32_16x16x32_bf16 v[136:139], v[64:67], v[88:91], v[136:139]
v_mfma_f32_16x16x32_bf16 v[140:143], v[64:67], v[92:95], v[140:143]
v_mfma_f32_16x16x32_bf16 v[156:159], v[68:71], v[92:95], v[156:159]
v_mfma_f32_16x16x32_bf16 v[152:155], v[68:71], v[88:91], v[152:155]
v_mfma_f32_16x16x32_bf16 v[148:151], v[68:71], v[84:87], v[148:151]
v_mfma_f32_16x16x32_bf16 v[144:147], v[68:71], v[80:83], v[144:147]
v_mfma_f32_16x16x32_bf16 v[160:163], v[72:75], v[80:83], v[160:163]
v_mfma_f32_16x16x32_bf16 v[164:167], v[72:75], v[84:87], v[164:167]
v_mfma_f32_16x16x32_bf16 v[168:171], v[72:75], v[88:91], v[168:171]
v_mfma_f32_16x16x32_bf16 v[172:175], v[72:75], v[92:95], v[172:175]
v_mfma_f32_16x16x32_bf16 v[188:191], v[76:79], v[92:95], v[188:191]
v_mfma_f32_16x16x32_bf16 v[184:187], v[76:79], v[88:91], v[184:187]
v_mfma_f32_16x16x32_bf16 v[180:183], v[76:79], v[84:87], v[180:183]
v_mfma_f32_16x16x32_bf16 v[176:179], v[76:79], v[80:83], v[176:179]
s_cmp_eq_u32 s91, 3
s_cbranch_scc1 K1_send
s_cmp_eq_u32 s71, 1
s_cbranch_scc1 K1_have
s_mov_b32 s73, 0x40000
K1_xpoll:
buffer_load_dword v24, v22, s[24:27], s70 offen sc1
s_waitcnt vmcnt(0)
v_readfirstlane_b32 s71, v24
s_cmp_eq_u32 s71, 1
s_cbranch_scc1 K1_xok
s_sleep 1
s_sub_u32 s73, s73, 1
s_cmp_lg_u32 s73, 0
s_cbranch_scc1 K1_xpoll
K1_xok:
s_add_u32 s72, s69, 0
buffer_load_dwordx4 v[192:195], v21, s[24:27], s72 offen offset:0 sc1
buffer_load_dwordx4 v[196:199], v21, s[24:27], s72 offen offset:1024 sc1
buffer_load_dwordx4 v[200:203], v21, s[24:27], s72 offen offset:2048 sc1
buffer_load_dwordx4 v[204:207], v21, s[24:27], s72 offen offset:3072 sc1
s_add_u32 s72, s69, 4096
buffer_load_dwordx4 v[208:211], v21, s[24:27], s72 offen offset:0 sc1
buffer_load_dwordx4 v[212:215], v21, s[24:27], s72 offen offset:1024 sc1
buffer_load_dwordx4 v[216:219], v21, s[24:27], s72 offen offset:2048 sc1
buffer_load_dwordx4 v[220:223], v21, s[24:27], s72 offen offset:3072 sc1
s_add_u32 s72, s69, 8192
buffer_load_dwordx4 v[224:227], v21, s[24:27], s72 offen offset:0 sc1
buffer_load_dwordx4 v[228:231], v21, s[24:27], s72 offen offset:1024 sc1
buffer_load_dwordx4 v[232:235], v21, s[24:27], s72 offen offset:2048 sc1
buffer_load_dwordx4 v[236:239], v21, s[24:27], s72 offen offset:3072 sc1
s_add_u32 s72, s69, 12288
buffer_load_dwordx4 v[240:243], v21, s[24:27], s72 offen offset:0 sc1
buffer_load_dwordx4 v[244:247], v21, s[24:27], s72 offen offset:1024 sc1
buffer_load_dwordx4 v[248:251], v21, s[24:27], s72 offen offset:2048 sc1
buffer_load_dwordx4 v[252:255], v21, s[24:27], s72 offen offset:3072 sc1
K1_have:
s_lshl_b32 s65, s62, 12
s_lshl_b32 s66, s64, 2
s_add_u32 s65, s65, s66
s_nop 7
s_nop 3
s_waitcnt vmcnt(15)
v_pk_add_f32 v[128:129], v[128:129], v[192:193]
v_pk_add_f32 v[130:131], v[130:131], v[194:195]
ds_write_b128 v25, v[128:131] offset:0
s_waitcnt vmcnt(14)
v_pk_add_f32 v[132:133], v[132:133], v[196:197]
v_pk_add_f32 v[134:135], v[134:135], v[198:199]
ds_write_b128 v25, v[132:135] offset:4352
s_waitcnt vmcnt(13)
v_pk_add_f32 v[136:137], v[136:137], v[200:201]
v_pk_add_f32 v[138:139], v[138:139], v[202:203]
ds_write_b128 v25, v[136:139] offset:8704
s_waitcnt vmcnt(12)
v_pk_add_f32 v[140:141], v[140:141], v[204:205]
v_pk_add_f32 v[142:143], v[142:143], v[206:207]
ds_write_b128 v25, v[140:143] offset:13056
s_waitcnt vmcnt(11)
v_pk_add_f32 v[144:145], v[144:145], v[208:209]
v_pk_add_f32 v[146:147], v[146:147], v[210:211]
ds_write_b128 v25, v[144:147] offset:64
s_waitcnt vmcnt(10)
v_pk_add_f32 v[148:149], v[148:149], v[212:213]
v_pk_add_f32 v[150:151], v[150:151], v[214:215]
ds_write_b128 v25, v[148:151] offset:4416
s_waitcnt vmcnt(9)
v_pk_add_f32 v[152:153], v[152:153], v[216:217]
v_pk_add_f32 v[154:155], v[154:155], v[218:219]
ds_write_b128 v25, v[152:155] offset:8768
s_waitcnt vmcnt(8)
v_pk_add_f32 v[156:157], v[156:157], v[220:221]
v_pk_add_f32 v[158:159], v[158:159], v[222:223]
ds_write_b128 v25, v[156:159] offset:13120
s_waitcnt vmcnt(7)
v_pk_add_f32 v[160:161], v[160:161], v[224:225]
v_pk_add_f32 v[162:163], v[162:163], v[226:227]
ds_write_b128 v25, v[160:163] offset:128
s_waitcnt vmcnt(6)
v_pk_add_f32 v[164:165], v[164:165], v[228:229]
v_pk_add_f32 v[166:167], v[166:167], v[230:231]
ds_write_b128 v25, v[164:167] offset:4480
s_waitcnt vmcnt(5)
v_pk_add_f32 v[168:169], v[168:169], v[232:233]
v_pk_add_f32 v[170:171], v[170:171], v[234:235]
ds_write_b128 v25, v[168:171] offset:8832
s_waitcnt vmcnt(4)
v_pk_add_f32 v[172:173], v[172:173], v[236:237]
v_pk_add_f32 v[174:175], v[174:175], v[238:239]
ds_write_b128 v25, v[172:175] offset:13184
s_waitcnt vmcnt(3)
v_pk_add_f32 v[176:177], v[176:177], v[240:241]
v_pk_add_f32 v[178:179], v[178:179], v[242:243]
ds_write_b128 v25, v[176:179] offset:192
s_waitcnt vmcnt(2)
v_pk_add_f32 v[180:181], v[180:181], v[244:245]
v_pk_add_f32 v[182:183], v[182:183], v[246:247]
ds_write_b128 v25, v[180:183] offset:4544
s_waitcnt vmcnt(1)
v_pk_add_f32 v[184:185], v[184:185], v[248:249]
v_pk_add_f32 v[186:187], v[186:187], v[250:251]
ds_write_b128 v25, v[184:187] offset:8896
s_waitcnt vmcnt(0)
v_pk_add_f32 v[188:189], v[188:189], v[252:253]
v_pk_add_f32 v[190:191], v[190:191], v[254:255]
ds_write_b128 v25, v[188:191] offset:13248
s_waitcnt lgkmcnt(0)
ds_read_b128 v[32:35], v26 offset:0
ds_read_b128 v[36:39], v26 offset:1088
ds_read_b128 v[40:43], v26 offset:2176
ds_read_b128 v[44:47], v26 offset:3264
ds_read_b128 v[48:51], v26 offset:4352
ds_read_b128 v[52:55], v26 offset:5440
ds_read_b128 v[56:59], v26 offset:6528
ds_read_b128 v[60:63], v26 offset:7616
ds_read_b128 v[64:67], v26 offset:8704
ds_read_b128 v[68:71], v26 offset:9792
ds_read_b128 v[72:75], v26 offset:10880
ds_read_b128 v[76:79], v26 offset:11968
ds_read_b128 v[80:83], v26 offset:13056
ds_read_b128 v[84:87], v26 offset:14144
ds_read_b128 v[88:91], v26 offset:15232
ds_read_b128 v[92:95], v26 offset:16320
s_waitcnt lgkmcnt(15)
buffer_store_dwordx4 v[32:35], v20, s[28:31], s65 offen nt
s_add_u32 s65, s65, 16384
s_waitcnt lgkmcnt(14)
buffer_store_dwordx4 v[36:39], v20, s[28:31], s65 offen nt
s_add_u32 s65, s65, 16384
s_waitcnt lgkmcnt(13)
buffer_store_dwordx4 v[40:43], v20, s[28:31], s65 offen nt
s_add_u32 s65, s65, 16384
s_waitcnt lgkmcnt(12)
buffer_store_dwordx4 v[44:47], v20, s[28:31], s65 offen nt
s_add_u32 s65, s65, 16384
s_waitcnt lgkmcnt(11)
buffer_store_dwordx4 v[48:51], v20, s[28:31], s65 offen nt
s_add_u32 s65, s65, 16384
s_waitcnt lgkmcnt(10)
buffer_store_dwordx4 v[52:55], v20, s[28:31], s65 offen nt
s_add_u32 s65, s65, 16384
s_waitcnt lgkmcnt(9)
buffer_store_dwordx4 v[56:59], v20, s[28:31], s65 offen nt
s_add_u32 s65, s65, 16384
s_waitcnt lgkmcnt(8)
buffer_store_dwordx4 v[60:63], v20, s[28:31], s65 offen nt
s_add_u32 s65, s65, 16384
s_waitcnt lgkmcnt(7)
buffer_store_dwordx4 v[64:67], v20, s[28:31], s65 offen nt
s_add_u32 s65, s65, 16384
s_waitcnt lgkmcnt(6)
buffer_store_dwordx4 v[68:71], v20, s[28:31], s65 offen nt
s_add_u32 s65, s65, 16384
s_waitcnt lgkmcnt(5)
buffer_store_dwordx4 v[72:75], v20, s[28:31], s65 offen nt
s_add_u32 s65, s65, 16384
s_waitcnt lgkmcnt(4)
buffer_store_dwordx4 v[76:79], v20, s[28:31], s65 offen nt
s_add_u32 s65, s65, 16384
s_waitcnt lgkmcnt(3)
buffer_store_dwordx4 v[80:83], v20, s[28:31], s65 offen nt
s_add_u32 s65, s65, 16384
s_waitcnt lgkmcnt(2)
buffer_store_dwordx4 v[84:87], v20, s[28:31], s65 offen nt
s_add_u32 s65, s65, 16384
s_waitcnt lgkmcnt(1)
buffer_store_dwordx4 v[88:91], v20, s[28:31], s65 offen nt
s_add_u32 s65, s65, 16384
s_waitcnt lgkmcnt(0)
buffer_store_dwordx4 v[92:95], v20, s[28:31], s65 offen nt
s_endpgm
K1_send:
s_nop 7
s_add_u32 s72, s69, 0
buffer_store_dwordx4 v[128:131], v21, s[24:27], s72 offen offset:0 sc1
buffer_store_dwordx4 v[132:135], v21, s[24:27], s72 offen offset:1024 sc1
buffer_store_dwordx4 v[136:139], v21, s[24:27], s72 offen offset:2048 sc1
buffer_store_dwordx4 v[140:143], v21, s[24:27], s72 offen offset:3072 sc1
s_add_u32 s72, s69, 4096
buffer_store_dwordx4 v[144:147], v21, s[24:27], s72 offen offset:0 sc1
buffer_store_dwordx4 v[148:151], v21, s[24:27], s72 offen offset:1024 sc1
buffer_store_dwordx4 v[152:155], v21, s[24:27], s72 offen offset:2048 sc1
buffer_store_dwordx4 v[156:159], v21, s[24:27], s72 offen offset:3072 sc1
s_add_u32 s72, s69, 8192
buffer_store_dwordx4 v[160:163], v21, s[24:27], s72 offen offset:0 sc1
buffer_store_dwordx4 v[164:167], v21, s[24:27], s72 offen offset:1024 sc1
buffer_store_dwordx4 v[168:171], v21, s[24:27], s72 offen offset:2048 sc1
buffer_store_dwordx4 v[172:175], v21, s[24:27], s72 offen offset:3072 sc1
s_add_u32 s72, s69, 12288
buffer_store_dwordx4 v[176:179], v21, s[24:27], s72 offen offset:0 sc1
buffer_store_dwordx4 v[180:183], v21, s[24:27], s72 offen offset:1024 sc1
buffer_store_dwordx4 v[184:187], v21, s[24:27], s72 offen offset:2048 sc1
buffer_store_dwordx4 v[188:191], v21, s[24:27], s72 offen offset:3072 sc1
s_waitcnt vmcnt(0)
s_mov_b64 exec, 1
buffer_store_dword v23, v22, s[24:27], s70 offen sc1
s_mov_b64 exec, -1
s_endpgm
K1_g1prod:
v_lshrrev_b32 v2, 3, v1
v_and_b32 v3, 7, v1
v_lshrrev_b32 v4, 1, v2
v_xor_b32 v3, v3, v4
s_mov_b32 s90, 2048
v_mul_lo_u32 v2, v2, s90
v_lshlrev_b32 v3, 4, v3
v_add_u32 v8, v2, v3
v_xor_b32 v3, 64, v3
v_add_u32 v9, v2, v3
s_lshl_b32 s86, s39, 19
s_lshl_b32 s89, s40, 17
s_and_b32 s78, s33, 1
s_mul_i32 s66, s78, 12
s_mul_i32 s78, s78, 24
s_sub_u32 s78, s78, 20
s_mov_b32 s79, 52
s_mov_b32 s69, 52
s_mov_b32 s67, 16
s_mov_b32 s68, 32
v_lshlrev_b32 v10, 7, v1
v_and_b32 v11, 31, v1
v_lshlrev_b32 v11, 7, v11
s_mov_b32 s70, s3
s_cmp_eq_u32 s32, 5
s_cbranch_scc1 K1_g1p1
s_lshl_b32 s75, s70, 13
s_add_u32 s75, s75, 2097152
s_barrier
s_barrier
s_barrier
s_waitcnt vmcnt(39)
s_mov_b32 s80, 0
s_mov_b32 s87, 0
s_add_u32 s85, s87, s88
s_and_b32 s85, s85, 3
s_andn2_b32 s83, s87, 3
s_or_b32 s85, s85, s83
s_add_u32 s87, s87, 1
s_lshl_b32 s83, s85, 7
s_add_u32 s81, s83, s86
s_add_u32 s82, s83, s89
s_add_u32 m0, s80, 0
s_add_u32 s83, s81, 0
buffer_load_dwordx4 v8, s[24:27], s83 offen lds
s_add_u32 m0, m0, 1024
s_add_u32 s83, s81, 16384
buffer_load_dwordx4 v9, s[24:27], s83 offen lds
s_add_u32 m0, m0, 1024
s_add_u32 s83, s81, 32768
buffer_load_dwordx4 v8, s[24:27], s83 offen lds
s_add_u32 m0, m0, 1024
s_add_u32 s83, s81, 49152
buffer_load_dwordx4 v9, s[24:27], s83 offen lds
s_add_u32 m0, m0, 1024
s_add_u32 s83, s81, 65536
buffer_load_dwordx4 v8, s[24:27], s83 offen lds
s_add_u32 m0, m0, 1024
s_add_u32 s83, s81, 81920
buffer_load_dwordx4 v9, s[24:27], s83 offen lds
s_add_u32 m0, m0, 1024
s_add_u32 s83, s81, 98304
buffer_load_dwordx4 v8, s[24:27], s83 offen lds
s_add_u32 m0, m0, 1024
s_add_u32 s83, s81, 114688
buffer_load_dwordx4 v9, s[24:27], s83 offen lds
s_add_u32 m0, m0, 1024
s_add_u32 s83, s81, 131072
buffer_load_dwordx4 v8, s[24:27], s83 offen lds
s_add_u32 m0, m0, 1024
s_add_u32 s83, s81, 147456
buffer_load_dwordx4 v9, s[24:27], s83 offen lds
s_add_u32 m0, m0, 1024
s_add_u32 s83, s81, 163840
buffer_load_dwordx4 v8, s[24:27], s83 offen lds
s_add_u32 m0, m0, 1024
s_add_u32 s83, s81, 180224
buffer_load_dwordx4 v9, s[24:27], s83 offen lds
s_add_u32 m0, m0, 1024
s_add_u32 s83, s81, 196608
buffer_load_dwordx4 v8, s[24:27], s83 offen lds
s_add_u32 m0, m0, 1024
s_add_u32 s83, s81, 212992
buffer_load_dwordx4 v9, s[24:27], s83 offen lds
s_add_u32 m0, m0, 1024
s_add_u32 s83, s81, 229376
buffer_load_dwordx4 v8, s[24:27], s83 offen lds
s_add_u32 m0, m0, 1024
s_add_u32 s83, s81, 245760
buffer_load_dwordx4 v9, s[24:27], s83 offen lds
s_add_u32 m0, m0, 1024
s_add_u32 s83, s81, 262144
buffer_load_dwordx4 v8, s[24:27], s83 offen lds
s_add_u32 m0, m0, 1024
s_add_u32 s83, s81, 278528
buffer_load_dwordx4 v9, s[24:27], s83 offen lds
s_add_u32 m0, m0, 1024
s_add_u32 s83, s81, 294912
buffer_load_dwordx4 v8, s[24:27], s83 offen lds
s_add_u32 m0, m0, 1024
s_add_u32 s83, s81, 311296
buffer_load_dwordx4 v9, s[24:27], s83 offen lds
s_add_u32 m0, m0, 1024
s_add_u32 s83, s81, 327680
buffer_load_dwordx4 v8, s[24:27], s83 offen lds
s_add_u32 m0, m0, 1024
s_add_u32 s83, s81, 344064
buffer_load_dwordx4 v9, s[24:27], s83 offen lds
s_add_u32 m0, m0, 1024
s_add_u32 s83, s81, 360448
buffer_load_dwordx4 v8, s[24:27], s83 offen lds
s_add_u32 m0, m0, 1024
s_add_u32 s83, s81, 376832
buffer_load_dwordx4 v9, s[24:27], s83 offen lds
s_add_u32 s80, s80, 49152
s_cmp_eq_u32 s80, 147456
s_cselect_b32 s80, 0, s80
s_waitcnt vmcnt(39)
s_mov_b32 s80, 49152
s_mov_b32 s87, 1
s_add_u32 s85, s87, s88
s_and_b32 s85, s85, 3
s_andn2_b32 s83, s87, 3
s_or_b32 s85, s85, s83
s_add_u32 s87, s87, 1
s_lshl_b32 s83, s85, 7
s_add_u32 s81, s83, s86
s_add_u32 s82, s83, s89
s_add_u32 m0, s80, 0
s_add_u32 s83, s81, 0
buffer_load_dwordx4 v8, s[24:27], s83 offen lds
s_add_u32 m0, m0, 1024
s_add_u32 s83, s81, 16384
buffer_load_dwordx4 v9, s[24:27], s83 offen lds
s_add_u32 m0, m0, 1024
s_add_u32 s83, s81, 32768
buffer_load_dwordx4 v8, s[24:27], s83 offen lds
s_add_u32 m0, m0, 1024
s_add_u32 s83, s81, 49152
buffer_load_dwordx4 v9, s[24:27], s83 offen lds
s_add_u32 m0, m0, 1024
s_add_u32 s83, s81, 65536
buffer_load_dwordx4 v8, s[24:27], s83 offen lds
s_add_u32 m0, m0, 1024
s_add_u32 s83, s81, 81920
buffer_load_dwordx4 v9, s[24:27], s83 offen lds
s_add_u32 m0, m0, 1024
s_add_u32 s83, s81, 98304
buffer_load_dwordx4 v8, s[24:27], s83 offen lds
s_add_u32 m0, m0, 1024
s_add_u32 s83, s81, 114688
buffer_load_dwordx4 v9, s[24:27], s83 offen lds
s_add_u32 m0, m0, 1024
s_add_u32 s83, s81, 131072
buffer_load_dwordx4 v8, s[24:27], s83 offen lds
s_add_u32 m0, m0, 1024
s_add_u32 s83, s81, 147456
buffer_load_dwordx4 v9, s[24:27], s83 offen lds
s_add_u32 m0, m0, 1024
s_add_u32 s83, s81, 163840
buffer_load_dwordx4 v8, s[24:27], s83 offen lds
s_add_u32 m0, m0, 1024
s_add_u32 s83, s81, 180224
buffer_load_dwordx4 v9, s[24:27], s83 offen lds
s_add_u32 m0, m0, 1024
s_add_u32 s83, s81, 196608
buffer_load_dwordx4 v8, s[24:27], s83 offen lds
s_add_u32 m0, m0, 1024
s_add_u32 s83, s81, 212992
buffer_load_dwordx4 v9, s[24:27], s83 offen lds
s_add_u32 m0, m0, 1024
s_add_u32 s83, s81, 229376
buffer_load_dwordx4 v8, s[24:27], s83 offen lds
s_add_u32 m0, m0, 1024
s_add_u32 s83, s81, 245760
buffer_load_dwordx4 v9, s[24:27], s83 offen lds
s_add_u32 m0, m0, 1024
s_add_u32 s83, s81, 262144
buffer_load_dwordx4 v8, s[24:27], s83 offen lds
s_add_u32 m0, m0, 1024
s_add_u32 s83, s81, 278528
buffer_load_dwordx4 v9, s[24:27], s83 offen lds
s_add_u32 m0, m0, 1024
s_add_u32 s83, s81, 294912
buffer_load_dwordx4 v8, s[24:27], s83 offen lds
s_add_u32 m0, m0, 1024
s_add_u32 s83, s81, 311296
buffer_load_dwordx4 v9, s[24:27], s83 offen lds
s_add_u32 m0, m0, 1024
s_add_u32 s83, s81, 327680
buffer_load_dwordx4 v8, s[24:27], s83 offen lds
s_add_u32 m0, m0, 1024
s_add_u32 s83, s81, 344064
buffer_load_dwordx4 v9, s[24:27], s83 offen lds
s_add_u32 m0, m0, 1024
s_add_u32 s83, s81, 360448
buffer_load_dwordx4 v8, s[24:27], s83 offen lds
s_add_u32 m0, m0, 1024
s_add_u32 s83, s81, 376832
buffer_load_dwordx4 v9, s[24:27], s83 offen lds
s_add_u32 s80, s80, 49152
s_cmp_eq_u32 s80, 147456
s_cselect_b32 s80, 0, s80
s_waitcnt vmcnt(39)
s_mov_b32 s80, 98304
s_mov_b32 s87, 2
s_add_u32 s85, s87, s88
s_and_b32 s85, s85, 3
s_andn2_b32 s83, s87, 3
s_or_b32 s85, s85, s83
s_add_u32 s87, s87, 1
s_lshl_b32 s83, s85, 7
s_add_u32 s81, s83, s86
s_add_u32 s82, s83, s89
s_add_u32 m0, s80, 0
s_add_u32 s83, s81, 0
buffer_load_dwordx4 v8, s[24:27], s83 offen lds
s_add_u32 m0, m0, 1024
s_add_u32 s83, s81, 16384
buffer_load_dwordx4 v9, s[24:27], s83 offen lds
s_add_u32 m0, m0, 1024
s_add_u32 s83, s81, 32768
buffer_load_dwordx4 v8, s[24:27], s83 offen lds
s_add_u32 m0, m0, 1024
s_add_u32 s83, s81, 49152
buffer_load_dwordx4 v9, s[24:27], s83 offen lds
s_add_u32 m0, m0, 1024
s_add_u32 s83, s81, 65536
buffer_load_dwordx4 v8, s[24:27], s83 offen lds
s_add_u32 m0, m0, 1024
s_add_u32 s83, s81, 81920
buffer_load_dwordx4 v9, s[24:27], s83 offen lds
s_add_u32 m0, m0, 1024
s_add_u32 s83, s81, 98304
buffer_load_dwordx4 v8, s[24:27], s83 offen lds
s_add_u32 m0, m0, 1024
s_add_u32 s83, s81, 114688
buffer_load_dwordx4 v9, s[24:27], s83 offen lds
s_add_u32 m0, m0, 1024
s_add_u32 s83, s81, 131072
buffer_load_dwordx4 v8, s[24:27], s83 offen lds
s_add_u32 m0, m0, 1024
s_add_u32 s83, s81, 147456
buffer_load_dwordx4 v9, s[24:27], s83 offen lds
s_add_u32 m0, m0, 1024
s_add_u32 s83, s81, 163840
buffer_load_dwordx4 v8, s[24:27], s83 offen lds
s_add_u32 m0, m0, 1024
s_add_u32 s83, s81, 180224
buffer_load_dwordx4 v9, s[24:27], s83 offen lds
s_add_u32 m0, m0, 1024
s_add_u32 s83, s81, 196608
buffer_load_dwordx4 v8, s[24:27], s83 offen lds
s_add_u32 m0, m0, 1024
s_add_u32 s83, s81, 212992
buffer_load_dwordx4 v9, s[24:27], s83 offen lds
s_add_u32 m0, m0, 1024
s_add_u32 s83, s81, 229376
buffer_load_dwordx4 v8, s[24:27], s83 offen lds
s_add_u32 m0, m0, 1024
s_add_u32 s83, s81, 245760
buffer_load_dwordx4 v9, s[24:27], s83 offen lds
s_add_u32 m0, m0, 1024
s_add_u32 s83, s81, 262144
buffer_load_dwordx4 v8, s[24:27], s83 offen lds
s_add_u32 m0, m0, 1024
s_add_u32 s83, s81, 278528
buffer_load_dwordx4 v9, s[24:27], s83 offen lds
s_add_u32 m0, m0, 1024
s_add_u32 s83, s81, 294912
buffer_load_dwordx4 v8, s[24:27], s83 offen lds
s_add_u32 m0, m0, 1024
s_add_u32 s83, s81, 311296
buffer_load_dwordx4 v9, s[24:27], s83 offen lds
s_add_u32 m0, m0, 1024
s_add_u32 s83, s81, 327680
buffer_load_dwordx4 v8, s[24:27], s83 offen lds
s_add_u32 m0, m0, 1024
s_add_u32 s83, s81, 344064
buffer_load_dwordx4 v9, s[24:27], s83 offen lds
s_add_u32 m0, m0, 1024
s_add_u32 s83, s81, 360448
buffer_load_dwordx4 v8, s[24:27], s83 offen lds
s_add_u32 m0, m0, 1024
s_add_u32 s83, s81, 376832
buffer_load_dwordx4 v9, s[24:27], s83 offen lds
s_add_u32 s80, s80, 49152
s_cmp_eq_u32 s80, 147456
s_cselect_b32 s80, 0, s80
s_mov_b32 s80, 0
s_mov_b32 s87, 3
s_waitcnt vmcnt(48)
s_barrier
s_waitcnt vmcnt(24)
s_barrier
s_add_u32 s85, s87, s88
s_and_b32 s85, s85, 3
s_andn2_b32 s83, s87, 3
s_or_b32 s85, s85, s83
s_add_u32 s87, s87, 1
s_lshl_b32 s83, s85, 7
s_add_u32 s81, s83, s86
s_add_u32 s82, s83, s89
s_add_u32 m0, s80, 0
s_add_u32 s83, s81, 0
buffer_load_dwordx4 v8, s[24:27], s83 offen lds
s_add_u32 m0, m0, 1024
s_add_u32 s83, s81, 16384
buffer_load_dwordx4 v9, s[24:27], s83 offen lds
s_add_u32 m0, m0, 1024
s_add_u32 s83, s81, 32768
buffer_load_dwordx4 v8, s[24:27], s83 offen lds
s_add_u32 m0, m0, 1024
s_add_u32 s83, s81, 49152
buffer_load_dwordx4 v9, s[24:27], s83 offen lds
s_add_u32 m0, m0, 1024
s_add_u32 s83, s81, 65536
buffer_load_dwordx4 v8, s[24:27], s83 offen lds
s_add_u32 m0, m0, 1024
s_add_u32 s83, s81, 81920
buffer_load_dwordx4 v9, s[24:27], s83 offen lds
s_add_u32 m0, m0, 1024
s_add_u32 s83, s81, 98304
buffer_load_dwordx4 v8, s[24:27], s83 offen lds
s_add_u32 m0, m0, 1024
s_add_u32 s83, s81, 114688
buffer_load_dwordx4 v9, s[24:27], s83 offen lds
s_add_u32 m0, m0, 1024
s_add_u32 s83, s81, 131072
buffer_load_dwordx4 v8, s[24:27], s83 offen lds
s_add_u32 m0, m0, 1024
s_add_u32 s83, s81, 147456
buffer_load_dwordx4 v9, s[24:27], s83 offen lds
s_add_u32 m0, m0, 1024
s_add_u32 s83, s81, 163840
buffer_load_dwordx4 v8, s[24:27], s83 offen lds
s_add_u32 m0, m0, 1024
s_add_u32 s83, s81, 180224
buffer_load_dwordx4 v9, s[24:27], s83 offen lds
s_add_u32 m0, m0, 1024
s_add_u32 s83, s81, 196608
buffer_load_dwordx4 v8, s[24:27], s83 offen lds
s_add_u32 m0, m0, 1024
s_add_u32 s83, s81, 212992
buffer_load_dwordx4 v9, s[24:27], s83 offen lds
s_add_u32 m0, m0, 1024
s_add_u32 s83, s81, 229376
buffer_load_dwordx4 v8, s[24:27], s83 offen lds
s_add_u32 m0, m0, 1024
s_add_u32 s83, s81, 245760
buffer_load_dwordx4 v9, s[24:27], s83 offen lds
s_add_u32 m0, m0, 1024
s_add_u32 s83, s81, 262144
buffer_load_dwordx4 v8, s[24:27], s83 offen lds
s_add_u32 m0, m0, 1024
s_add_u32 s83, s81, 278528
buffer_load_dwordx4 v9, s[24:27], s83 offen lds
s_add_u32 m0, m0, 1024
s_add_u32 s83, s81, 294912
buffer_load_dwordx4 v8, s[24:27], s83 offen lds
s_add_u32 m0, m0, 1024
s_add_u32 s83, s81, 311296
buffer_load_dwordx4 v9, s[24:27], s83 offen lds
s_add_u32 m0, m0, 1024
s_add_u32 s83, s81, 327680
buffer_load_dwordx4 v8, s[24:27], s83 offen lds
s_add_u32 m0, m0, 1024
s_add_u32 s83, s81, 344064
buffer_load_dwordx4 v9, s[24:27], s83 offen lds
s_add_u32 m0, m0, 1024
s_add_u32 s83, s81, 360448
buffer_load_dwordx4 v8, s[24:27], s83 offen lds
s_add_u32 m0, m0, 1024
s_add_u32 s83, s81, 376832
buffer_load_dwordx4 v9, s[24:27], s83 offen lds
s_add_u32 s80, s80, 49152
s_cmp_eq_u32 s80, 147456
s_cselect_b32 s80, 0, s80
s_mov_b32 s84, 12
K1_g1p0_loop:
s_waitcnt vmcnt(24)
s_barrier
s_add_u32 s85, s87, s88
s_and_b32 s85, s85, 3
s_andn2_b32 s83, s87, 3
s_or_b32 s85, s85, s83
s_add_u32 s87, s87, 1
s_lshl_b32 s83, s85, 7
s_add_u32 s81, s83, s86
s_add_u32 s82, s83, s89
s_add_u32 m0, s80, 0
s_add_u32 s83, s81, 0
buffer_load_dwordx4 v8, s[24:27], s83 offen lds
s_add_u32 m0, m0, 1024
s_add_u32 s83, s81, 16384
buffer_load_dwordx4 v9, s[24:27], s83 offen lds
s_add_u32 m0, m0, 1024
s_add_u32 s83, s81, 32768
buffer_load_dwordx4 v8, s[24:27], s83 offen lds
s_add_u32 m0, m0, 1024
s_add_u32 s83, s81, 49152
buffer_load_dwordx4 v9, s[24:27], s83 offen lds
s_add_u32 m0, m0, 1024
s_add_u32 s83, s81, 65536
buffer_load_dwordx4 v8, s[24:27], s83 offen lds
s_add_u32 m0, m0, 1024
s_add_u32 s83, s81, 81920
buffer_load_dwordx4 v9, s[24:27], s83 offen lds
s_add_u32 m0, m0, 1024
s_add_u32 s83, s81, 98304
buffer_load_dwordx4 v8, s[24:27], s83 offen lds
s_add_u32 m0, m0, 1024
s_add_u32 s83, s81, 114688
buffer_load_dwordx4 v9, s[24:27], s83 offen lds
s_add_u32 m0, m0, 1024
s_add_u32 s83, s81, 131072
buffer_load_dwordx4 v8, s[24:27], s83 offen lds
s_add_u32 m0, m0, 1024
s_add_u32 s83, s81, 147456
buffer_load_dwordx4 v9, s[24:27], s83 offen lds
s_add_u32 m0, m0, 1024
s_add_u32 s83, s81, 163840
buffer_load_dwordx4 v8, s[24:27], s83 offen lds
s_add_u32 m0, m0, 1024
s_add_u32 s83, s81, 180224
buffer_load_dwordx4 v9, s[24:27], s83 offen lds
s_add_u32 m0, m0, 1024
s_add_u32 s83, s81, 196608
buffer_load_dwordx4 v8, s[24:27], s83 offen lds
s_add_u32 m0, m0, 1024
s_add_u32 s83, s81, 212992
buffer_load_dwordx4 v9, s[24:27], s83 offen lds
s_add_u32 m0, m0, 1024
s_add_u32 s83, s81, 229376
buffer_load_dwordx4 v8, s[24:27], s83 offen lds
s_add_u32 m0, m0, 1024
s_add_u32 s83, s81, 245760
buffer_load_dwordx4 v9, s[24:27], s83 offen lds
s_add_u32 m0, m0, 1024
s_add_u32 s83, s81, 262144
buffer_load_dwordx4 v8, s[24:27], s83 offen lds
s_add_u32 m0, m0, 1024
s_add_u32 s83, s81, 278528
buffer_load_dwordx4 v9, s[24:27], s83 offen lds
s_add_u32 m0, m0, 1024
s_add_u32 s83, s81, 294912
buffer_load_dwordx4 v8, s[24:27], s83 offen lds
s_add_u32 m0, m0, 1024
s_add_u32 s83, s81, 311296
buffer_load_dwordx4 v9, s[24:27], s83 offen lds
s_add_u32 m0, m0, 1024
s_add_u32 s83, s81, 327680
buffer_load_dwordx4 v8, s[24:27], s83 offen lds
s_add_u32 m0, m0, 1024
s_add_u32 s83, s81, 344064
buffer_load_dwordx4 v9, s[24:27], s83 offen lds
s_add_u32 m0, m0, 1024
s_add_u32 s83, s81, 360448
buffer_load_dwordx4 v8, s[24:27], s83 offen lds
s_add_u32 m0, m0, 1024
s_add_u32 s83, s81, 376832
buffer_load_dwordx4 v9, s[24:27], s83 offen lds
s_add_u32 s80, s80, 49152
s_cmp_eq_u32 s80, 147456
s_cselect_b32 s80, 0, s80
s_sub_u32 s84, s84, 1
s_cmp_lg_u32 s84, 0
s_cbranch_scc1 K1_g1p0_loop
s_bitcmp1_b32 s3, 0
s_cselect_b32 s28, s6, s4
s_cselect_b32 s29, s7, s5
s_mov_b32 s30, 2097152
s_mov_b32 s31, 0x20000
s_lshr_b32 s74, s3, 1
s_lshl_b32 s74, s74, 15
s_add_u32 s74, s74, 0
buffer_load_dword v21, v10, s[28:31], s74 offen
s_add_u32 s74, s74, 8192
buffer_load_dword v21, v10, s[28:31], s74 offen
s_add_u32 s74, s74, 8192
s_waitcnt vmcnt(26)
s_barrier
s_waitcnt vmcnt(2)
s_barrier
K1_pb_a:
s_add_u32 s88, s35, s36
v_lshlrev_b32 v18, 4, v1
s_mov_b32 s8, s4
s_mov_b32 s9, s5
s_mov_b32 s10, 2097152
s_mov_b32 s11, 0x20000
s_lshl_b32 s86, s37, 18
s_barrier
s_cmp_eq_u32 s34, 0
s_cbranch_scc1 K1_nd4
s_sleep 100
K1_nd4:
s_mov_b32 s80, 0
s_mov_b32 s87, 0
s_add_u32 s85, s87, s88
s_and_b32 s85, s85, 3
s_andn2_b32 s83, s87, 3
s_or_b32 s85, s85, s83
s_add_u32 s87, s87, 1
s_add_u32 s85, s85, s66
s_lshr_b32 s83, s85, 1
s_bitcmp1_b32 s85, 0
s_cselect_b32 s8, s6, s4
s_cselect_b32 s9, s7, s5
s_lshl_b32 s83, s83, 7
s_add_u32 s81, s86, s83
s_add_u32 m0, s80, 0
s_add_u32 s83, s81, 0
buffer_load_dwordx4 v8, s[8:11], s83 offen lds
s_add_u32 m0, m0, 1024
s_add_u32 s83, s81, 16384
buffer_load_dwordx4 v9, s[8:11], s83 offen lds
s_add_u32 m0, m0, 1024
s_add_u32 s83, s81, 32768
buffer_load_dwordx4 v8, s[8:11], s83 offen lds
s_add_u32 m0, m0, 1024
s_add_u32 s83, s81, 49152
buffer_load_dwordx4 v9, s[8:11], s83 offen lds
s_add_u32 m0, m0, 1024
s_add_u32 s83, s81, 65536
buffer_load_dwordx4 v8, s[8:11], s83 offen lds
s_add_u32 m0, m0, 1024
s_add_u32 s83, s81, 81920
buffer_load_dwordx4 v9, s[8:11], s83 offen lds
s_add_u32 m0, m0, 1024
s_add_u32 s83, s81, 98304
buffer_load_dwordx4 v8, s[8:11], s83 offen lds
s_add_u32 m0, m0, 1024
s_add_u32 s83, s81, 114688
buffer_load_dwordx4 v9, s[8:11], s83 offen lds
s_add_u32 m0, m0, 1024
s_add_u32 s83, s81, 131072
buffer_load_dwordx4 v8, s[8:11], s83 offen lds
s_add_u32 m0, m0, 1024
s_add_u32 s83, s81, 147456
buffer_load_dwordx4 v9, s[8:11], s83 offen lds
s_add_u32 m0, m0, 1024
s_add_u32 s83, s81, 163840
buffer_load_dwordx4 v8, s[8:11], s83 offen lds
s_add_u32 m0, m0, 1024
s_add_u32 s83, s81, 180224
buffer_load_dwordx4 v9, s[8:11], s83 offen lds
s_add_u32 m0, m0, 1024
s_add_u32 s83, s81, 196608
buffer_load_dwordx4 v8, s[8:11], s83 offen lds
s_add_u32 m0, m0, 1024
s_add_u32 s83, s81, 212992
buffer_load_dwordx4 v9, s[8:11], s83 offen lds
s_add_u32 m0, m0, 1024
s_add_u32 s83, s81, 229376
buffer_load_dwordx4 v8, s[8:11], s83 offen lds
s_add_u32 m0, m0, 1024
s_add_u32 s83, s81, 245760
buffer_load_dwordx4 v9, s[8:11], s83 offen lds
s_add_u32 s80, s80, 32768
s_cmp_eq_u32 s80, 131072
s_cselect_b32 s80, 0, s80
s_add_u32 s85, s87, s88
s_and_b32 s85, s85, 3
s_andn2_b32 s83, s87, 3
s_or_b32 s85, s85, s83
s_add_u32 s87, s87, 1
s_add_u32 s85, s85, s66
s_lshr_b32 s83, s85, 1
s_bitcmp1_b32 s85, 0
s_cselect_b32 s8, s6, s4
s_cselect_b32 s9, s7, s5
s_lshl_b32 s83, s83, 7
s_add_u32 s81, s86, s83
s_add_u32 m0, s80, 0
s_add_u32 s83, s81, 0
buffer_load_dwordx4 v8, s[8:11], s83 offen lds
s_add_u32 m0, m0, 1024
s_add_u32 s83, s81, 16384
buffer_load_dwordx4 v9, s[8:11], s83 offen lds
s_add_u32 m0, m0, 1024
s_add_u32 s83, s81, 32768
buffer_load_dwordx4 v8, s[8:11], s83 offen lds
s_add_u32 m0, m0, 1024
s_add_u32 s83, s81, 49152
buffer_load_dwordx4 v9, s[8:11], s83 offen lds
s_add_u32 m0, m0, 1024
s_add_u32 s83, s81, 65536
buffer_load_dwordx4 v8, s[8:11], s83 offen lds
s_add_u32 m0, m0, 1024
s_add_u32 s83, s81, 81920
buffer_load_dwordx4 v9, s[8:11], s83 offen lds
s_add_u32 m0, m0, 1024
s_add_u32 s83, s81, 98304
buffer_load_dwordx4 v8, s[8:11], s83 offen lds
s_add_u32 m0, m0, 1024
s_add_u32 s83, s81, 114688
buffer_load_dwordx4 v9, s[8:11], s83 offen lds
s_add_u32 m0, m0, 1024
s_add_u32 s83, s81, 131072
buffer_load_dwordx4 v8, s[8:11], s83 offen lds
s_add_u32 m0, m0, 1024
s_add_u32 s83, s81, 147456
buffer_load_dwordx4 v9, s[8:11], s83 offen lds
s_add_u32 m0, m0, 1024
s_add_u32 s83, s81, 163840
buffer_load_dwordx4 v8, s[8:11], s83 offen lds
s_add_u32 m0, m0, 1024
s_add_u32 s83, s81, 180224
buffer_load_dwordx4 v9, s[8:11], s83 offen lds
s_add_u32 m0, m0, 1024
s_add_u32 s83, s81, 196608
buffer_load_dwordx4 v8, s[8:11], s83 offen lds
s_add_u32 m0, m0, 1024
s_add_u32 s83, s81, 212992
buffer_load_dwordx4 v9, s[8:11], s83 offen lds
s_add_u32 m0, m0, 1024
s_add_u32 s83, s81, 229376
buffer_load_dwordx4 v8, s[8:11], s83 offen lds
s_add_u32 m0, m0, 1024
s_add_u32 s83, s81, 245760
buffer_load_dwordx4 v9, s[8:11], s83 offen lds
s_add_u32 s80, s80, 32768
s_cmp_eq_u32 s80, 131072
s_cselect_b32 s80, 0, s80
s_add_u32 s85, s87, s88
s_and_b32 s85, s85, 3
s_andn2_b32 s83, s87, 3
s_or_b32 s85, s85, s83
s_add_u32 s87, s87, 1
s_add_u32 s85, s85, s66
s_lshr_b32 s83, s85, 1
s_bitcmp1_b32 s85, 0
s_cselect_b32 s8, s6, s4
s_cselect_b32 s9, s7, s5
s_lshl_b32 s83, s83, 7
s_add_u32 s81, s86, s83
s_add_u32 m0, s80, 0
s_add_u32 s83, s81, 0
buffer_load_dwordx4 v8, s[8:11], s83 offen lds
s_add_u32 m0, m0, 1024
s_add_u32 s83, s81, 16384
buffer_load_dwordx4 v9, s[8:11], s83 offen lds
s_add_u32 m0, m0, 1024
s_add_u32 s83, s81, 32768
buffer_load_dwordx4 v8, s[8:11], s83 offen lds
s_add_u32 m0, m0, 1024
s_add_u32 s83, s81, 49152
buffer_load_dwordx4 v9, s[8:11], s83 offen lds
s_add_u32 m0, m0, 1024
s_add_u32 s83, s81, 65536
buffer_load_dwordx4 v8, s[8:11], s83 offen lds
s_add_u32 m0, m0, 1024
s_add_u32 s83, s81, 81920
buffer_load_dwordx4 v9, s[8:11], s83 offen lds
s_add_u32 m0, m0, 1024
s_add_u32 s83, s81, 98304
buffer_load_dwordx4 v8, s[8:11], s83 offen lds
s_add_u32 m0, m0, 1024
s_add_u32 s83, s81, 114688
buffer_load_dwordx4 v9, s[8:11], s83 offen lds
s_add_u32 m0, m0, 1024
s_add_u32 s83, s81, 131072
buffer_load_dwordx4 v8, s[8:11], s83 offen lds
s_add_u32 m0, m0, 1024
s_add_u32 s83, s81, 147456
buffer_load_dwordx4 v9, s[8:11], s83 offen lds
s_add_u32 m0, m0, 1024
s_add_u32 s83, s81, 163840
buffer_load_dwordx4 v8, s[8:11], s83 offen lds
s_add_u32 m0, m0, 1024
s_add_u32 s83, s81, 180224
buffer_load_dwordx4 v9, s[8:11], s83 offen lds
s_add_u32 m0, m0, 1024
s_add_u32 s83, s81, 196608
buffer_load_dwordx4 v8, s[8:11], s83 offen lds
s_add_u32 m0, m0, 1024
s_add_u32 s83, s81, 212992
buffer_load_dwordx4 v9, s[8:11], s83 offen lds
s_add_u32 m0, m0, 1024
s_add_u32 s83, s81, 229376
buffer_load_dwordx4 v8, s[8:11], s83 offen lds
s_add_u32 m0, m0, 1024
s_add_u32 s83, s81, 245760
buffer_load_dwordx4 v9, s[8:11], s83 offen lds
s_add_u32 s80, s80, 32768
s_cmp_eq_u32 s80, 131072
s_cselect_b32 s80, 0, s80
s_waitcnt vmcnt(47)
s_add_u32 s85, s87, s88
s_and_b32 s85, s85, 3
s_andn2_b32 s83, s87, 3
s_or_b32 s85, s85, s83
s_add_u32 s87, s87, 1
s_add_u32 s85, s85, s66
s_lshr_b32 s83, s85, 1
s_bitcmp1_b32 s85, 0
s_cselect_b32 s8, s6, s4
s_cselect_b32 s9, s7, s5
s_lshl_b32 s83, s83, 7
s_add_u32 s81, s86, s83
s_add_u32 m0, s80, 0
s_add_u32 s83, s81, 0
buffer_load_dwordx4 v8, s[8:11], s83 offen lds
s_add_u32 m0, m0, 1024
s_add_u32 s83, s81, 16384
buffer_load_dwordx4 v9, s[8:11], s83 offen lds
s_add_u32 m0, m0, 1024
s_add_u32 s83, s81, 32768
buffer_load_dwordx4 v8, s[8:11], s83 offen lds
s_add_u32 m0, m0, 1024
s_add_u32 s83, s81, 49152
buffer_load_dwordx4 v9, s[8:11], s83 offen lds
s_add_u32 m0, m0, 1024
s_add_u32 s83, s81, 65536
buffer_load_dwordx4 v8, s[8:11], s83 offen lds
s_add_u32 m0, m0, 1024
s_add_u32 s83, s81, 81920
buffer_load_dwordx4 v9, s[8:11], s83 offen lds
s_add_u32 m0, m0, 1024
s_add_u32 s83, s81, 98304
buffer_load_dwordx4 v8, s[8:11], s83 offen lds
s_add_u32 m0, m0, 1024
s_add_u32 s83, s81, 114688
buffer_load_dwordx4 v9, s[8:11], s83 offen lds
s_add_u32 m0, m0, 1024
s_add_u32 s83, s81, 131072
buffer_load_dwordx4 v8, s[8:11], s83 offen lds
s_add_u32 m0, m0, 1024
s_add_u32 s83, s81, 147456
buffer_load_dwordx4 v9, s[8:11], s83 offen lds
s_add_u32 m0, m0, 1024
s_add_u32 s83, s81, 163840
buffer_load_dwordx4 v8, s[8:11], s83 offen lds
s_add_u32 m0, m0, 1024
s_add_u32 s83, s81, 180224
buffer_load_dwordx4 v9, s[8:11], s83 offen lds
s_add_u32 m0, m0, 1024
s_add_u32 s83, s81, 196608
buffer_load_dwordx4 v8, s[8:11], s83 offen lds
s_add_u32 m0, m0, 1024
s_add_u32 s83, s81, 212992
buffer_load_dwordx4 v9, s[8:11], s83 offen lds
s_add_u32 m0, m0, 1024
s_add_u32 s83, s81, 229376
buffer_load_dwordx4 v8, s[8:11], s83 offen lds
s_add_u32 m0, m0, 1024
s_add_u32 s83, s81, 245760
buffer_load_dwordx4 v9, s[8:11], s83 offen lds
s_add_u32 s80, s80, 32768
s_cmp_eq_u32 s80, 131072
s_cselect_b32 s80, 0, s80
s_waitcnt vmcnt(48)
s_barrier
s_mov_b32 s84, s67
K1_pbC_loop:
s_waitcnt vmcnt(32)
s_barrier
s_add_u32 s85, s87, s88
s_and_b32 s85, s85, 3
s_andn2_b32 s83, s87, 3
s_or_b32 s85, s85, s83
s_add_u32 s87, s87, 1
s_add_u32 s85, s85, s66
s_lshr_b32 s83, s85, 1
s_bitcmp1_b32 s85, 0
s_cselect_b32 s8, s6, s4
s_cselect_b32 s9, s7, s5
s_lshl_b32 s83, s83, 7
s_add_u32 s81, s86, s83
s_add_u32 m0, s80, 0
s_add_u32 s83, s81, 0
buffer_load_dwordx4 v8, s[8:11], s83 offen lds
s_add_u32 m0, m0, 1024
s_add_u32 s83, s81, 16384
buffer_load_dwordx4 v9, s[8:11], s83 offen lds
s_add_u32 m0, m0, 1024
s_add_u32 s83, s81, 32768
buffer_load_dwordx4 v8, s[8:11], s83 offen lds
s_add_u32 m0, m0, 1024
s_add_u32 s83, s81, 49152
buffer_load_dwordx4 v9, s[8:11], s83 offen lds
s_add_u32 m0, m0, 1024
s_add_u32 s83, s81, 65536
buffer_load_dwordx4 v8, s[8:11], s83 offen lds
s_add_u32 m0, m0, 1024
s_add_u32 s83, s81, 81920
buffer_load_dwordx4 v9, s[8:11], s83 offen lds
s_add_u32 m0, m0, 1024
s_add_u32 s83, s81, 98304
buffer_load_dwordx4 v8, s[8:11], s83 offen lds
s_add_u32 m0, m0, 1024
s_add_u32 s83, s81, 114688
buffer_load_dwordx4 v9, s[8:11], s83 offen lds
s_add_u32 m0, m0, 1024
s_add_u32 s83, s81, 131072
buffer_load_dwordx4 v8, s[8:11], s83 offen lds
s_add_u32 m0, m0, 1024
s_add_u32 s83, s81, 147456
buffer_load_dwordx4 v9, s[8:11], s83 offen lds
s_add_u32 m0, m0, 1024
s_add_u32 s83, s81, 163840
buffer_load_dwordx4 v8, s[8:11], s83 offen lds
s_add_u32 m0, m0, 1024
s_add_u32 s83, s81, 180224
buffer_load_dwordx4 v9, s[8:11], s83 offen lds
s_add_u32 m0, m0, 1024
s_add_u32 s83, s81, 196608
buffer_load_dwordx4 v8, s[8:11], s83 offen lds
s_add_u32 m0, m0, 1024
s_add_u32 s83, s81, 212992
buffer_load_dwordx4 v9, s[8:11], s83 offen lds
s_add_u32 m0, m0, 1024
s_add_u32 s83, s81, 229376
buffer_load_dwordx4 v8, s[8:11], s83 offen lds
s_add_u32 m0, m0, 1024
s_add_u32 s83, s81, 245760
buffer_load_dwordx4 v9, s[8:11], s83 offen lds
s_add_u32 s80, s80, 32768
s_cmp_eq_u32 s80, 131072
s_cselect_b32 s80, 0, s80
s_sub_u32 s84, s84, 1
s_cmp_lg_u32 s84, 0
s_cbranch_scc1 K1_pbC_loop
s_mov_b32 s87, 0
s_bitcmp1_b32 s33, 0
s_cselect_b32 s63, -1, 0
s_cselect_b32 s78, 56, 0
s_andn2_b32 s79, s68, 7
s_andn2_b32 s69, s68, 3
s_lshl_b32 s88, s88, 1
s_add_u32 s88, s88, s34
s_mul_i32 s86, s37, 917504
s_add_u32 s86, s86, 16777216
v_lshlrev_b32 v19, 2, v1
s_lshl_b32 s72, s37, 8
s_add_u32 s72, s72, 25427968
s_mov_b64 s[76:77], 0
s_mov_b32 s84, s68
K1_pbU_loop:
s_waitcnt vmcnt(32)
s_barrier
s_cmp_lt_u32 s87, s69
s_cselect_b32 s83, 3, 0
s_cmp_lt_u32 s87, s79
s_cselect_b32 s83, 7, s83
s_add_u32 s85, s87, s88
s_and_b32 s85, s85, s83
s_andn2_b32 s83, s87, s83
s_or_b32 s85, s85, s83
s_add_u32 s87, s87, 1
s_xor_b32 s85, s85, s63
s_add_u32 s85, s85, s78
s_lshl_b32 s81, s85, 14
s_add_u32 s81, s81, s86
s_mul_i32 s83, s85, 18726
s_lshr_b32 s74, s83, 16
s_add_u32 s83, s83, 9363
s_lshr_b32 s83, s83, 16
s_lshl_b32 s74, s74, 2
s_lshl_b32 s83, s83, 2
s_lshl_b64 s[70:71], 15, s74
s_lshl_b64 s[74:75], 15, s83
s_or_b64 s[70:71], s[70:71], s[74:75]
s_andn2_b64 s[74:75], s[70:71], s[76:77]
s_cbranch_scc0 K1_uf1_ok
s_mov_b32 s73, 0x40000
K1_uf1_poll:
buffer_load_dword v20, v19, s[24:27], s72 offen sc1
s_waitcnt vmcnt(0)
v_cmp_eq_u32 s[76:77], 1, v20
s_nop 0
s_andn2_b64 s[74:75], s[70:71], s[76:77]
s_cbranch_scc0 K1_uf1_ok
s_sleep 2
s_sub_u32 s73, s73, 1
s_cmp_lg_u32 s73, 0
s_cbranch_scc1 K1_uf1_poll
K1_uf1_ok:
s_add_u32 m0, s80, 0
s_add_u32 s83, s81, 0
buffer_load_dwordx4 v18, s[24:27], s83 offen sc1 lds
s_add_u32 m0, m0, 1024
s_add_u32 s83, s81, 1024
buffer_load_dwordx4 v18, s[24:27], s83 offen sc1 lds
s_add_u32 m0, m0, 1024
s_add_u32 s83, s81, 2048
buffer_load_dwordx4 v18, s[24:27], s83 offen sc1 lds
s_add_u32 m0, m0, 1024
s_add_u32 s83, s81, 3072
buffer_load_dwordx4 v18, s[24:27], s83 offen sc1 lds
s_add_u32 m0, m0, 1024
s_add_u32 s83, s81, 4096
buffer_load_dwordx4 v18, s[24:27], s83 offen sc1 lds
s_add_u32 m0, m0, 1024
s_add_u32 s83, s81, 5120
buffer_load_dwordx4 v18, s[24:27], s83 offen sc1 lds
s_add_u32 m0, m0, 1024
s_add_u32 s83, s81, 6144
buffer_load_dwordx4 v18, s[24:27], s83 offen sc1 lds
s_add_u32 m0, m0, 1024
s_add_u32 s83, s81, 7168
buffer_load_dwordx4 v18, s[24:27], s83 offen sc1 lds
s_add_u32 m0, m0, 1024
s_add_u32 s83, s81, 8192
buffer_load_dwordx4 v18, s[24:27], s83 offen sc1 lds
s_add_u32 m0, m0, 1024
s_add_u32 s83, s81, 9216
buffer_load_dwordx4 v18, s[24:27], s83 offen sc1 lds
s_add_u32 m0, m0, 1024
s_add_u32 s83, s81, 10240
buffer_load_dwordx4 v18, s[24:27], s83 offen sc1 lds
s_add_u32 m0, m0, 1024
s_add_u32 s83, s81, 11264
buffer_load_dwordx4 v18, s[24:27], s83 offen sc1 lds
s_add_u32 m0, m0, 1024
s_add_u32 s83, s81, 12288
buffer_load_dwordx4 v18, s[24:27], s83 offen sc1 lds
s_add_u32 m0, m0, 1024
s_add_u32 s83, s81, 13312
buffer_load_dwordx4 v18, s[24:27], s83 offen sc1 lds
s_add_u32 m0, m0, 1024
s_add_u32 s83, s81, 14336
buffer_load_dwordx4 v18, s[24:27], s83 offen sc1 lds
s_add_u32 m0, m0, 1024
s_add_u32 s83, s81, 15360
buffer_load_dwordx4 v18, s[24:27], s83 offen sc1 lds
s_add_u32 s80, s80, 32768
s_cmp_eq_u32 s80, 131072
s_cselect_b32 s80, 0, s80
s_sub_u32 s84, s84, 1
s_cmp_lg_u32 s84, 0
s_cbranch_scc1 K1_pbU_loop
s_waitcnt vmcnt(32)
s_barrier
s_waitcnt vmcnt(16)
s_barrier
s_waitcnt vmcnt(0)
s_barrier
s_waitcnt lgkmcnt(0)
s_endpgm
K1_g1p1:
s_and_b32 s71, s70, 1
s_cmp_eq_u32 s71, 1
s_cselect_b32 s28, s6, s4
s_cselect_b32 s29, s7, s5
s_mov_b32 s30, 2097152
s_mov_b32 s31, 0x20000
s_lshr_b32 s75, s70, 1
s_lshl_b32 s75, s75, 12
v_mul_u32_u24 v45, 16, v1
s_and_b32 s62, s2, 7
s_mul_i32 s62, s62, 4096
s_add_u32 s62, s62, 26214400
s_add_u32 s64, s62, 0
buffer_load_dword v40, v45, s[24:27], s64 offen sc1
s_add_u32 s64, s62, 1024
buffer_load_dword v41, v45, s[24:27], s64 offen sc1
s_add_u32 s64, s62, 2048
buffer_load_dword v42, v45, s[24:27], s64 offen sc1
s_add_u32 s64, s62, 3072
buffer_load_dword v43, v45, s[24:27], s64 offen sc1
v_and_b32 v46, 7, v1
v_mul_u32_u24 v46, 4096, v46
s_mul_i32 s63, s2, 16
s_add_u32 s63, s63, 26214400
buffer_load_dword v44, v46, s[24:27], s63 offen sc1
s_barrier
s_barrier
s_waitcnt vmcnt(0)
v_xor_b32 v47, 1, v44
s_mov_b64 exec, 255
buffer_store_dword v47, v46, s[24:27], s63 offen sc1
s_mov_b64 exec, -1
s_mov_b32 s80, 0
s_mov_b32 s87, 0
s_add_u32 s85, s87, s88
s_and_b32 s85, s85, 3
s_andn2_b32 s83, s87, 3
s_or_b32 s85, s85, s83
s_add_u32 s87, s87, 1
s_lshl_b32 s83, s85, 7
s_add_u32 s81, s83, s86
s_add_u32 s82, s83, s89
s_add_u32 m0, s80, 32768
s_add_u32 s83, s82, 0
buffer_load_dwordx4 v8, s[8:11], s83 offen lds
s_add_u32 m0, m0, 1024
s_add_u32 s83, s82, 16384
buffer_load_dwordx4 v9, s[8:11], s83 offen lds
s_add_u32 m0, m0, 1024
s_add_u32 s83, s82, 0
buffer_load_dwordx4 v8, s[12:15], s83 offen lds
s_add_u32 m0, m0, 1024
s_add_u32 s83, s82, 16384
buffer_load_dwordx4 v9, s[12:15], s83 offen lds
s_add_u32 m0, m0, 1024
s_add_u32 s83, s82, 32768
buffer_load_dwordx4 v8, s[8:11], s83 offen lds
s_add_u32 m0, m0, 1024
s_add_u32 s83, s82, 49152
buffer_load_dwordx4 v9, s[8:11], s83 offen lds
s_add_u32 m0, m0, 1024
s_add_u32 s83, s82, 32768
buffer_load_dwordx4 v8, s[12:15], s83 offen lds
s_add_u32 m0, m0, 1024
s_add_u32 s83, s82, 49152
buffer_load_dwordx4 v9, s[12:15], s83 offen lds
s_add_u32 m0, m0, 1024
s_add_u32 s83, s82, 65536
buffer_load_dwordx4 v8, s[8:11], s83 offen lds
s_add_u32 m0, m0, 1024
s_add_u32 s83, s82, 81920
buffer_load_dwordx4 v9, s[8:11], s83 offen lds
s_add_u32 m0, m0, 1024
s_add_u32 s83, s82, 65536
buffer_load_dwordx4 v8, s[12:15], s83 offen lds
s_add_u32 m0, m0, 1024
s_add_u32 s83, s82, 81920
buffer_load_dwordx4 v9, s[12:15], s83 offen lds
s_add_u32 m0, m0, 1024
s_add_u32 s83, s82, 98304
buffer_load_dwordx4 v8, s[8:11], s83 offen lds
s_add_u32 m0, m0, 1024
s_add_u32 s83, s82, 114688
buffer_load_dwordx4 v9, s[8:11], s83 offen lds
s_add_u32 m0, m0, 1024
s_add_u32 s83, s82, 98304
buffer_load_dwordx4 v8, s[12:15], s83 offen lds
s_add_u32 m0, m0, 1024
s_add_u32 s83, s82, 114688
buffer_load_dwordx4 v9, s[12:15], s83 offen lds
s_add_u32 s80, s80, 49152
s_cmp_eq_u32 s80, 147456
s_cselect_b32 s80, 0, s80
s_mov_b32 s80, 49152
s_mov_b32 s87, 1
s_add_u32 s85, s87, s88
s_and_b32 s85, s85, 3
s_andn2_b32 s83, s87, 3
s_or_b32 s85, s85, s83
s_add_u32 s87, s87, 1
s_lshl_b32 s83, s85, 7
s_add_u32 s81, s83, s86
s_add_u32 s82, s83, s89
s_add_u32 m0, s80, 32768
s_add_u32 s83, s82, 0
buffer_load_dwordx4 v8, s[8:11], s83 offen lds
s_add_u32 m0, m0, 1024
s_add_u32 s83, s82, 16384
buffer_load_dwordx4 v9, s[8:11], s83 offen lds
s_add_u32 m0, m0, 1024
s_add_u32 s83, s82, 0
buffer_load_dwordx4 v8, s[12:15], s83 offen lds
s_add_u32 m0, m0, 1024
s_add_u32 s83, s82, 16384
buffer_load_dwordx4 v9, s[12:15], s83 offen lds
s_add_u32 m0, m0, 1024
s_add_u32 s83, s82, 32768
buffer_load_dwordx4 v8, s[8:11], s83 offen lds
s_add_u32 m0, m0, 1024
s_add_u32 s83, s82, 49152
buffer_load_dwordx4 v9, s[8:11], s83 offen lds
s_add_u32 m0, m0, 1024
s_add_u32 s83, s82, 32768
buffer_load_dwordx4 v8, s[12:15], s83 offen lds
s_add_u32 m0, m0, 1024
s_add_u32 s83, s82, 49152
buffer_load_dwordx4 v9, s[12:15], s83 offen lds
s_add_u32 m0, m0, 1024
s_add_u32 s83, s82, 65536
buffer_load_dwordx4 v8, s[8:11], s83 offen lds
s_add_u32 m0, m0, 1024
s_add_u32 s83, s82, 81920
buffer_load_dwordx4 v9, s[8:11], s83 offen lds
s_add_u32 m0, m0, 1024
s_add_u32 s83, s82, 65536
buffer_load_dwordx4 v8, s[12:15], s83 offen lds
s_add_u32 m0, m0, 1024
s_add_u32 s83, s82, 81920
buffer_load_dwordx4 v9, s[12:15], s83 offen lds
s_add_u32 m0, m0, 1024
s_add_u32 s83, s82, 98304
buffer_load_dwordx4 v8, s[8:11], s83 offen lds
s_add_u32 m0, m0, 1024
s_add_u32 s83, s82, 114688
buffer_load_dwordx4 v9, s[8:11], s83 offen lds
s_add_u32 m0, m0, 1024
s_add_u32 s83, s82, 98304
buffer_load_dwordx4 v8, s[12:15], s83 offen lds
s_add_u32 m0, m0, 1024
s_add_u32 s83, s82, 114688
buffer_load_dwordx4 v9, s[12:15], s83 offen lds
s_add_u32 s80, s80, 49152
s_cmp_eq_u32 s80, 147456
s_cselect_b32 s80, 0, s80
s_mov_b32 s80, 98304
s_mov_b32 s87, 2
s_add_u32 s85, s87, s88
s_and_b32 s85, s85, 3
s_andn2_b32 s83, s87, 3
s_or_b32 s85, s85, s83
s_add_u32 s87, s87, 1
s_lshl_b32 s83, s85, 7
s_add_u32 s81, s83, s86
s_add_u32 s82, s83, s89
s_add_u32 m0, s80, 32768
s_add_u32 s83, s82, 0
buffer_load_dwordx4 v8, s[8:11], s83 offen lds
s_add_u32 m0, m0, 1024
s_add_u32 s83, s82, 16384
buffer_load_dwordx4 v9, s[8:11], s83 offen lds
s_add_u32 m0, m0, 1024
s_add_u32 s83, s82, 0
buffer_load_dwordx4 v8, s[12:15], s83 offen lds
s_add_u32 m0, m0, 1024
s_add_u32 s83, s82, 16384
buffer_load_dwordx4 v9, s[12:15], s83 offen lds
s_add_u32 m0, m0, 1024
s_add_u32 s83, s82, 32768
buffer_load_dwordx4 v8, s[8:11], s83 offen lds
s_add_u32 m0, m0, 1024
s_add_u32 s83, s82, 49152
buffer_load_dwordx4 v9, s[8:11], s83 offen lds
s_add_u32 m0, m0, 1024
s_add_u32 s83, s82, 32768
buffer_load_dwordx4 v8, s[12:15], s83 offen lds
s_add_u32 m0, m0, 1024
s_add_u32 s83, s82, 49152
buffer_load_dwordx4 v9, s[12:15], s83 offen lds
s_add_u32 m0, m0, 1024
s_add_u32 s83, s82, 65536
buffer_load_dwordx4 v8, s[8:11], s83 offen lds
s_add_u32 m0, m0, 1024
s_add_u32 s83, s82, 81920
buffer_load_dwordx4 v9, s[8:11], s83 offen lds
s_add_u32 m0, m0, 1024
s_add_u32 s83, s82, 65536
buffer_load_dwordx4 v8, s[12:15], s83 offen lds
s_add_u32 m0, m0, 1024
s_add_u32 s83, s82, 81920
buffer_load_dwordx4 v9, s[12:15], s83 offen lds
s_add_u32 m0, m0, 1024
s_add_u32 s83, s82, 98304
buffer_load_dwordx4 v8, s[8:11], s83 offen lds
s_add_u32 m0, m0, 1024
s_add_u32 s83, s82, 114688
buffer_load_dwordx4 v9, s[8:11], s83 offen lds
s_add_u32 m0, m0, 1024
s_add_u32 s83, s82, 98304
buffer_load_dwordx4 v8, s[12:15], s83 offen lds
s_add_u32 m0, m0, 1024
s_add_u32 s83, s82, 114688
buffer_load_dwordx4 v9, s[12:15], s83 offen lds
s_add_u32 s80, s80, 49152
s_cmp_eq_u32 s80, 147456
s_cselect_b32 s80, 0, s80
s_barrier
s_mov_b32 s80, 0
s_mov_b32 s87, 0
s_add_u32 s85, s87, s88
s_and_b32 s85, s85, 3
s_andn2_b32 s83, s87, 3
s_or_b32 s85, s85, s83
s_add_u32 s87, s87, 1
s_lshl_b32 s83, s85, 7
s_add_u32 s81, s83, s86
s_add_u32 s82, s83, s89
s_add_u32 m0, s80, 24576
s_add_u32 s83, s81, 393216
buffer_load_dwordx4 v8, s[24:27], s83 offen lds
s_add_u32 m0, m0, 1024
s_add_u32 s83, s81, 409600
buffer_load_dwordx4 v9, s[24:27], s83 offen lds
s_add_u32 m0, m0, 1024
s_add_u32 s83, s81, 425984
buffer_load_dwordx4 v8, s[24:27], s83 offen lds
s_add_u32 m0, m0, 1024
s_add_u32 s83, s81, 442368
buffer_load_dwordx4 v9, s[24:27], s83 offen lds
s_add_u32 m0, m0, 1024
s_add_u32 s83, s81, 458752
buffer_load_dwordx4 v8, s[24:27], s83 offen lds
s_add_u32 m0, m0, 1024
s_add_u32 s83, s81, 475136
buffer_load_dwordx4 v9, s[24:27], s83 offen lds
s_add_u32 m0, m0, 1024
s_add_u32 s83, s81, 491520
buffer_load_dwordx4 v8, s[24:27], s83 offen lds
s_add_u32 m0, m0, 1024
s_add_u32 s83, s81, 507904
buffer_load_dwordx4 v9, s[24:27], s83 offen lds
s_add_u32 s80, s80, 49152
s_cmp_eq_u32 s80, 147456
s_cselect_b32 s80, 0, s80
s_waitcnt vmcnt(55)
s_mov_b32 s80, 49152
s_mov_b32 s87, 1
s_add_u32 s85, s87, s88
s_and_b32 s85, s85, 3
s_andn2_b32 s83, s87, 3
s_or_b32 s85, s85, s83
s_add_u32 s87, s87, 1
s_lshl_b32 s83, s85, 7
s_add_u32 s81, s83, s86
s_add_u32 s82, s83, s89
s_add_u32 m0, s80, 24576
s_add_u32 s83, s81, 393216
buffer_load_dwordx4 v8, s[24:27], s83 offen lds
s_add_u32 m0, m0, 1024
s_add_u32 s83, s81, 409600
buffer_load_dwordx4 v9, s[24:27], s83 offen lds
s_add_u32 m0, m0, 1024
s_add_u32 s83, s81, 425984
buffer_load_dwordx4 v8, s[24:27], s83 offen lds
s_add_u32 m0, m0, 1024
s_add_u32 s83, s81, 442368
buffer_load_dwordx4 v9, s[24:27], s83 offen lds
s_add_u32 m0, m0, 1024
s_add_u32 s83, s81, 458752
buffer_load_dwordx4 v8, s[24:27], s83 offen lds
s_add_u32 m0, m0, 1024
s_add_u32 s83, s81, 475136
buffer_load_dwordx4 v9, s[24:27], s83 offen lds
s_add_u32 m0, m0, 1024
s_add_u32 s83, s81, 491520
buffer_load_dwordx4 v8, s[24:27], s83 offen lds
s_add_u32 m0, m0, 1024
s_add_u32 s83, s81, 507904
buffer_load_dwordx4 v9, s[24:27], s83 offen lds
s_add_u32 s80, s80, 49152
s_cmp_eq_u32 s80, 147456
s_cselect_b32 s80, 0, s80
s_waitcnt vmcnt(55)
s_mov_b32 s80, 98304
s_mov_b32 s87, 2
s_add_u32 s85, s87, s88
s_and_b32 s85, s85, 3
s_andn2_b32 s83, s87, 3
s_or_b32 s85, s85, s83
s_add_u32 s87, s87, 1
s_lshl_b32 s83, s85, 7
s_add_u32 s81, s83, s86
s_add_u32 s82, s83, s89
s_add_u32 m0, s80, 24576
s_add_u32 s83, s81, 393216
buffer_load_dwordx4 v8, s[24:27], s83 offen lds
s_add_u32 m0, m0, 1024
s_add_u32 s83, s81, 409600
buffer_load_dwordx4 v9, s[24:27], s83 offen lds
s_add_u32 m0, m0, 1024
s_add_u32 s83, s81, 425984
buffer_load_dwordx4 v8, s[24:27], s83 offen lds
s_add_u32 m0, m0, 1024
s_add_u32 s83, s81, 442368
buffer_load_dwordx4 v9, s[24:27], s83 offen lds
s_add_u32 m0, m0, 1024
s_add_u32 s83, s81, 458752
buffer_load_dwordx4 v8, s[24:27], s83 offen lds
s_add_u32 m0, m0, 1024
s_add_u32 s83, s81, 475136
buffer_load_dwordx4 v9, s[24:27], s83 offen lds
s_add_u32 m0, m0, 1024
s_add_u32 s83, s81, 491520
buffer_load_dwordx4 v8, s[24:27], s83 offen lds
s_add_u32 m0, m0, 1024
s_add_u32 s83, s81, 507904
buffer_load_dwordx4 v9, s[24:27], s83 offen lds
s_add_u32 s80, s80, 49152
s_cmp_eq_u32 s80, 147456
s_cselect_b32 s80, 0, s80
s_mov_b32 s80, 0
s_mov_b32 s87, 3
s_waitcnt vmcnt(16)
s_barrier
s_waitcnt vmcnt(8)
s_barrier
s_add_u32 s64, s62, 0
buffer_load_dword v48, v45, s[24:27], s64 offen sc1
s_add_u32 s64, s62, 1024
buffer_load_dword v49, v45, s[24:27], s64 offen sc1
s_add_u32 s64, s62, 2048
buffer_load_dword v50, v45, s[24:27], s64 offen sc1
s_add_u32 s64, s62, 3072
buffer_load_dword v51, v45, s[24:27], s64 offen sc1
s_add_u32 s85, s87, s88
s_and_b32 s85, s85, 3
s_andn2_b32 s83, s87, 3
s_or_b32 s85, s85, s83
s_add_u32 s87, s87, 1
s_lshl_b32 s83, s85, 7
s_add_u32 s81, s83, s86
s_add_u32 s82, s83, s89
s_add_u32 m0, s80, 24576
s_add_u32 s83, s81, 393216
buffer_load_dwordx4 v8, s[24:27], s83 offen lds
s_add_u32 m0, m0, 1024
s_add_u32 s83, s81, 409600
buffer_load_dwordx4 v9, s[24:27], s83 offen lds
s_add_u32 m0, m0, 1024
s_add_u32 s83, s81, 425984
buffer_load_dwordx4 v8, s[24:27], s83 offen lds
s_add_u32 m0, m0, 1024
s_add_u32 s83, s81, 442368
buffer_load_dwordx4 v9, s[24:27], s83 offen lds
s_add_u32 m0, m0, 1024
s_add_u32 s83, s81, 458752
buffer_load_dwordx4 v8, s[24:27], s83 offen lds
s_add_u32 m0, m0, 1024
s_add_u32 s83, s81, 475136
buffer_load_dwordx4 v9, s[24:27], s83 offen lds
s_add_u32 m0, m0, 1024
s_add_u32 s83, s81, 491520
buffer_load_dwordx4 v8, s[24:27], s83 offen lds
s_add_u32 m0, m0, 1024
s_add_u32 s83, s81, 507904
buffer_load_dwordx4 v9, s[24:27], s83 offen lds
s_add_u32 m0, m0, 1024
s_add_u32 s83, s82, 0
buffer_load_dwordx4 v8, s[8:11], s83 offen lds
s_add_u32 m0, m0, 1024
s_add_u32 s83, s82, 16384
buffer_load_dwordx4 v9, s[8:11], s83 offen lds
s_add_u32 m0, m0, 1024
s_add_u32 s83, s82, 0
buffer_load_dwordx4 v8, s[12:15], s83 offen lds
s_add_u32 m0, m0, 1024
s_add_u32 s83, s82, 16384
buffer_load_dwordx4 v9, s[12:15], s83 offen lds
s_add_u32 m0, m0, 1024
s_add_u32 s83, s82, 32768
buffer_load_dwordx4 v8, s[8:11], s83 offen lds
s_add_u32 m0, m0, 1024
s_add_u32 s83, s82, 49152
buffer_load_dwordx4 v9, s[8:11], s83 offen lds
s_add_u32 m0, m0, 1024
s_add_u32 s83, s82, 32768
buffer_load_dwordx4 v8, s[12:15], s83 offen lds
s_add_u32 m0, m0, 1024
s_add_u32 s83, s82, 49152
buffer_load_dwordx4 v9, s[12:15], s83 offen lds
s_add_u32 m0, m0, 1024
s_add_u32 s83, s82, 65536
buffer_load_dwordx4 v8, s[8:11], s83 offen lds
s_add_u32 m0, m0, 1024
s_add_u32 s83, s82, 81920
buffer_load_dwordx4 v9, s[8:11], s83 offen lds
s_add_u32 m0, m0, 1024
s_add_u32 s83, s82, 65536
buffer_load_dwordx4 v8, s[12:15], s83 offen lds
s_add_u32 m0, m0, 1024
s_add_u32 s83, s82, 81920
buffer_load_dwordx4 v9, s[12:15], s83 offen lds
s_add_u32 m0, m0, 1024
s_add_u32 s83, s82, 98304
buffer_load_dwordx4 v8, s[8:11], s83 offen lds
s_add_u32 m0, m0, 1024
s_add_u32 s83, s82, 114688
buffer_load_dwordx4 v9, s[8:11], s83 offen lds
s_add_u32 m0, m0, 1024
s_add_u32 s83, s82, 98304
buffer_load_dwordx4 v8, s[12:15], s83 offen lds
s_add_u32 m0, m0, 1024
s_add_u32 s83, s82, 114688
buffer_load_dwordx4 v9, s[12:15], s83 offen lds
s_add_u32 s80, s80, 49152
s_cmp_eq_u32 s80, 147456
s_cselect_b32 s80, 0, s80
s_mov_b32 s84, 12
K1_g1p1_loop:
s_waitcnt vmcnt(24)
s_barrier
s_cmp_lg_u32 s84, 12
s_cbranch_scc1 K1_g1p1_pb
s_mov_b32 s73, 0x40000
s_branch K1_g1p1_lnchk
K1_g1p1_lnpoll:
s_add_u32 s64, s62, 0
buffer_load_dword v48, v45, s[24:27], s64 offen sc1
s_add_u32 s64, s62, 1024
buffer_load_dword v49, v45, s[24:27], s64 offen sc1
s_add_u32 s64, s62, 2048
buffer_load_dword v50, v45, s[24:27], s64 offen sc1
s_add_u32 s64, s62, 3072
buffer_load_dword v51, v45, s[24:27], s64 offen sc1
s_waitcnt vmcnt(0)
K1_g1p1_lnchk:
v_xor_b32 v48, v48, v40
v_xor_b32 v49, v49, v41
v_xor_b32 v50, v50, v42
v_xor_b32 v51, v51, v43
v_min_u32 v48, v48, v49
v_min3_u32 v48, v48, v50, v51
v_cmp_eq_u32 vcc, 0, v48
s_cmp_eq_u64 vcc, 0
s_cbranch_scc1 K1_g1p1_lnok
s_sleep 2
s_sub_u32 s73, s73, 1
s_cmp_lg_u32 s73, 0
s_cbranch_scc1 K1_g1p1_lnpoll
K1_g1p1_lnok:
v_xor_b32 v47, 2, v44
s_mov_b64 exec, 255
buffer_store_dword v47, v46, s[24:27], s63 offen sc1
s_mov_b64 exec, -1
K1_g1p1_pb:
s_add_u32 s85, s87, s88
s_and_b32 s85, s85, 3
s_andn2_b32 s83, s87, 3
s_or_b32 s85, s85, s83
s_add_u32 s87, s87, 1
s_lshl_b32 s83, s85, 7
s_add_u32 s81, s83, s86
s_add_u32 s82, s83, s89
s_add_u32 m0, s80, 24576
s_add_u32 s83, s81, 393216
buffer_load_dwordx4 v8, s[24:27], s83 offen lds
s_add_u32 m0, m0, 1024
s_add_u32 s83, s81, 409600
buffer_load_dwordx4 v9, s[24:27], s83 offen lds
s_add_u32 m0, m0, 1024
s_add_u32 s83, s81, 425984
buffer_load_dwordx4 v8, s[24:27], s83 offen lds
s_add_u32 m0, m0, 1024
s_add_u32 s83, s81, 442368
buffer_load_dwordx4 v9, s[24:27], s83 offen lds
s_add_u32 m0, m0, 1024
s_add_u32 s83, s81, 458752
buffer_load_dwordx4 v8, s[24:27], s83 offen lds
s_add_u32 m0, m0, 1024
s_add_u32 s83, s81, 475136
buffer_load_dwordx4 v9, s[24:27], s83 offen lds
s_add_u32 m0, m0, 1024
s_add_u32 s83, s81, 491520
buffer_load_dwordx4 v8, s[24:27], s83 offen lds
s_add_u32 m0, m0, 1024
s_add_u32 s83, s81, 507904
buffer_load_dwordx4 v9, s[24:27], s83 offen lds
s_add_u32 m0, m0, 1024
s_add_u32 s83, s82, 0
buffer_load_dwordx4 v8, s[8:11], s83 offen lds
s_add_u32 m0, m0, 1024
s_add_u32 s83, s82, 16384
buffer_load_dwordx4 v9, s[8:11], s83 offen lds
s_add_u32 m0, m0, 1024
s_add_u32 s83, s82, 0
buffer_load_dwordx4 v8, s[12:15], s83 offen lds
s_add_u32 m0, m0, 1024
s_add_u32 s83, s82, 16384
buffer_load_dwordx4 v9, s[12:15], s83 offen lds
s_add_u32 m0, m0, 1024
s_add_u32 s83, s82, 32768
buffer_load_dwordx4 v8, s[8:11], s83 offen lds
s_add_u32 m0, m0, 1024
s_add_u32 s83, s82, 49152
buffer_load_dwordx4 v9, s[8:11], s83 offen lds
s_add_u32 m0, m0, 1024
s_add_u32 s83, s82, 32768
buffer_load_dwordx4 v8, s[12:15], s83 offen lds
s_add_u32 m0, m0, 1024
s_add_u32 s83, s82, 49152
buffer_load_dwordx4 v9, s[12:15], s83 offen lds
s_add_u32 m0, m0, 1024
s_add_u32 s83, s82, 65536
buffer_load_dwordx4 v8, s[8:11], s83 offen lds
s_add_u32 m0, m0, 1024
s_add_u32 s83, s82, 81920
buffer_load_dwordx4 v9, s[8:11], s83 offen lds
s_add_u32 m0, m0, 1024
s_add_u32 s83, s82, 65536
buffer_load_dwordx4 v8, s[12:15], s83 offen lds
s_add_u32 m0, m0, 1024
s_add_u32 s83, s82, 81920
buffer_load_dwordx4 v9, s[12:15], s83 offen lds
s_add_u32 m0, m0, 1024
s_add_u32 s83, s82, 98304
buffer_load_dwordx4 v8, s[8:11], s83 offen lds
s_add_u32 m0, m0, 1024
s_add_u32 s83, s82, 114688
buffer_load_dwordx4 v9, s[8:11], s83 offen lds
s_add_u32 m0, m0, 1024
s_add_u32 s83, s82, 98304
buffer_load_dwordx4 v8, s[12:15], s83 offen lds
s_add_u32 m0, m0, 1024
s_add_u32 s83, s82, 114688
buffer_load_dwordx4 v9, s[12:15], s83 offen lds
s_add_u32 s80, s80, 49152
s_cmp_eq_u32 s80, 147456
s_cselect_b32 s80, 0, s80
s_sub_u32 s84, s84, 1
s_cmp_lg_u32 s84, 0
s_cbranch_scc1 K1_g1p1_loop
s_bitcmp1_b32 s3, 0
s_cselect_b32 s28, s6, s4
s_cselect_b32 s29, s7, s5
s_mov_b32 s30, 2097152
s_mov_b32 s31, 0x20000
s_lshr_b32 s74, s3, 1
s_lshl_b32 s74, s74, 15
s_add_u32 s74, s74, 16384
buffer_load_dword v21, v10, s[28:31], s74 offen
s_add_u32 s74, s74, 8192
buffer_load_dword v21, v10, s[28:31], s74 offen
s_add_u32 s74, s74, 8192
s_waitcnt vmcnt(26)
s_barrier
s_waitcnt vmcnt(2)
s_barrier
K1_pb_b:
s_add_u32 s88, s35, s36
v_lshlrev_b32 v18, 4, v1
s_lshl_b32 s89, s43, 19
s_add_u32 s89, s89, 8388608
v_and_b32 v19, 31, v1
v_lshlrev_b32 v19, 2, v19
s_lshl_b32 s72, s43, 8
s_add_u32 s72, s72, 25432064
s_mov_b64 s[76:77], 0
s_barrier
s_mov_b32 s16, s20
s_mov_b32 s17, s21
s_mov_b32 s18, 14680064
s_mov_b32 s19, 0x20000
s_lshl_b32 s64, s3, 13
s_cmp_eq_u32 s34, 1
s_cselect_b32 s65, 2, 0
s_cselect_b32 s62, 6291456, 0
s_add_u32 s64, s64, s62
v_lshlrev_b32 v10, 7, v1
s_cmp_eq_u32 s65, 0
s_cbranch_scc1 K1_tw_done
K1_tw:
buffer_load_dword v21, v10, s[16:19], s64 offen
s_add_u32 s64, s64, 1048576
s_sub_u32 s65, s65, 1
s_cmp_lg_u32 s65, 0
s_cbranch_scc1 K1_tw
K1_tw_done:
s_mov_b32 s80, 0
s_mov_b32 s87, 0
s_add_u32 s85, s87, s88
s_and_b32 s85, s85, 3
s_andn2_b32 s83, s87, 3
s_or_b32 s85, s85, s83
s_add_u32 s87, s87, 1
s_add_u32 s85, s85, s66
s_lshr_b32 s83, s85, 1
s_bitcmp1_b32 s85, 0
s_cselect_b32 s82, 16, 0
s_add_u32 s82, s82, s83
s_lshl_b32 s82, s82, 14
s_add_u32 s82, s82, s89
s_lshl_b32 s83, s83, 1
s_lshl_b64 s[70:71], 3, s83
s_andn2_b64 s[74:75], s[70:71], s[76:77]
s_cbranch_scc0 K1_uf2_ok
s_mov_b32 s73, 0x40000
K1_uf2_poll:
buffer_load_dword v20, v19, s[24:27], s72 offen sc1
s_waitcnt vmcnt(0)
v_cmp_eq_u32 s[76:77], 1, v20
s_nop 0
s_andn2_b64 s[74:75], s[70:71], s[76:77]
s_cbranch_scc0 K1_uf2_ok
s_sleep 2
s_sub_u32 s73, s73, 1
s_cmp_lg_u32 s73, 0
s_cbranch_scc1 K1_uf2_poll
K1_uf2_ok:
s_add_u32 m0, s80, 16384
s_add_u32 s83, s82, 0
buffer_load_dwordx4 v18, s[24:27], s83 offen sc1 lds
s_add_u32 m0, m0, 1024
s_add_u32 s83, s82, 1024
buffer_load_dwordx4 v18, s[24:27], s83 offen sc1 lds
s_add_u32 m0, m0, 1024
s_add_u32 s83, s82, 2048
buffer_load_dwordx4 v18, s[24:27], s83 offen sc1 lds
s_add_u32 m0, m0, 1024
s_add_u32 s83, s82, 3072
buffer_load_dwordx4 v18, s[24:27], s83 offen sc1 lds
s_add_u32 m0, m0, 1024
s_add_u32 s83, s82, 4096
buffer_load_dwordx4 v18, s[24:27], s83 offen sc1 lds
s_add_u32 m0, m0, 1024
s_add_u32 s83, s82, 5120
buffer_load_dwordx4 v18, s[24:27], s83 offen sc1 lds
s_add_u32 m0, m0, 1024
s_add_u32 s83, s82, 6144
buffer_load_dwordx4 v18, s[24:27], s83 offen sc1 lds
s_add_u32 m0, m0, 1024
s_add_u32 s83, s82, 7168
buffer_load_dwordx4 v18, s[24:27], s83 offen sc1 lds
s_add_u32 m0, m0, 1024
s_add_u32 s83, s82, 8192
buffer_load_dwordx4 v18, s[24:27], s83 offen sc1 lds
s_add_u32 m0, m0, 1024
s_add_u32 s83, s82, 9216
buffer_load_dwordx4 v18, s[24:27], s83 offen sc1 lds
s_add_u32 m0, m0, 1024
s_add_u32 s83, s82, 10240
buffer_load_dwordx4 v18, s[24:27], s83 offen sc1 lds
s_add_u32 m0, m0, 1024
s_add_u32 s83, s82, 11264
buffer_load_dwordx4 v18, s[24:27], s83 offen sc1 lds
s_add_u32 m0, m0, 1024
s_add_u32 s83, s82, 12288
buffer_load_dwordx4 v18, s[24:27], s83 offen sc1 lds
s_add_u32 m0, m0, 1024
s_add_u32 s83, s82, 13312
buffer_load_dwordx4 v18, s[24:27], s83 offen sc1 lds
s_add_u32 m0, m0, 1024
s_add_u32 s83, s82, 14336
buffer_load_dwordx4 v18, s[24:27], s83 offen sc1 lds
s_add_u32 m0, m0, 1024
s_add_u32 s83, s82, 15360
buffer_load_dwordx4 v18, s[24:27], s83 offen sc1 lds
s_add_u32 s80, s80, 32768
s_cmp_eq_u32 s80, 131072
s_cselect_b32 s80, 0, s80
s_add_u32 s85, s87, s88
s_and_b32 s85, s85, 3
s_andn2_b32 s83, s87, 3
s_or_b32 s85, s85, s83
s_add_u32 s87, s87, 1
s_add_u32 s85, s85, s66
s_lshr_b32 s83, s85, 1
s_bitcmp1_b32 s85, 0
s_cselect_b32 s82, 16, 0
s_add_u32 s82, s82, s83
s_lshl_b32 s82, s82, 14
s_add_u32 s82, s82, s89
s_lshl_b32 s83, s83, 1
s_lshl_b64 s[70:71], 3, s83
s_andn2_b64 s[74:75], s[70:71], s[76:77]
s_cbranch_scc0 K1_uf3_ok
s_mov_b32 s73, 0x40000
K1_uf3_poll:
buffer_load_dword v20, v19, s[24:27], s72 offen sc1
s_waitcnt vmcnt(0)
v_cmp_eq_u32 s[76:77], 1, v20
s_nop 0
s_andn2_b64 s[74:75], s[70:71], s[76:77]
s_cbranch_scc0 K1_uf3_ok
s_sleep 2
s_sub_u32 s73, s73, 1
s_cmp_lg_u32 s73, 0
s_cbranch_scc1 K1_uf3_poll
K1_uf3_ok:
s_add_u32 m0, s80, 16384
s_add_u32 s83, s82, 0
buffer_load_dwordx4 v18, s[24:27], s83 offen sc1 lds
s_add_u32 m0, m0, 1024
s_add_u32 s83, s82, 1024
buffer_load_dwordx4 v18, s[24:27], s83 offen sc1 lds
s_add_u32 m0, m0, 1024
s_add_u32 s83, s82, 2048
buffer_load_dwordx4 v18, s[24:27], s83 offen sc1 lds
s_add_u32 m0, m0, 1024
s_add_u32 s83, s82, 3072
buffer_load_dwordx4 v18, s[24:27], s83 offen sc1 lds
s_add_u32 m0, m0, 1024
s_add_u32 s83, s82, 4096
buffer_load_dwordx4 v18, s[24:27], s83 offen sc1 lds
s_add_u32 m0, m0, 1024
s_add_u32 s83, s82, 5120
buffer_load_dwordx4 v18, s[24:27], s83 offen sc1 lds
s_add_u32 m0, m0, 1024
s_add_u32 s83, s82, 6144
buffer_load_dwordx4 v18, s[24:27], s83 offen sc1 lds
s_add_u32 m0, m0, 1024
s_add_u32 s83, s82, 7168
buffer_load_dwordx4 v18, s[24:27], s83 offen sc1 lds
s_add_u32 m0, m0, 1024
s_add_u32 s83, s82, 8192
buffer_load_dwordx4 v18, s[24:27], s83 offen sc1 lds
s_add_u32 m0, m0, 1024
s_add_u32 s83, s82, 9216
buffer_load_dwordx4 v18, s[24:27], s83 offen sc1 lds
s_add_u32 m0, m0, 1024
s_add_u32 s83, s82, 10240
buffer_load_dwordx4 v18, s[24:27], s83 offen sc1 lds
s_add_u32 m0, m0, 1024
s_add_u32 s83, s82, 11264
buffer_load_dwordx4 v18, s[24:27], s83 offen sc1 lds
s_add_u32 m0, m0, 1024
s_add_u32 s83, s82, 12288
buffer_load_dwordx4 v18, s[24:27], s83 offen sc1 lds
s_add_u32 m0, m0, 1024
s_add_u32 s83, s82, 13312
buffer_load_dwordx4 v18, s[24:27], s83 offen sc1 lds
s_add_u32 m0, m0, 1024
s_add_u32 s83, s82, 14336
buffer_load_dwordx4 v18, s[24:27], s83 offen sc1 lds
s_add_u32 m0, m0, 1024
s_add_u32 s83, s82, 15360
buffer_load_dwordx4 v18, s[24:27], s83 offen sc1 lds
s_add_u32 s80, s80, 32768
s_cmp_eq_u32 s80, 131072
s_cselect_b32 s80, 0, s80
s_waitcnt vmcnt(16)
s_barrier
s_add_u32 s85, s87, s88
s_and_b32 s85, s85, 3
s_andn2_b32 s83, s87, 3
s_or_b32 s85, s85, s83
s_add_u32 s87, s87, 1
s_add_u32 s85, s85, s66
s_lshr_b32 s83, s85, 1
s_bitcmp1_b32 s85, 0
s_cselect_b32 s82, 16, 0
s_add_u32 s82, s82, s83
s_lshl_b32 s82, s82, 14
s_add_u32 s82, s82, s89
s_lshl_b32 s83, s83, 1
s_lshl_b64 s[70:71], 3, s83
s_andn2_b64 s[74:75], s[70:71], s[76:77]
s_cbranch_scc0 K1_uf4_ok
s_mov_b32 s73, 0x40000
K1_uf4_poll:
buffer_load_dword v20, v19, s[24:27], s72 offen sc1
s_waitcnt vmcnt(0)
v_cmp_eq_u32 s[76:77], 1, v20
s_nop 0
s_andn2_b64 s[74:75], s[70:71], s[76:77]
s_cbranch_scc0 K1_uf4_ok
s_sleep 2
s_sub_u32 s73, s73, 1
s_cmp_lg_u32 s73, 0
s_cbranch_scc1 K1_uf4_poll
K1_uf4_ok:
s_add_u32 m0, s80, 16384
s_add_u32 s83, s82, 0
buffer_load_dwordx4 v18, s[24:27], s83 offen sc1 lds
s_add_u32 m0, m0, 1024
s_add_u32 s83, s82, 1024
buffer_load_dwordx4 v18, s[24:27], s83 offen sc1 lds
s_add_u32 m0, m0, 1024
s_add_u32 s83, s82, 2048
buffer_load_dwordx4 v18, s[24:27], s83 offen sc1 lds
s_add_u32 m0, m0, 1024
s_add_u32 s83, s82, 3072
buffer_load_dwordx4 v18, s[24:27], s83 offen sc1 lds
s_add_u32 m0, m0, 1024
s_add_u32 s83, s82, 4096
buffer_load_dwordx4 v18, s[24:27], s83 offen sc1 lds
s_add_u32 m0, m0, 1024
s_add_u32 s83, s82, 5120
buffer_load_dwordx4 v18, s[24:27], s83 offen sc1 lds
s_add_u32 m0, m0, 1024
s_add_u32 s83, s82, 6144
buffer_load_dwordx4 v18, s[24:27], s83 offen sc1 lds
s_add_u32 m0, m0, 1024
s_add_u32 s83, s82, 7168
buffer_load_dwordx4 v18, s[24:27], s83 offen sc1 lds
s_add_u32 m0, m0, 1024
s_add_u32 s83, s82, 8192
buffer_load_dwordx4 v18, s[24:27], s83 offen sc1 lds
s_add_u32 m0, m0, 1024
s_add_u32 s83, s82, 9216
buffer_load_dwordx4 v18, s[24:27], s83 offen sc1 lds
s_add_u32 m0, m0, 1024
s_add_u32 s83, s82, 10240
buffer_load_dwordx4 v18, s[24:27], s83 offen sc1 lds
s_add_u32 m0, m0, 1024
s_add_u32 s83, s82, 11264
buffer_load_dwordx4 v18, s[24:27], s83 offen sc1 lds
s_add_u32 m0, m0, 1024
s_add_u32 s83, s82, 12288
buffer_load_dwordx4 v18, s[24:27], s83 offen sc1 lds
s_add_u32 m0, m0, 1024
s_add_u32 s83, s82, 13312
buffer_load_dwordx4 v18, s[24:27], s83 offen sc1 lds
s_add_u32 m0, m0, 1024
s_add_u32 s83, s82, 14336
buffer_load_dwordx4 v18, s[24:27], s83 offen sc1 lds
s_add_u32 m0, m0, 1024
s_add_u32 s83, s82, 15360
buffer_load_dwordx4 v18, s[24:27], s83 offen sc1 lds
s_add_u32 s80, s80, 32768
s_cmp_eq_u32 s80, 131072
s_cselect_b32 s80, 0, s80
s_waitcnt vmcnt(16)
s_barrier
s_add_u32 s85, s87, s88
s_and_b32 s85, s85, 3
s_andn2_b32 s83, s87, 3
s_or_b32 s85, s85, s83
s_add_u32 s87, s87, 1
s_add_u32 s85, s85, s66
s_lshr_b32 s83, s85, 1
s_bitcmp1_b32 s85, 0
s_cselect_b32 s82, 16, 0
s_add_u32 s82, s82, s83
s_lshl_b32 s82, s82, 14
s_add_u32 s82, s82, s89
s_lshl_b32 s83, s83, 1
s_lshl_b64 s[70:71], 3, s83
s_andn2_b64 s[74:75], s[70:71], s[76:77]
s_cbranch_scc0 K1_uf5_ok
s_mov_b32 s73, 0x40000
K1_uf5_poll:
buffer_load_dword v20, v19, s[24:27], s72 offen sc1
s_waitcnt vmcnt(0)
v_cmp_eq_u32 s[76:77], 1, v20
s_nop 0
s_andn2_b64 s[74:75], s[70:71], s[76:77]
s_cbranch_scc0 K1_uf5_ok
s_sleep 2
s_sub_u32 s73, s73, 1
s_cmp_lg_u32 s73, 0
s_cbranch_scc1 K1_uf5_poll
K1_uf5_ok:
s_add_u32 m0, s80, 16384
s_add_u32 s83, s82, 0
buffer_load_dwordx4 v18, s[24:27], s83 offen sc1 lds
s_add_u32 m0, m0, 1024
s_add_u32 s83, s82, 1024
buffer_load_dwordx4 v18, s[24:27], s83 offen sc1 lds
s_add_u32 m0, m0, 1024
s_add_u32 s83, s82, 2048
buffer_load_dwordx4 v18, s[24:27], s83 offen sc1 lds
s_add_u32 m0, m0, 1024
s_add_u32 s83, s82, 3072
buffer_load_dwordx4 v18, s[24:27], s83 offen sc1 lds
s_add_u32 m0, m0, 1024
s_add_u32 s83, s82, 4096
buffer_load_dwordx4 v18, s[24:27], s83 offen sc1 lds
s_add_u32 m0, m0, 1024
s_add_u32 s83, s82, 5120
buffer_load_dwordx4 v18, s[24:27], s83 offen sc1 lds
s_add_u32 m0, m0, 1024
s_add_u32 s83, s82, 6144
buffer_load_dwordx4 v18, s[24:27], s83 offen sc1 lds
s_add_u32 m0, m0, 1024
s_add_u32 s83, s82, 7168
buffer_load_dwordx4 v18, s[24:27], s83 offen sc1 lds
s_add_u32 m0, m0, 1024
s_add_u32 s83, s82, 8192
buffer_load_dwordx4 v18, s[24:27], s83 offen sc1 lds
s_add_u32 m0, m0, 1024
s_add_u32 s83, s82, 9216
buffer_load_dwordx4 v18, s[24:27], s83 offen sc1 lds
s_add_u32 m0, m0, 1024
s_add_u32 s83, s82, 10240
buffer_load_dwordx4 v18, s[24:27], s83 offen sc1 lds
s_add_u32 m0, m0, 1024
s_add_u32 s83, s82, 11264
buffer_load_dwordx4 v18, s[24:27], s83 offen sc1 lds
s_add_u32 m0, m0, 1024
s_add_u32 s83, s82, 12288
buffer_load_dwordx4 v18, s[24:27], s83 offen sc1 lds
s_add_u32 m0, m0, 1024
s_add_u32 s83, s82, 13312
buffer_load_dwordx4 v18, s[24:27], s83 offen sc1 lds
s_add_u32 m0, m0, 1024
s_add_u32 s83, s82, 14336
buffer_load_dwordx4 v18, s[24:27], s83 offen sc1 lds
s_add_u32 m0, m0, 1024
s_add_u32 s83, s82, 15360
buffer_load_dwordx4 v18, s[24:27], s83 offen sc1 lds
s_add_u32 s80, s80, 32768
s_cmp_eq_u32 s80, 131072
s_cselect_b32 s80, 0, s80
s_add_u32 s85, s87, s88
s_and_b32 s85, s85, 3
s_andn2_b32 s83, s87, 3
s_or_b32 s85, s85, s83
s_add_u32 s87, s87, 1
s_add_u32 s85, s85, s66
s_lshr_b32 s83, s85, 1
s_bitcmp1_b32 s85, 0
s_cselect_b32 s82, 16, 0
s_add_u32 s82, s82, s83
s_lshl_b32 s82, s82, 14
s_add_u32 s82, s82, s89
s_lshl_b32 s83, s83, 1
s_lshl_b64 s[70:71], 3, s83
s_andn2_b64 s[74:75], s[70:71], s[76:77]
s_cbranch_scc0 K1_uf6_ok
s_mov_b32 s73, 0x40000
K1_uf6_poll:
buffer_load_dword v20, v19, s[24:27], s72 offen sc1
s_waitcnt vmcnt(0)
v_cmp_eq_u32 s[76:77], 1, v20
s_nop 0
s_andn2_b64 s[74:75], s[70:71], s[76:77]
s_cbranch_scc0 K1_uf6_ok
s_sleep 2
s_sub_u32 s73, s73, 1
s_cmp_lg_u32 s73, 0
s_cbranch_scc1 K1_uf6_poll
K1_uf6_ok:
s_add_u32 m0, s80, 16384
s_add_u32 s83, s82, 0
buffer_load_dwordx4 v18, s[24:27], s83 offen sc1 lds
s_add_u32 m0, m0, 1024
s_add_u32 s83, s82, 1024
buffer_load_dwordx4 v18, s[24:27], s83 offen sc1 lds
s_add_u32 m0, m0, 1024
s_add_u32 s83, s82, 2048
buffer_load_dwordx4 v18, s[24:27], s83 offen sc1 lds
s_add_u32 m0, m0, 1024
s_add_u32 s83, s82, 3072
buffer_load_dwordx4 v18, s[24:27], s83 offen sc1 lds
s_add_u32 m0, m0, 1024
s_add_u32 s83, s82, 4096
buffer_load_dwordx4 v18, s[24:27], s83 offen sc1 lds
s_add_u32 m0, m0, 1024
s_add_u32 s83, s82, 5120
buffer_load_dwordx4 v18, s[24:27], s83 offen sc1 lds
s_add_u32 m0, m0, 1024
s_add_u32 s83, s82, 6144
buffer_load_dwordx4 v18, s[24:27], s83 offen sc1 lds
s_add_u32 m0, m0, 1024
s_add_u32 s83, s82, 7168
buffer_load_dwordx4 v18, s[24:27], s83 offen sc1 lds
s_add_u32 m0, m0, 1024
s_add_u32 s83, s82, 8192
buffer_load_dwordx4 v18, s[24:27], s83 offen sc1 lds
s_add_u32 m0, m0, 1024
s_add_u32 s83, s82, 9216
buffer_load_dwordx4 v18, s[24:27], s83 offen sc1 lds
s_add_u32 m0, m0, 1024
s_add_u32 s83, s82, 10240
buffer_load_dwordx4 v18, s[24:27], s83 offen sc1 lds
s_add_u32 m0, m0, 1024
s_add_u32 s83, s82, 11264
buffer_load_dwordx4 v18, s[24:27], s83 offen sc1 lds
s_add_u32 m0, m0, 1024
s_add_u32 s83, s82, 12288
buffer_load_dwordx4 v18, s[24:27], s83 offen sc1 lds
s_add_u32 m0, m0, 1024
s_add_u32 s83, s82, 13312
buffer_load_dwordx4 v18, s[24:27], s83 offen sc1 lds
s_add_u32 m0, m0, 1024
s_add_u32 s83, s82, 14336
buffer_load_dwordx4 v18, s[24:27], s83 offen sc1 lds
s_add_u32 m0, m0, 1024
s_add_u32 s83, s82, 15360
buffer_load_dwordx4 v18, s[24:27], s83 offen sc1 lds
s_add_u32 s80, s80, 32768
s_cmp_eq_u32 s80, 131072
s_cselect_b32 s80, 0, s80
s_sub_u32 s84, s67, 1
K1_pbH_loop:
s_waitcnt vmcnt(32)
s_barrier
s_add_u32 s85, s87, s88
s_and_b32 s85, s85, 3
s_andn2_b32 s83, s87, 3
s_or_b32 s85, s85, s83
s_add_u32 s87, s87, 1
s_add_u32 s85, s85, s66
s_lshr_b32 s83, s85, 1
s_bitcmp1_b32 s85, 0
s_cselect_b32 s82, 16, 0
s_add_u32 s82, s82, s83
s_lshl_b32 s82, s82, 14
s_add_u32 s82, s82, s89
s_lshl_b32 s83, s83, 1
s_lshl_b64 s[70:71], 3, s83
s_andn2_b64 s[74:75], s[70:71], s[76:77]
s_cbranch_scc0 K1_uf7_ok
s_mov_b32 s73, 0x40000
K1_uf7_poll:
buffer_load_dword v20, v19, s[24:27], s72 offen sc1
s_waitcnt vmcnt(0)
v_cmp_eq_u32 s[76:77], 1, v20
s_nop 0
s_andn2_b64 s[74:75], s[70:71], s[76:77]
s_cbranch_scc0 K1_uf7_ok
s_sleep 2
s_sub_u32 s73, s73, 1
s_cmp_lg_u32 s73, 0
s_cbranch_scc1 K1_uf7_poll
K1_uf7_ok:
s_add_u32 m0, s80, 16384
s_add_u32 s83, s82, 0
buffer_load_dwordx4 v18, s[24:27], s83 offen sc1 lds
s_add_u32 m0, m0, 1024
s_add_u32 s83, s82, 1024
buffer_load_dwordx4 v18, s[24:27], s83 offen sc1 lds
s_add_u32 m0, m0, 1024
s_add_u32 s83, s82, 2048
buffer_load_dwordx4 v18, s[24:27], s83 offen sc1 lds
s_add_u32 m0, m0, 1024
s_add_u32 s83, s82, 3072
buffer_load_dwordx4 v18, s[24:27], s83 offen sc1 lds
s_add_u32 m0, m0, 1024
s_add_u32 s83, s82, 4096
buffer_load_dwordx4 v18, s[24:27], s83 offen sc1 lds
s_add_u32 m0, m0, 1024
s_add_u32 s83, s82, 5120
buffer_load_dwordx4 v18, s[24:27], s83 offen sc1 lds
s_add_u32 m0, m0, 1024
s_add_u32 s83, s82, 6144
buffer_load_dwordx4 v18, s[24:27], s83 offen sc1 lds
s_add_u32 m0, m0, 1024
s_add_u32 s83, s82, 7168
buffer_load_dwordx4 v18, s[24:27], s83 offen sc1 lds
s_add_u32 m0, m0, 1024
s_add_u32 s83, s82, 8192
buffer_load_dwordx4 v18, s[24:27], s83 offen sc1 lds
s_add_u32 m0, m0, 1024
s_add_u32 s83, s82, 9216
buffer_load_dwordx4 v18, s[24:27], s83 offen sc1 lds
s_add_u32 m0, m0, 1024
s_add_u32 s83, s82, 10240
buffer_load_dwordx4 v18, s[24:27], s83 offen sc1 lds
s_add_u32 m0, m0, 1024
s_add_u32 s83, s82, 11264
buffer_load_dwordx4 v18, s[24:27], s83 offen sc1 lds
s_add_u32 m0, m0, 1024
s_add_u32 s83, s82, 12288
buffer_load_dwordx4 v18, s[24:27], s83 offen sc1 lds
s_add_u32 m0, m0, 1024
s_add_u32 s83, s82, 13312
buffer_load_dwordx4 v18, s[24:27], s83 offen sc1 lds
s_add_u32 m0, m0, 1024
s_add_u32 s83, s82, 14336
buffer_load_dwordx4 v18, s[24:27], s83 offen sc1 lds
s_add_u32 m0, m0, 1024
s_add_u32 s83, s82, 15360
buffer_load_dwordx4 v18, s[24:27], s83 offen sc1 lds
s_add_u32 s80, s80, 32768
s_cmp_eq_u32 s80, 131072
s_cselect_b32 s80, 0, s80
s_sub_u32 s84, s84, 1
s_cmp_lg_u32 s84, 0
s_cbranch_scc1 K1_pbH_loop
s_mov_b32 s87, 0
s_bitcmp1_b32 s33, 0
s_cselect_b32 s63, -1, 0
s_cselect_b32 s78, 56, 0
s_andn2_b32 s79, s68, 7
s_andn2_b32 s69, s68, 3
s_lshl_b32 s88, s88, 1
s_add_u32 s88, s88, s34
s_mov_b32 s16, s20
s_mov_b32 s17, s21
s_mov_b32 s18, 14680064
s_mov_b32 s19, 0x20000
v_lshrrev_b32 v2, 4, v1
v_and_b32 v3, 15, v1
v_lshlrev_b32 v4, 1, v2
v_xor_b32 v3, v3, v4
s_mov_b32 s90, 4096
v_mul_lo_u32 v2, v2, s90
v_lshlrev_b32 v3, 4, v3
v_add_u32 v16, v2, v3
v_xor_b32 v3, 128, v3
v_add_u32 v17, v2, v3
s_lshl_b32 s89, s43, 8
s_mov_b32 s84, s68
K1_pbW_loop:
s_waitcnt vmcnt(32)
s_barrier
s_cmp_lt_u32 s87, s69
s_cselect_b32 s83, 3, 0
s_cmp_lt_u32 s87, s79
s_cselect_b32 s83, 7, s83
s_add_u32 s85, s87, s88
s_and_b32 s85, s85, s83
s_andn2_b32 s83, s87, s83
s_or_b32 s85, s85, s83
s_add_u32 s87, s87, 1
s_xor_b32 s85, s85, s63
s_add_u32 s85, s85, s78
s_lshl_b32 s82, s85, 18
s_add_u32 s82, s82, s89
s_add_u32 m0, s80, 16384
s_add_u32 s83, s82, 0
buffer_load_dwordx4 v16, s[16:19], s83 offen lds
s_add_u32 m0, m0, 1024
s_add_u32 s83, s82, 16384
buffer_load_dwordx4 v17, s[16:19], s83 offen lds
s_add_u32 m0, m0, 1024
s_add_u32 s83, s82, 32768
buffer_load_dwordx4 v16, s[16:19], s83 offen lds
s_add_u32 m0, m0, 1024
s_add_u32 s83, s82, 49152
buffer_load_dwordx4 v17, s[16:19], s83 offen lds
s_add_u32 m0, m0, 1024
s_add_u32 s83, s82, 65536
buffer_load_dwordx4 v16, s[16:19], s83 offen lds
s_add_u32 m0, m0, 1024
s_add_u32 s83, s82, 81920
buffer_load_dwordx4 v17, s[16:19], s83 offen lds
s_add_u32 m0, m0, 1024
s_add_u32 s83, s82, 98304
buffer_load_dwordx4 v16, s[16:19], s83 offen lds
s_add_u32 m0, m0, 1024
s_add_u32 s83, s82, 114688
buffer_load_dwordx4 v17, s[16:19], s83 offen lds
s_add_u32 m0, m0, 1024
s_add_u32 s83, s82, 131072
buffer_load_dwordx4 v16, s[16:19], s83 offen lds
s_add_u32 m0, m0, 1024
s_add_u32 s83, s82, 147456
buffer_load_dwordx4 v17, s[16:19], s83 offen lds
s_add_u32 m0, m0, 1024
s_add_u32 s83, s82, 163840
buffer_load_dwordx4 v16, s[16:19], s83 offen lds
s_add_u32 m0, m0, 1024
s_add_u32 s83, s82, 180224
buffer_load_dwordx4 v17, s[16:19], s83 offen lds
s_add_u32 m0, m0, 1024
s_add_u32 s83, s82, 196608
buffer_load_dwordx4 v16, s[16:19], s83 offen lds
s_add_u32 m0, m0, 1024
s_add_u32 s83, s82, 212992
buffer_load_dwordx4 v17, s[16:19], s83 offen lds
s_add_u32 m0, m0, 1024
s_add_u32 s83, s82, 229376
buffer_load_dwordx4 v16, s[16:19], s83 offen lds
s_add_u32 m0, m0, 1024
s_add_u32 s83, s82, 245760
buffer_load_dwordx4 v17, s[16:19], s83 offen lds
s_add_u32 s80, s80, 32768
s_cmp_eq_u32 s80, 131072
s_cselect_b32 s80, 0, s80
s_sub_u32 s84, s84, 1
s_cmp_lg_u32 s84, 0
s_cbranch_scc1 K1_pbW_loop
s_waitcnt vmcnt(32)
s_barrier
s_waitcnt vmcnt(16)
s_barrier
s_waitcnt vmcnt(0)
s_barrier
s_waitcnt lgkmcnt(0)
K1_end:
s_endpgm
K1_code_end:
.section .rodata,"a"
.p2align 6
.amdhsa_kernel k1_kernel
  .amdhsa_next_free_vgpr 256
  .amdhsa_next_free_sgpr 102
  .amdhsa_accum_offset 256
  .amdhsa_group_segment_fixed_size 0
  .amdhsa_kernarg_size 136
  .amdhsa_user_sgpr_count 2
  .amdhsa_user_sgpr_kernarg_segment_ptr 1
  .amdhsa_system_sgpr_workgroup_id_x 1
  .amdhsa_float_denorm_mode_32 3
  .amdhsa_float_denorm_mode_16_64 3
.end_amdhsa_kernel
```
